```python
import torch

def _softmax(x, axis=-1):
    return torch.softmax(x, dim=axis)

def _gelu(x):
    return torch.nn.functional.gelu(x, approximate='tanh')

def _silu(x):
    return torch.nn.functional.silu(x)

def _sigmoid(x):
    return torch.sigmoid(x)

def _layernorm(x, axis=-1, eps=1e-05):
    m = x.mean(dim=axis, keepdim=True)
    v = x.var(dim=axis, keepdim=True, unbiased=False)
    return (x - m) / torch.sqrt(v + eps)

def _scatter_add(tgt, idx, src, axis=0):
    return tgt.clone().index_add_(axis, idx, src)

def _segment_sum(src, seg, n):
    out = torch.zeros((n,) + src.shape[1:], dtype=src.dtype)
    return out.index_add_(0, seg, src)

def _pad(x, pw):
    flat = tuple((v for pair in reversed(pw) for v in pair))
    return torch.nn.functional.pad(x, flat)
kernel_name = 'standalone__conformer_family_zipformer__speech'

def setup_inputs():

    _w = lambda a: (lambda t: t.to(torch.bfloat16) if t.is_floating_point() else t)(torch.as_tensor(a))
    B, T, D, K, H = (2, 4000, 256, 31, 4)
    sc = 0.1
    return {'x': _w((lambda *s: torch.randn(*s, dtype=torch.bfloat16) * 0.8)(B, T, D)), 'w_ff1a': _w((lambda *s: torch.randn(*s, dtype=torch.bfloat16) * 0.8)(D, 4 * D) * sc), 'w_ff1b': _w((lambda *s: torch.randn(*s, dtype=torch.bfloat16) * 0.8)(4 * D, D) * sc), 'w_qkv': _w((lambda *s: torch.randn(*s, dtype=torch.bfloat16) * 0.8)(D, 3 * D) * sc), 'w_o': _w((lambda *s: torch.randn(*s, dtype=torch.bfloat16) * 1.6)(D, D) * sc), 'w_pw1': _w((lambda *s: torch.randn(*s, dtype=torch.bfloat16) * 1.6)(D, 2 * D) * sc), 'dw': _w((lambda *s: torch.randn(*s, dtype=torch.bfloat16) * 0.4)(K, D)), 'w_pw2': _w((lambda *s: torch.randn(*s, dtype=torch.bfloat16) * 0.4)(D, D) * sc), 'w_ff2a': _w((lambda *s: torch.randn(*s, dtype=torch.bfloat16) * 0.8)(D, 4 * D) * sc), 'w_ff2b': _w((lambda *s: torch.randn(*s, dtype=torch.bfloat16) * 0.8)(4 * D, D) * sc)}

def reference(x, w_ff1a, w_ff1b, w_qkv, w_o, w_pw1, dw, w_pw2, w_ff2a, w_ff2b):
    B, T, D = x.shape
    K = dw.shape[0]
    H = 4
    Dh = D // H
    h = _layernorm(x, axis=-1)
    h = _silu(h @ w_ff1a) @ w_ff1b
    x = x + 0.5 * h
    h = _layernorm(x, axis=-1)
    qkv = h @ w_qkv
    q = (lambda x, *d: x.permute(*d))(qkv[..., :D].reshape(B, T, H, Dh), 0, 2, 1, 3)
    k = (lambda x, *d: x.permute(*d))(qkv[..., D:2 * D].reshape(B, T, H, Dh), 0, 2, 1, 3)
    v = (lambda x, *d: x.permute(*d))(qkv[..., 2 * D:].reshape(B, T, H, Dh), 0, 2, 1, 3)
    scale = Dh ** (-0.5)
    scores = torch.einsum('bhqd,bhkd->bhqk', q, k) * scale
    p = _softmax(scores, axis=-1)
    att = torch.einsum('bhqk,bhkd->bhqd', p, v)
    att = (lambda x, *d: x.permute(*d))(att, 0, 2, 1, 3).reshape(B, T, D)
    x = x + att @ w_o
    h = _layernorm(x, axis=-1)
    h = h @ w_pw1
    a, b = (h[..., :D].clone(), h[..., D:].clone())
    h = a * _sigmoid(b)
    pad = K // 2
    hp = _pad(h, ((0, 0), (pad, pad), (0, 0)))
    c = torch.zeros_like(h)
    for i in range(K):
        c = c + hp[:, i:i + T, :] * dw[i][None, None, :]
    x = x + _silu(c) @ w_pw2
    h = _layernorm(x, axis=-1)
    h = _silu(h @ w_ff2a) @ w_ff2b
    x = x + 0.5 * h
    return _layernorm(x, axis=-1)
```

```asm
; @launch grid=(256,1,1) block=(256,1,1) lds=150528
.amdgcn_target "amdgcn-amd-amdhsa--gfx950"
.text
.globl standalone__conformer_family_zipformer__speech_kernel
.p2align 8
.type standalone__conformer_family_zipformer__speech_kernel,@function
standalone__conformer_family_zipformer__speech_kernel:
    s_cmp_ge_u32 s2, 256
    s_cbranch_scc1 standalone__conformer_family_zipformer__speech_kernel_end
    s_load_dwordx4 s[4:7], s[0:1], 0
    s_load_dwordx4 s[8:11], s[0:1], 16
    s_load_dwordx2 s[14:15], s[0:1], 96
    s_load_dwordx4 s[96:99], s[0:1], 80
    s_getpc_b64 s[36:37]
    v_and_b32 v13, 63, v0
    v_lshlrev_b32 v13, 7, v13
    s_mov_b64 exec, -1
    global_load_dword v14, v13, s[36:37]
    s_mov_b64 exec, -1
    v_lshrrev_b32 v2, 6, v0
    v_and_b32 v1, 63, v0
    v_readfirstlane_b32 s20, v2
    v_lshlrev_b32 v1, 4, v1
    s_and_b32 s29, s2, 7
    s_lshr_b32 s30, s2, 3
    s_lshl_b32 s24, s29, 5
    s_add_u32 s24, s24, s30
    s_xor_b32 s25, s24, 1
    s_and_b32 s26, s30, 1
    s_mul_i32 s21, s20, 20480
    s_add_u32 s21, s21, 65536
    v_bfe_u32 v11, v0, 3, 3
    v_bfe_u32 v12, v0, 4, 1
    v_lshlrev_b32 v12, 2, v12
    v_xor_b32 v12, v12, v0
    v_and_b32 v12, 7, v12
    v_lshlrev_b32 v12, 4, v12
    s_cmp_ge_u32 s24, 250
    s_cbranch_scc1 standalone__conformer_family_zipformer__speech_kernel_cprep
    v_and_b32 v236, 31, v0
    v_bfe_u32 v237, v0, 4, 2
    v_xor_b32 v237, v237, v0
    v_and_b32 v237, 7, v237
    v_lshlrev_b32 v237, 4, v237
    v_lshl_add_u32 v2, v11, 9, v237
    v_xor_b32 v3, 64, v2
    v_add_u32 v3, 3072, v3
    v_add_u32 v4, 6144, v2
    v_add_u32 v5, 6144, v3
    s_lshl_b32 s31, s20, 7
    s_lshl_b32 s32, s24, 14
    s_add_u32 s32, s32, s31
    s_lshl_b32 s33, s25, 14
    s_add_u32 s33, s33, s31
    s_mov_b32 m0, s21
    s_lshl_b32 s35, s30, 2
    s_add_u32 s35, s35, s20
    s_mul_i32 s34, s35, 3072
    s_lshl_b32 s35, s35, 12
    v_lshlrev_b32 v245, 7, v236
    v_add_u32 v246, s35, v245
    v_min_u32 v245, 2944, v245
    v_add_u32 v245, s34, v245
    v_mov_b32 v250, v245
    s_xor_b32 s44, s2, 8
    s_lshl_b32 s44, s44, 2
    s_add_u32 s44, s44, s20
    s_lshl_b32 s45, s2, 2
    s_add_u32 s45, s45, s20
    s_lshl_b32 s46, s44, 9
    s_add_u32 s46, s46, 34603008
    v_mov_b32 v240, s46
    s_lshl_b32 s46, s45, 9
    s_add_u32 s46, s46, 34603008
    v_mov_b32 v241, s46
    s_lshr_b32 s50, s20, 1
    s_lshl_b32 s51, s26, 1
    s_add_u32 s50, s50, s51
    s_mul_i32 s50, s50, 125
    s_and_b32 s51, s20, 1
    s_cmp_ge_u32 s24, 125
    s_cselect_b32 s46, 375, 0
    s_add_u32 s46, s46, s24
    s_add_u32 s52, s46, s50
    s_cmp_ge_u32 s25, 125
    s_cselect_b32 s46, 375, 0
    s_add_u32 s46, s46, s25
    s_add_u32 s53, s46, s50
    s_cmp_eq_u32 s51, 0
    s_cselect_b32 s62, s52, s53
    s_lshl_b32 s62, s62, 7
    s_add_u32 s62, s62, 45088768
    s_lshl_b32 s51, s51, 11
    s_lshl_b32 s46, s24, 14
    s_lshl_b32 s47, s20, 12
    s_add_u32 s48, s46, s47
    s_add_u32 s46, s48, 16777216
    v_add_u32 v237, s46, v1
    v_add_u32 v251, s48, v1
    v_xor_b32 v243, 16384, v251
    s_getreg_b32 s47, hwreg(HW_REG_XCC_ID, 0, 4)
    s_add_u32 s47, s47, 16
    v_mov_b32 v247, 0
    s_waitcnt lgkmcnt(0)
    s_add_u32 s16, s4, s32
    s_addc_u32 s17, s5, 0
    global_load_lds_dwordx4 v2, s[16:17] offset:0
    global_load_lds_dwordx4 v3, s[16:17] offset:1024
    global_load_lds_dwordx4 v4, s[16:17] offset:2048
    global_load_lds_dwordx4 v5, s[16:17] offset:3072
    s_add_u32 m0, m0, 4096
    s_add_u32 s18, s4, s33
    s_addc_u32 s19, s5, 0
    global_load_lds_dwordx4 v2, s[18:19] offset:0
    global_load_lds_dwordx4 v3, s[18:19] offset:1024
    global_load_lds_dwordx4 v4, s[18:19] offset:2048
    global_load_lds_dwordx4 v5, s[18:19] offset:3072
    global_load_dword v244, v240, s[14:15] offset:128 sc1
    v_lshlrev_b32 v248, 3, v1
    s_lshl_b32 s46, s45, 9
    v_add_u32 v249, s46, v248
    v_min_u32 v248, 256, v248
    s_mul_i32 s46, s45, 384
    v_add_u32 v248, s46, v248
    s_mov_b64 exec, 15
    global_load_dword v13, v249, s[6:7]
    global_load_dword v14, v249, s[8:9]
    global_load_dword v15, v248, s[10:11]
    s_mov_b64 exec, -1
    s_getpc_b64 s[36:37]
    v_lshlrev_b32 v248, 3, v1
    s_lshr_b32 s46, s35, 12
    s_mul_i32 s46, s46, 384
    v_add_u32 v248, s46, v248
    s_mov_b64 exec, 7
    global_load_dword v13, v248, s[36:37]
    s_mov_b64 exec, -1
    v_bfe_u32 v196, v0, 2, 2
    v_bfe_u32 v197, v0, 5, 1
    v_lshl_add_u32 v197, v197, 2, v196
    v_lshlrev_b32 v197, 7, v197
    v_lshrrev_b32 v196, 1, v196
    v_lshl_add_u32 v197, v196, 6, v197
    v_bfe_u32 v196, v0, 4, 1
    v_lshl_add_u32 v197, v196, 5, v197
    v_and_b32 v196, 3, v0
    v_lshl_add_u32 v197, v196, 3, v197
    v_add_u32 v6, s21, v197
    v_xor_b32 v7, 64, v6
    v_lshlrev_b32 v236, 3, v236
    v_add_u32 v9, 147456, v236
    s_lshl_b32 s33, s20, 8
    v_add_u32 v8, s33, v9
    s_lshl_b32 s33, s20, 13
    v_add_u32 v10, s33, v1
    s_lshl_b32 s33, s20, 12
    v_add_u32 v236, s33, v1
    v_bfe_u32 v254, v0, 2, 2
    v_bfe_u32 v255, v0, 5, 1
    v_lshl_add_u32 v254, v255, 2, v254
    v_lshlrev_b32 v254, 6, v254
    v_bfe_u32 v255, v0, 4, 1
    v_lshl_add_u32 v254, v255, 5, v254
    v_and_b32 v255, 3, v0
    v_lshl_add_u32 v254, v255, 3, v254
    v_add_u32 v254, s21, v254
    v_and_b32 v157, 31, v0
    v_bfe_u32 v156, v0, 1, 3
    v_lshlrev_b32 v156, 4, v156
    v_lshl_add_u32 v156, v157, 7, v156
    v_bfe_u32 v157, v0, 5, 1
    v_lshl_add_u32 v156, v157, 3, v156
    v_add_u32 v156, s21, v156
    v_xor_b32 v157, 16, v156
    v_xor_b32 v158, 32, v156
    v_xor_b32 v159, 48, v156
    v_xor_b32 v160, 64, v156
    v_xor_b32 v161, 80, v156
    v_xor_b32 v162, 96, v156
    v_xor_b32 v163, 112, v156
    s_waitcnt vmcnt(9)
    ds_read_b64 v[180:181], v156 offset:0
    ds_read_b64 v[182:183], v157 offset:0
    ds_read_b64 v[184:185], v158 offset:0
    ds_read_b64 v[186:187], v159 offset:0
    ds_read_b64 v[188:189], v160 offset:0
    ds_read_b64 v[190:191], v161 offset:0
    ds_read_b64 v[192:193], v162 offset:0
    ds_read_b64 v[194:195], v163 offset:0
    s_waitcnt lgkmcnt(0)
    v_lshlrev_b32 v16, 16, v180
    v_and_b32 v17, 0xffff0000, v180
    v_lshlrev_b32 v18, 16, v181
    v_and_b32 v19, 0xffff0000, v181
    v_lshlrev_b32 v20, 16, v182
    v_and_b32 v21, 0xffff0000, v182
    v_lshlrev_b32 v22, 16, v183
    v_and_b32 v23, 0xffff0000, v183
    v_lshlrev_b32 v24, 16, v184
    v_and_b32 v25, 0xffff0000, v184
    v_lshlrev_b32 v26, 16, v185
    v_and_b32 v27, 0xffff0000, v185
    v_lshlrev_b32 v28, 16, v186
    v_and_b32 v29, 0xffff0000, v186
    v_lshlrev_b32 v30, 16, v187
    v_and_b32 v31, 0xffff0000, v187
    v_lshlrev_b32 v32, 16, v188
    v_and_b32 v33, 0xffff0000, v188
    v_lshlrev_b32 v34, 16, v189
    v_and_b32 v35, 0xffff0000, v189
    v_lshlrev_b32 v36, 16, v190
    v_and_b32 v37, 0xffff0000, v190
    v_lshlrev_b32 v38, 16, v191
    v_and_b32 v39, 0xffff0000, v191
    v_lshlrev_b32 v40, 16, v192
    v_and_b32 v41, 0xffff0000, v192
    v_lshlrev_b32 v42, 16, v193
    v_and_b32 v43, 0xffff0000, v193
    v_lshlrev_b32 v44, 16, v194
    v_and_b32 v45, 0xffff0000, v194
    v_lshlrev_b32 v46, 16, v195
    v_and_b32 v47, 0xffff0000, v195
    v_pk_add_f32 v[196:197], v[16:17], v[18:19]
    v_pk_mul_f32 v[198:199], v[16:17], v[16:17]
    v_pk_fma_f32 v[198:199], v[18:19], v[18:19], v[198:199]
    v_pk_add_f32 v[196:197], v[196:197], v[20:21]
    v_pk_fma_f32 v[198:199], v[20:21], v[20:21], v[198:199]
    v_pk_add_f32 v[196:197], v[196:197], v[22:23]
    v_pk_fma_f32 v[198:199], v[22:23], v[22:23], v[198:199]
    v_pk_add_f32 v[196:197], v[196:197], v[24:25]
    v_pk_fma_f32 v[198:199], v[24:25], v[24:25], v[198:199]
    v_pk_add_f32 v[196:197], v[196:197], v[26:27]
    v_pk_fma_f32 v[198:199], v[26:27], v[26:27], v[198:199]
    v_pk_add_f32 v[196:197], v[196:197], v[28:29]
    v_pk_fma_f32 v[198:199], v[28:29], v[28:29], v[198:199]
    v_pk_add_f32 v[196:197], v[196:197], v[30:31]
    v_pk_fma_f32 v[198:199], v[30:31], v[30:31], v[198:199]
    v_pk_add_f32 v[196:197], v[196:197], v[32:33]
    v_pk_fma_f32 v[198:199], v[32:33], v[32:33], v[198:199]
    v_pk_add_f32 v[196:197], v[196:197], v[34:35]
    v_pk_fma_f32 v[198:199], v[34:35], v[34:35], v[198:199]
    v_pk_add_f32 v[196:197], v[196:197], v[36:37]
    v_pk_fma_f32 v[198:199], v[36:37], v[36:37], v[198:199]
    v_pk_add_f32 v[196:197], v[196:197], v[38:39]
    v_pk_fma_f32 v[198:199], v[38:39], v[38:39], v[198:199]
    v_pk_add_f32 v[196:197], v[196:197], v[40:41]
    v_pk_fma_f32 v[198:199], v[40:41], v[40:41], v[198:199]
    v_pk_add_f32 v[196:197], v[196:197], v[42:43]
    v_pk_fma_f32 v[198:199], v[42:43], v[42:43], v[198:199]
    v_pk_add_f32 v[196:197], v[196:197], v[44:45]
    v_pk_fma_f32 v[198:199], v[44:45], v[44:45], v[198:199]
    v_pk_add_f32 v[196:197], v[196:197], v[46:47]
    v_pk_fma_f32 v[198:199], v[46:47], v[46:47], v[198:199]
    v_add_f32 v196, v196, v197
    v_add_f32 v197, v198, v199
    v_mov_b32 v198, v196
    v_mov_b32 v199, v197
    s_nop 1
    v_permlane32_swap_b32 v196, v198
    v_permlane32_swap_b32 v197, v199
    v_pk_add_f32 v[196:197], v[196:197], v[198:199]
    ds_write_b64 v8, v[196:197] offset:0
    s_waitcnt vmcnt(5)
    ds_read_b64 v[80:81], v156 offset:4096
    ds_read_b64 v[82:83], v157 offset:4096
    ds_read_b64 v[84:85], v158 offset:4096
    ds_read_b64 v[86:87], v159 offset:4096
    ds_read_b64 v[88:89], v160 offset:4096
    ds_read_b64 v[90:91], v161 offset:4096
    ds_read_b64 v[92:93], v162 offset:4096
    ds_read_b64 v[94:95], v163 offset:4096
    s_waitcnt vmcnt(4)
    v_and_b32 v244, -16, v244
    v_add_u32 v244, s47, v244
    global_store_dword v241, v244, s[14:15] sc1
    v_readfirstlane_b32 s27, v244
    s_waitcnt lgkmcnt(0)
    v_lshlrev_b32 v48, 16, v80
    s_add_u32 m0, s21, 0
    s_lshl_b32 s34, s26, 10
    s_lshl_b32 s35, s20, 7
    s_add_u32 s34, s34, s35
    s_add_u32 s22, s6, s34
    s_addc_u32 s23, s7, 0
    v_lshl_add_u32 v2, v11, 11, v12
    v_add_u32 v3, 15360, v2
    v_add_u32 v4, 30720, v2
    v_add_u32 v5, 46080, v2
    global_load_lds_dwordx4 v2, s[22:23] offset:0
    v_and_b32 v49, 0xffff0000, v80
    v_lshlrev_b32 v50, 16, v81
    global_load_lds_dwordx4 v3, s[22:23] offset:1024
    v_and_b32 v51, 0xffff0000, v81
    v_lshlrev_b32 v52, 16, v82
    v_and_b32 v53, 0xffff0000, v82
    v_lshlrev_b32 v54, 16, v83
    v_and_b32 v55, 0xffff0000, v83
    v_lshlrev_b32 v56, 16, v84
    v_and_b32 v57, 0xffff0000, v84
    v_lshlrev_b32 v58, 16, v85
    global_load_lds_dwordx4 v4, s[22:23] offset:2048
    v_and_b32 v59, 0xffff0000, v85
    v_lshlrev_b32 v60, 16, v86
    v_and_b32 v61, 0xffff0000, v86
    v_lshlrev_b32 v62, 16, v87
    v_and_b32 v63, 0xffff0000, v87
    v_lshlrev_b32 v64, 16, v88
    v_and_b32 v65, 0xffff0000, v88
    v_lshlrev_b32 v66, 16, v89
    global_load_lds_dwordx4 v5, s[22:23] offset:3072
    v_and_b32 v67, 0xffff0000, v89
    v_lshlrev_b32 v68, 16, v90
    v_and_b32 v69, 0xffff0000, v90
    v_lshlrev_b32 v70, 16, v91
    v_and_b32 v71, 0xffff0000, v91
    v_lshlrev_b32 v72, 16, v92
    v_and_b32 v73, 0xffff0000, v92
    s_add_u32 m0, s21, 4096
    s_add_u32 s22, s22, 65536
    s_addc_u32 s23, s23, 0
    global_load_lds_dwordx4 v2, s[22:23] offset:0
    v_lshlrev_b32 v74, 16, v93
    v_and_b32 v75, 0xffff0000, v93
    v_lshlrev_b32 v76, 16, v94
    v_and_b32 v77, 0xffff0000, v94
    v_lshlrev_b32 v78, 16, v95
    global_load_lds_dwordx4 v3, s[22:23] offset:1024
    v_and_b32 v79, 0xffff0000, v95
    v_pk_add_f32 v[196:197], v[48:49], v[50:51]
    v_pk_mul_f32 v[198:199], v[48:49], v[48:49]
    v_pk_fma_f32 v[198:199], v[50:51], v[50:51], v[198:199]
    v_pk_add_f32 v[196:197], v[196:197], v[52:53]
    v_pk_fma_f32 v[198:199], v[52:53], v[52:53], v[198:199]
    v_pk_add_f32 v[196:197], v[196:197], v[54:55]
    v_pk_fma_f32 v[198:199], v[54:55], v[54:55], v[198:199]
    global_load_lds_dwordx4 v4, s[22:23] offset:2048
    v_pk_add_f32 v[196:197], v[196:197], v[56:57]
    v_pk_fma_f32 v[198:199], v[56:57], v[56:57], v[198:199]
    v_pk_add_f32 v[196:197], v[196:197], v[58:59]
    v_pk_fma_f32 v[198:199], v[58:59], v[58:59], v[198:199]
    v_pk_add_f32 v[196:197], v[196:197], v[60:61]
    v_pk_fma_f32 v[198:199], v[60:61], v[60:61], v[198:199]
    v_pk_add_f32 v[196:197], v[196:197], v[62:63]
    v_pk_fma_f32 v[198:199], v[62:63], v[62:63], v[198:199]
    global_load_lds_dwordx4 v5, s[22:23] offset:3072
    v_pk_add_f32 v[196:197], v[196:197], v[64:65]
    v_pk_fma_f32 v[198:199], v[64:65], v[64:65], v[198:199]
    v_pk_add_f32 v[196:197], v[196:197], v[66:67]
    v_pk_fma_f32 v[198:199], v[66:67], v[66:67], v[198:199]
    v_pk_add_f32 v[196:197], v[196:197], v[68:69]
    v_pk_fma_f32 v[198:199], v[68:69], v[68:69], v[198:199]
    v_pk_add_f32 v[196:197], v[196:197], v[70:71]
    v_pk_fma_f32 v[198:199], v[70:71], v[70:71], v[198:199]
    s_add_u32 m0, s21, 8192
    s_add_u32 s22, s22, 65536
    s_addc_u32 s23, s23, 0
    global_load_lds_dwordx4 v2, s[22:23] offset:0
    v_pk_add_f32 v[196:197], v[196:197], v[72:73]
    v_pk_fma_f32 v[198:199], v[72:73], v[72:73], v[198:199]
    v_pk_add_f32 v[196:197], v[196:197], v[74:75]
    v_pk_fma_f32 v[198:199], v[74:75], v[74:75], v[198:199]
    v_pk_add_f32 v[196:197], v[196:197], v[76:77]
    global_load_lds_dwordx4 v3, s[22:23] offset:1024
    v_pk_fma_f32 v[198:199], v[76:77], v[76:77], v[198:199]
    v_pk_add_f32 v[196:197], v[196:197], v[78:79]
    v_pk_fma_f32 v[198:199], v[78:79], v[78:79], v[198:199]
    v_add_f32 v196, v196, v197
    v_add_f32 v197, v198, v199
    v_mov_b32 v198, v196
    v_mov_b32 v199, v197
    s_nop 1
    global_load_lds_dwordx4 v4, s[22:23] offset:2048
    v_permlane32_swap_b32 v196, v198
    v_permlane32_swap_b32 v197, v199
    v_pk_add_f32 v[196:197], v[196:197], v[198:199]
    ds_write_b64 v8, v[196:197] offset:1024
    s_waitcnt lgkmcnt(0)
    s_barrier
    ds_read_b64 v[196:197], v9 offset:0
    ds_read_b64 v[198:199], v9 offset:256
    ds_read_b64 v[200:201], v9 offset:512
    ds_read_b64 v[202:203], v9 offset:768
    ds_read_b64 v[204:205], v9 offset:1024
    ds_read_b64 v[206:207], v9 offset:1280
    ds_read_b64 v[208:209], v9 offset:1536
    ds_read_b64 v[210:211], v9 offset:1792
    s_waitcnt lgkmcnt(4)
    v_pk_add_f32 v[196:197], v[196:197], v[198:199]
    global_load_lds_dwordx4 v5, s[22:23] offset:3072
    v_pk_add_f32 v[200:201], v[200:201], v[202:203]
    v_pk_add_f32 v[196:197], v[196:197], v[200:201]
    s_add_u32 m0, s21, 12288
    s_add_u32 s22, s22, 65536
    s_addc_u32 s23, s23, 0
    global_load_lds_dwordx4 v2, s[22:23] offset:0
    v_mul_f32 v198, 0x3b800000, v196
    v_mul_f32 v197, 0x3b800000, v197
    v_fma_f32 v197, -v198, v198, v197
    v_max_f32 v197, 0, v197
    v_add_f32 v197, 0x3727c5ac, v197
    global_load_lds_dwordx4 v3, s[22:23] offset:1024
    v_rsq_f32 v196, v197
    s_nop 0
    v_mul_f32 v196, 0x3fb8aa3b, v196
    v_mul_f32_e64 v198, -v198, v196
    v_pk_fma_f32 v[16:17], v[16:17], v[196:197], v[198:199] op_sel_hi:[1,0,0]
    v_pk_fma_f32 v[18:19], v[18:19], v[196:197], v[198:199] op_sel_hi:[1,0,0]
    global_load_lds_dwordx4 v4, s[22:23] offset:2048
    v_pk_fma_f32 v[20:21], v[20:21], v[196:197], v[198:199] op_sel_hi:[1,0,0]
    v_pk_fma_f32 v[22:23], v[22:23], v[196:197], v[198:199] op_sel_hi:[1,0,0]
    global_load_lds_dwordx4 v5, s[22:23] offset:3072
    v_pk_fma_f32 v[24:25], v[24:25], v[196:197], v[198:199] op_sel_hi:[1,0,0]
    v_pk_fma_f32 v[26:27], v[26:27], v[196:197], v[198:199] op_sel_hi:[1,0,0]
    v_pk_fma_f32 v[28:29], v[28:29], v[196:197], v[198:199] op_sel_hi:[1,0,0]
    v_pk_fma_f32 v[30:31], v[30:31], v[196:197], v[198:199] op_sel_hi:[1,0,0]
    s_waitcnt vmcnt(12)
    ds_read_b64_tr_b16 a[128:129], v6 offset:0
    ds_read_b64_tr_b16 a[130:131], v6 offset:1024
    v_pk_fma_f32 v[32:33], v[32:33], v[196:197], v[198:199] op_sel_hi:[1,0,0]
    ds_read_b64_tr_b16 a[132:133], v7 offset:0
    ds_read_b64_tr_b16 a[134:135], v7 offset:1024
    v_pk_fma_f32 v[34:35], v[34:35], v[196:197], v[198:199] op_sel_hi:[1,0,0]
    ds_read_b64_tr_b16 a[136:137], v6 offset:2048
    ds_read_b64_tr_b16 a[138:139], v6 offset:3072
    v_pk_fma_f32 v[36:37], v[36:37], v[196:197], v[198:199] op_sel_hi:[1,0,0]
    ds_read_b64_tr_b16 a[140:141], v7 offset:2048
    ds_read_b64_tr_b16 a[142:143], v7 offset:3072
    s_add_u32 m0, s21, 16384
    s_add_u32 s22, s22, 65536
    s_addc_u32 s23, s23, 0
    global_load_lds_dwordx4 v2, s[22:23] offset:0
    v_pk_fma_f32 v[38:39], v[38:39], v[196:197], v[198:199] op_sel_hi:[1,0,0]
    global_load_lds_dwordx4 v3, s[22:23] offset:1024
    v_pk_fma_f32 v[40:41], v[40:41], v[196:197], v[198:199] op_sel_hi:[1,0,0]
    v_pk_fma_f32 v[42:43], v[42:43], v[196:197], v[198:199] op_sel_hi:[1,0,0]
    v_pk_fma_f32 v[44:45], v[44:45], v[196:197], v[198:199] op_sel_hi:[1,0,0]
    v_pk_fma_f32 v[46:47], v[46:47], v[196:197], v[198:199] op_sel_hi:[1,0,0]
    v_cvt_pk_bf16_f32 v80, v16, v17
    v_cvt_pk_bf16_f32 v81, v18, v19
    v_cvt_pk_bf16_f32 v82, v20, v21
    v_cvt_pk_bf16_f32 v83, v22, v23
    global_load_lds_dwordx4 v4, s[22:23] offset:2048
    ds_write_b128 v236, v[80:83] offset:32768
    v_cvt_pk_bf16_f32 v84, v24, v25
    v_cvt_pk_bf16_f32 v85, v26, v27
    v_cvt_pk_bf16_f32 v86, v28, v29
    v_cvt_pk_bf16_f32 v87, v30, v31
    ds_write_b128 v236, v[84:87] offset:33792
    v_cvt_pk_bf16_f32 v88, v32, v33
    v_cvt_pk_bf16_f32 v89, v34, v35
    global_load_lds_dwordx4 v5, s[22:23] offset:3072
    v_cvt_pk_bf16_f32 v90, v36, v37
    v_cvt_pk_bf16_f32 v91, v38, v39
    ds_write_b128 v236, v[88:91] offset:34816
    v_cvt_pk_bf16_f32 v92, v40, v41
    v_cvt_pk_bf16_f32 v93, v42, v43
    v_cvt_pk_bf16_f32 v94, v44, v45
    v_cvt_pk_bf16_f32 v95, v46, v47
    ds_write_b128 v236, v[92:95] offset:35840
    s_waitcnt lgkmcnt(4)
    s_add_u32 m0, s21, 0
    s_add_u32 s22, s22, 65536
    s_addc_u32 s23, s23, 0
    global_load_lds_dwordx4 v2, s[22:23] offset:0
    v_pk_add_f32 v[204:205], v[204:205], v[206:207]
    v_pk_add_f32 v[208:209], v[208:209], v[210:211]
    v_pk_add_f32 v[204:205], v[204:205], v[208:209]
    v_mul_f32 v206, 0x3b800000, v204
    v_mul_f32 v205, 0x3b800000, v205
    v_fma_f32 v205, -v206, v206, v205
    s_waitcnt vmcnt(13)
    ds_read_b64_tr_b16 a[144:145], v6 offset:4096
    ds_read_b64_tr_b16 a[146:147], v6 offset:5120
    v_max_f32 v205, 0, v205
    ds_read_b64_tr_b16 a[148:149], v7 offset:4096
    ds_read_b64_tr_b16 a[150:151], v7 offset:5120
    v_add_f32 v205, 0x3727c5ac, v205
    global_load_lds_dwordx4 v3, s[22:23] offset:1024
    ds_read_b64_tr_b16 a[152:153], v6 offset:6144
    ds_read_b64_tr_b16 a[154:155], v6 offset:7168
    v_rsq_f32 v204, v205
    ds_read_b64_tr_b16 a[156:157], v7 offset:6144
    ds_read_b64_tr_b16 a[158:159], v7 offset:7168
    s_nop 0
    v_mul_f32 v204, 0x3fb8aa3b, v204
    v_mul_f32_e64 v206, -v206, v204
    v_pk_fma_f32 v[48:49], v[48:49], v[204:205], v[206:207] op_sel_hi:[1,0,0]
    v_pk_fma_f32 v[50:51], v[50:51], v[204:205], v[206:207] op_sel_hi:[1,0,0]
    v_pk_fma_f32 v[52:53], v[52:53], v[204:205], v[206:207] op_sel_hi:[1,0,0]
    v_pk_fma_f32 v[54:55], v[54:55], v[204:205], v[206:207] op_sel_hi:[1,0,0]
    global_load_lds_dwordx4 v4, s[22:23] offset:2048
    v_pk_fma_f32 v[56:57], v[56:57], v[204:205], v[206:207] op_sel_hi:[1,0,0]
    v_pk_fma_f32 v[58:59], v[58:59], v[204:205], v[206:207] op_sel_hi:[1,0,0]
    v_pk_fma_f32 v[60:61], v[60:61], v[204:205], v[206:207] op_sel_hi:[1,0,0]
    v_pk_fma_f32 v[62:63], v[62:63], v[204:205], v[206:207] op_sel_hi:[1,0,0]
    v_pk_fma_f32 v[64:65], v[64:65], v[204:205], v[206:207] op_sel_hi:[1,0,0]
    v_pk_fma_f32 v[66:67], v[66:67], v[204:205], v[206:207] op_sel_hi:[1,0,0]
    v_pk_fma_f32 v[68:69], v[68:69], v[204:205], v[206:207] op_sel_hi:[1,0,0]
    v_pk_fma_f32 v[70:71], v[70:71], v[204:205], v[206:207] op_sel_hi:[1,0,0]
    global_load_lds_dwordx4 v5, s[22:23] offset:3072
    v_pk_fma_f32 v[72:73], v[72:73], v[204:205], v[206:207] op_sel_hi:[1,0,0]
    v_pk_fma_f32 v[74:75], v[74:75], v[204:205], v[206:207] op_sel_hi:[1,0,0]
    v_pk_fma_f32 v[76:77], v[76:77], v[204:205], v[206:207] op_sel_hi:[1,0,0]
    v_pk_fma_f32 v[78:79], v[78:79], v[204:205], v[206:207] op_sel_hi:[1,0,0]
    s_waitcnt vmcnt(12)
    ds_read_b64_tr_b16 a[160:161], v6 offset:8192
    ds_read_b64_tr_b16 a[162:163], v6 offset:9216
    v_cvt_pk_bf16_f32 v96, v48, v49
    ds_read_b64_tr_b16 a[164:165], v7 offset:8192
    ds_read_b64_tr_b16 a[166:167], v7 offset:9216
    v_cvt_pk_bf16_f32 v97, v50, v51
    ds_read_b64_tr_b16 a[168:169], v6 offset:10240
    ds_read_b64_tr_b16 a[170:171], v6 offset:11264
    v_cvt_pk_bf16_f32 v98, v52, v53
    ds_read_b64_tr_b16 a[172:173], v7 offset:10240
    ds_read_b64_tr_b16 a[174:175], v7 offset:11264
    v_cvt_pk_bf16_f32 v99, v54, v55
    s_waitcnt lgkmcnt(8)
    s_add_u32 m0, s21, 4096
    s_add_u32 s22, s22, 65536
    s_addc_u32 s23, s23, 0
    global_load_lds_dwordx4 v2, s[22:23] offset:0
    ds_write_b128 v236, v[96:99] offset:49152
    v_cvt_pk_bf16_f32 v100, v56, v57
    v_cvt_pk_bf16_f32 v101, v58, v59
    v_cvt_pk_bf16_f32 v102, v60, v61
    v_cvt_pk_bf16_f32 v103, v62, v63
    ds_write_b128 v236, v[100:103] offset:50176
    v_cvt_pk_bf16_f32 v104, v64, v65
    v_cvt_pk_bf16_f32 v105, v66, v67
    global_load_lds_dwordx4 v3, s[22:23] offset:1024
    v_cvt_pk_bf16_f32 v106, v68, v69
    v_cvt_pk_bf16_f32 v107, v70, v71
    ds_write_b128 v236, v[104:107] offset:51200
    v_cvt_pk_bf16_f32 v108, v72, v73
    v_cvt_pk_bf16_f32 v109, v74, v75
    v_cvt_pk_bf16_f32 v110, v76, v77
    v_cvt_pk_bf16_f32 v111, v78, v79
    ds_write_b128 v236, v[108:111] offset:52224
    global_load_lds_dwordx4 v4, s[22:23] offset:2048
    s_waitcnt lgkmcnt(0)
    s_barrier
    ds_read_b128 a[0:3], v1 offset:32768
    ds_read_b128 a[4:7], v1 offset:33792
    ds_read_b128 a[8:11], v1 offset:34816
    ds_read_b128 a[12:15], v1 offset:35840
    s_mov_b32 s31, 0x4038aa3b
    s_waitcnt lgkmcnt(3)
    v_mfma_f32_32x32x16_bf16 v[16:31], a[128:131], a[0:3], 0
    ds_read_b128 a[16:19], v1 offset:36864
    s_waitcnt vmcnt(11)
    ds_read_b64_tr_b16 a[176:177], v6 offset:12288
    ds_read_b64_tr_b16 a[178:179], v6 offset:13312
    global_load_lds_dwordx4 v5, s[22:23] offset:3072
    v_mfma_f32_32x32x16_bf16 v[32:47], a[132:135], a[0:3], 0
    ds_read_b128 a[20:23], v1 offset:37888
    ds_read_b64_tr_b16 a[180:181], v7 offset:12288
    ds_read_b64_tr_b16 a[182:183], v7 offset:13312
    s_add_u32 m0, s21, 8192
    s_add_u32 s22, s22, 65536
    s_addc_u32 s23, s23, 0
    global_load_lds_dwordx4 v2, s[22:23] offset:0
    s_waitcnt lgkmcnt(8)
    v_mfma_f32_32x32x16_bf16 v[16:31], a[136:139], a[4:7], v[16:31]
    ds_read_b128 a[24:27], v1 offset:38912
    ds_read_b64_tr_b16 a[184:185], v6 offset:14336
    ds_read_b64_tr_b16 a[186:187], v6 offset:15360
    v_mfma_f32_32x32x16_bf16 v[32:47], a[140:143], a[4:7], v[32:47]
    ds_read_b128 a[28:31], v1 offset:39936
    ds_read_b64_tr_b16 a[188:189], v7 offset:14336
    ds_read_b64_tr_b16 a[190:191], v7 offset:15360
    global_load_lds_dwordx4 v3, s[22:23] offset:1024
    v_lshlrev_b32 v204, 16, v180
    v_and_b32 v205, 0xffff0000, v180
    v_mul_f32 v204, s31, v204
    s_waitcnt lgkmcnt(13)
    v_mfma_f32_32x32x16_bf16 v[16:31], a[144:147], a[8:11], v[16:31]
    ds_read_b128 a[32:35], v1 offset:40960
    s_waitcnt vmcnt(10)
    ds_read_b64_tr_b16 a[192:193], v6 offset:16384
    ds_read_b64_tr_b16 a[194:195], v6 offset:17408
    v_mul_f32 v205, s31, v205
    v_lshlrev_b32 v206, 16, v181
    v_and_b32 v207, 0xffff0000, v181
    v_mfma_f32_32x32x16_bf16 v[32:47], a[148:151], a[8:11], v[32:47]
    ds_read_b128 a[36:39], v1 offset:41984
    ds_read_b64_tr_b16 a[196:197], v7 offset:16384
    ds_read_b64_tr_b16 a[198:199], v7 offset:17408
    global_load_lds_dwordx4 v4, s[22:23] offset:2048
    v_mul_f32 v206, s31, v206
    v_mul_f32 v207, s31, v207
    v_lshlrev_b32 v208, 16, v182
    s_waitcnt lgkmcnt(15)
    v_mfma_f32_32x32x16_bf16 v[16:31], a[152:155], a[12:15], v[16:31]
    ds_read_b128 a[40:43], v1 offset:43008
    ds_read_b64_tr_b16 a[200:201], v6 offset:18432
    ds_read_b64_tr_b16 a[202:203], v6 offset:19456
    v_and_b32 v209, 0xffff0000, v182
    v_mul_f32 v208, s31, v208
    v_mul_f32 v209, s31, v209
    v_mfma_f32_32x32x16_bf16 v[32:47], a[156:159], a[12:15], v[32:47]
    ds_read_b128 a[44:47], v1 offset:44032
    ds_read_b64_tr_b16 a[204:205], v7 offset:18432
    ds_read_b64_tr_b16 a[206:207], v7 offset:19456
    global_load_lds_dwordx4 v5, s[22:23] offset:3072
    v_lshlrev_b32 v210, 16, v183
    v_and_b32 v211, 0xffff0000, v183
    v_mul_f32 v210, s31, v210
    s_waitcnt lgkmcnt(15)
    v_mfma_f32_32x32x16_bf16 v[16:31], a[160:163], a[16:19], v[16:31]
    ds_read_b128 a[48:51], v1 offset:45056
    v_mul_f32 v211, s31, v211
    v_lshlrev_b32 v212, 16, v184
    v_and_b32 v213, 0xffff0000, v184
    v_mfma_f32_32x32x16_bf16 v[32:47], a[164:167], a[16:19], v[32:47]
    ds_read_b128 a[52:55], v1 offset:46080
    s_waitcnt lgkmcnt(14)
    s_add_u32 m0, s21, 12288
    s_sub_u32 s22, s22, 458240
    s_subb_u32 s23, s23, 0
    global_load_lds_dwordx4 v2, s[22:23] offset:0
    v_mul_f32 v212, s31, v212
    v_mul_f32 v213, s31, v213
    v_lshlrev_b32 v214, 16, v185
    v_mfma_f32_32x32x16_bf16 v[16:31], a[168:171], a[20:23], v[16:31]
    ds_read_b128 a[56:59], v1 offset:47104
    s_waitcnt vmcnt(9)
    ds_read_b64_tr_b16 a[208:209], v6 offset:0
    ds_read_b64_tr_b16 a[210:211], v6 offset:1024
    v_and_b32 v215, 0xffff0000, v185
    v_mul_f32 v214, s31, v214
    v_mul_f32 v215, s31, v215
    v_mfma_f32_32x32x16_bf16 v[32:47], a[172:175], a[20:23], v[32:47]
    ds_read_b128 a[60:63], v1 offset:48128
    ds_read_b64_tr_b16 a[212:213], v7 offset:0
    ds_read_b64_tr_b16 a[214:215], v7 offset:1024
    global_load_lds_dwordx4 v3, s[22:23] offset:1024
    v_lshlrev_b32 v216, 16, v186
    v_and_b32 v217, 0xffff0000, v186
    v_mul_f32 v216, s31, v216
    v_mfma_f32_32x32x16_bf16 v[16:31], a[176:179], a[24:27], v[16:31]
    ds_read_b128 a[64:67], v1 offset:49152
    ds_read_b64_tr_b16 a[216:217], v6 offset:2048
    ds_read_b64_tr_b16 a[218:219], v6 offset:3072
    v_mul_f32 v217, s31, v217
    v_lshlrev_b32 v218, 16, v187
    v_and_b32 v219, 0xffff0000, v187
    v_mfma_f32_32x32x16_bf16 v[32:47], a[180:183], a[24:27], v[32:47]
    ds_read_b128 a[68:71], v1 offset:50176
    ds_read_b64_tr_b16 a[220:221], v7 offset:2048
    ds_read_b64_tr_b16 a[222:223], v7 offset:3072
    global_load_lds_dwordx4 v4, s[22:23] offset:2048
    v_mul_f32 v218, s31, v218
    v_mul_f32 v219, s31, v219
    v_lshlrev_b32 v220, 16, v188
    v_mfma_f32_32x32x16_bf16 v[16:31], a[184:187], a[28:31], v[16:31]
    ds_read_b128 a[72:75], v1 offset:51200
    v_and_b32 v221, 0xffff0000, v188
    v_mul_f32 v220, s31, v220
    v_mul_f32 v221, s31, v221
    v_mfma_f32_32x32x16_bf16 v[32:47], a[188:191], a[28:31], v[32:47]
    ds_read_b128 a[76:79], v1 offset:52224
    global_load_lds_dwordx4 v5, s[22:23] offset:3072
    v_lshlrev_b32 v222, 16, v189
    v_and_b32 v223, 0xffff0000, v189
    v_mul_f32 v222, s31, v222
    s_waitcnt lgkmcnt(15)
    s_waitcnt lgkmcnt(15)
    v_mfma_f32_32x32x16_bf16 v[16:31], a[192:195], a[32:35], v[16:31]
    ds_read_b128 a[80:83], v1 offset:53248
    s_add_u32 m0, s21, 16384
    s_add_u32 s22, s22, 65536
    s_addc_u32 s23, s23, 0
    global_load_lds_dwordx4 v2, s[22:23] offset:0
    v_mul_f32 v223, s31, v223
    v_lshlrev_b32 v224, 16, v190
    v_and_b32 v225, 0xffff0000, v190
    v_mfma_f32_32x32x16_bf16 v[32:47], a[196:199], a[32:35], v[32:47]
    ds_read_b128 a[84:87], v1 offset:54272
    global_load_lds_dwordx4 v3, s[22:23] offset:1024
    v_mul_f32 v224, s31, v224
    v_mul_f32 v225, s31, v225
    v_lshlrev_b32 v226, 16, v191
    v_mfma_f32_32x32x16_bf16 v[16:31], a[200:203], a[36:39], v[16:31]
    ds_read_b128 a[88:91], v1 offset:55296
    s_waitcnt vmcnt(10)
    ds_read_b64_tr_b16 a[224:225], v6 offset:4096
    ds_read_b64_tr_b16 a[226:227], v6 offset:5120
    global_load_lds_dwordx4 v4, s[22:23] offset:2048
    v_and_b32 v227, 0xffff0000, v191
    v_mul_f32 v226, s31, v226
    v_mul_f32 v227, s31, v227
    v_mfma_f32_32x32x16_bf16 v[32:47], a[204:207], a[36:39], v[32:47]
    ds_read_b128 a[92:95], v1 offset:56320
    ds_read_b64_tr_b16 a[228:229], v7 offset:4096
    ds_read_b64_tr_b16 a[230:231], v7 offset:5120
    global_load_lds_dwordx4 v5, s[22:23] offset:3072
    v_lshlrev_b32 v228, 16, v192
    v_and_b32 v229, 0xffff0000, v192
    v_mul_f32 v228, s31, v228
    s_waitcnt lgkmcnt(10)
    v_mfma_f32_32x32x16_bf16 v[16:31], a[208:211], a[40:43], v[16:31]
    ds_read_b128 a[96:99], v1 offset:57344
    ds_read_b64_tr_b16 a[232:233], v6 offset:6144
    ds_read_b64_tr_b16 a[234:235], v6 offset:7168
    s_add_u32 m0, s21, 0
    s_add_u32 s22, s22, 65536
    s_addc_u32 s23, s23, 0
    global_load_lds_dwordx4 v2, s[22:23] offset:0
    v_mul_f32 v229, s31, v229
    v_lshlrev_b32 v230, 16, v193
    v_and_b32 v231, 0xffff0000, v193
    v_mfma_f32_32x32x16_bf16 v[32:47], a[212:215], a[40:43], v[32:47]
    ds_read_b128 a[100:103], v1 offset:58368
    ds_read_b64_tr_b16 a[236:237], v7 offset:6144
    ds_read_b64_tr_b16 a[238:239], v7 offset:7168
    global_load_lds_dwordx4 v3, s[22:23] offset:1024
    v_mul_f32 v230, s31, v230
    v_mul_f32 v231, s31, v231
    v_lshlrev_b32 v232, 16, v194
    v_mfma_f32_32x32x16_bf16 v[16:31], a[216:219], a[44:47], v[16:31]
    ds_read_b128 a[104:107], v1 offset:59392
    s_waitcnt vmcnt(10)
    ds_read_b64_tr_b16 a[240:241], v6 offset:8192
    ds_read_b64_tr_b16 a[242:243], v6 offset:9216
    global_load_lds_dwordx4 v4, s[22:23] offset:2048
    v_and_b32 v233, 0xffff0000, v194
    v_mul_f32 v232, s31, v232
    v_mul_f32 v233, s31, v233
    v_mfma_f32_32x32x16_bf16 v[32:47], a[220:223], a[44:47], v[32:47]
    ds_read_b128 a[108:111], v1 offset:60416
    ds_read_b64_tr_b16 a[244:245], v7 offset:8192
    ds_read_b64_tr_b16 a[246:247], v7 offset:9216
    global_load_lds_dwordx4 v5, s[22:23] offset:3072
    v_lshlrev_b32 v234, 16, v195
    v_and_b32 v235, 0xffff0000, v195
    v_mul_f32 v234, s31, v234
    s_waitcnt lgkmcnt(6)
    v_mfma_f32_32x32x16_bf16 v[16:31], a[224:227], a[48:51], v[16:31]
    ds_read_b128 a[112:115], v1 offset:61440
    ds_read_b64_tr_b16 a[248:249], v6 offset:10240
    ds_read_b64_tr_b16 a[250:251], v6 offset:11264
    s_add_u32 m0, s21, 4096
    s_add_u32 s22, s22, 65536
    s_addc_u32 s23, s23, 0
    global_load_lds_dwordx4 v2, s[22:23] offset:0
    v_mul_f32 v235, s31, v235
    v_mov_b32 v252, 0x3f80
    v_mov_b32 v253, 0x3f800000
    v_mfma_f32_32x32x16_bf16 v[32:47], a[228:231], a[48:51], v[32:47]
    ds_read_b128 a[116:119], v1 offset:62464
    ds_read_b64_tr_b16 a[252:253], v7 offset:10240
    ds_read_b64_tr_b16 a[254:255], v7 offset:11264
    global_load_lds_dwordx4 v3, s[22:23] offset:1024
    v_mfma_f32_32x32x16_bf16 v[16:31], a[232:235], a[52:55], v[16:31]
    ds_read_b128 a[120:123], v1 offset:63488
    global_load_lds_dwordx4 v4, s[22:23] offset:2048
    v_mfma_f32_32x32x16_bf16 v[32:47], a[236:239], a[52:55], v[32:47]
    ds_read_b128 a[124:127], v1 offset:64512
    global_load_lds_dwordx4 v5, s[22:23] offset:3072
    s_waitcnt lgkmcnt(8)
    v_mfma_f32_32x32x16_bf16 v[16:31], a[240:243], a[56:59], v[16:31]
    s_waitcnt lgkmcnt(2)
    s_add_u32 m0, s21, 8192
    s_add_u32 s22, s22, 65536
    s_addc_u32 s23, s23, 0
    global_load_lds_dwordx4 v2, s[22:23] offset:0
    v_mfma_f32_32x32x16_bf16 v[32:47], a[244:247], a[56:59], v[32:47]
    global_load_lds_dwordx4 v3, s[22:23] offset:1024
    v_mfma_f32_32x32x16_bf16 v[16:31], a[248:251], a[60:63], v[16:31]
    global_load_lds_dwordx4 v4, s[22:23] offset:2048
    v_mfma_f32_32x32x16_bf16 v[32:47], a[252:255], a[60:63], v[32:47]
    global_load_lds_dwordx4 v5, s[22:23] offset:3072
    v_mfma_f32_32x32x16_bf16 v[48:63], a[128:131], a[64:67], 0
    s_waitcnt vmcnt(16)
    ds_read_b64_tr_b16 a[128:129], v6 offset:12288
    ds_read_b64_tr_b16 a[130:131], v6 offset:13312
    v_mfma_f32_32x32x16_bf16 v[64:79], a[132:135], a[64:67], 0
    ds_read_b64_tr_b16 a[132:133], v7 offset:12288
    ds_read_b64_tr_b16 a[134:135], v7 offset:13312
    global_load_dword v245, v240, s[14:15] sc1
    v_and_b32 v248, 31, v0
    v_lshlrev_b32 v248, 7, v248
    v_add_u32 v248, s48, v248
    s_mov_b64 exec, 0xffffffff
    global_load_dword v15, v248, s[96:97]
    s_mov_b64 exec, -1
    v_mfma_f32_32x32x16_bf16 v[48:63], a[136:139], a[68:71], v[48:63]
    ds_read_b64_tr_b16 a[136:137], v6 offset:14336
    ds_read_b64_tr_b16 a[138:139], v6 offset:15360
    v_exp_f32 v144, -v16
    v_exp_f32 v145, -v17
    v_add_f32 v144, 1.0, v144
    v_add_f32 v145, 1.0, v145
    v_rcp_f32 v144, v144
    v_rcp_f32 v145, v145
    v_mul_f32 v144, v16, v144
    v_mul_f32 v145, v17, v145
    v_cvt_pk_bf16_f32 v148, v144, v145
    v_exp_f32 v146, -v18
    v_mfma_f32_32x32x16_bf16 v[64:79], a[140:143], a[68:71], v[64:79]
    ds_read_b64_tr_b16 a[140:141], v7 offset:14336
    ds_read_b64_tr_b16 a[142:143], v7 offset:15360
    v_exp_f32 v147, -v19
    v_add_f32 v146, 1.0, v146
    v_add_f32 v147, 1.0, v147
    v_rcp_f32 v146, v146
    v_mfma_f32_32x32x16_bf16 v[48:63], a[144:147], a[72:75], v[48:63]
    v_rcp_f32 v147, v147
    v_mul_f32 v146, v18, v146
    v_mul_f32 v147, v19, v147
    v_mfma_f32_32x32x16_bf16 v[64:79], a[148:151], a[72:75], v[64:79]
    s_waitcnt vmcnt(14)
    ds_read_b64_tr_b16 a[144:145], v6 offset:16384
    ds_read_b64_tr_b16 a[146:147], v6 offset:17408
    v_cvt_pk_bf16_f32 v149, v146, v147
    v_exp_f32 v144, -v20
    v_exp_f32 v145, -v21
    v_mfma_f32_32x32x16_bf16 v[48:63], a[152:155], a[76:79], v[48:63]
    ds_read_b64_tr_b16 a[148:149], v7 offset:16384
    ds_read_b64_tr_b16 a[150:151], v7 offset:17408
    v_add_f32 v144, 1.0, v144
    v_add_f32 v145, 1.0, v145
    v_rcp_f32 v144, v144
    v_rcp_f32 v145, v145
    v_mfma_f32_32x32x16_bf16 v[64:79], a[156:159], a[76:79], v[64:79]
    ds_read_b64_tr_b16 a[152:153], v6 offset:18432
    ds_read_b64_tr_b16 a[154:155], v6 offset:19456
    v_mul_f32 v144, v20, v144
    v_mul_f32 v145, v21, v145
    v_cvt_pk_bf16_f32 v150, v144, v145
    v_mfma_f32_32x32x16_bf16 v[48:63], a[160:163], a[80:83], v[48:63]
    ds_read_b64_tr_b16 a[156:157], v7 offset:18432
    ds_read_b64_tr_b16 a[158:159], v7 offset:19456
    v_exp_f32 v146, -v22
    v_exp_f32 v147, -v23
    v_add_f32 v146, 1.0, v146
    v_mfma_f32_32x32x16_bf16 v[64:79], a[164:167], a[80:83], v[64:79]
    v_add_f32 v147, 1.0, v147
    v_rcp_f32 v146, v146
    v_rcp_f32 v147, v147
    v_mfma_f32_32x32x16_bf16 v[48:63], a[168:171], a[84:87], v[48:63]
    s_waitcnt lgkmcnt(8)
    s_add_u32 m0, s21, 12288
    s_add_u32 s22, s22, 65536
    s_addc_u32 s23, s23, 0
    global_load_lds_dwordx4 v2, s[22:23] offset:0
    v_mul_f32 v146, v22, v146
    v_mul_f32 v147, v23, v147
    v_cvt_pk_bf16_f32 v151, v146, v147
    ds_write_b128 v10, v[148:151] offset:0
    v_mfma_f32_32x32x16_bf16 v[64:79], a[172:175], a[84:87], v[64:79]
    v_exp_f32 v144, -v24
    v_exp_f32 v145, -v25
    v_add_f32 v144, 1.0, v144
    v_mfma_f32_32x32x16_bf16 v[48:63], a[176:179], a[88:91], v[48:63]
    v_add_f32 v145, 1.0, v145
    v_rcp_f32 v144, v144
    v_rcp_f32 v145, v145
    v_mfma_f32_32x32x16_bf16 v[64:79], a[180:183], a[88:91], v[64:79]
    v_mul_f32 v144, v24, v144
    v_mul_f32 v145, v25, v145
    v_cvt_pk_bf16_f32 v152, v144, v145
    v_exp_f32 v146, -v26
    v_mfma_f32_32x32x16_bf16 v[48:63], a[184:187], a[92:95], v[48:63]
    global_load_lds_dwordx4 v3, s[22:23] offset:1024
    v_exp_f32 v147, -v27
    v_add_f32 v146, 1.0, v146
    v_add_f32 v147, 1.0, v147
    v_mfma_f32_32x32x16_bf16 v[64:79], a[188:191], a[92:95], v[64:79]
    s_waitcnt vmcnt(12)
    ds_read_b64_tr_b16 a[160:161], v6 offset:0
    ds_read_b64_tr_b16 a[162:163], v6 offset:1024
    global_load_lds_dwordx4 v4, s[22:23] offset:2048
    v_rcp_f32 v146, v146
    v_rcp_f32 v147, v147
    v_mul_f32 v146, v26, v146
    v_mfma_f32_32x32x16_bf16 v[48:63], a[192:195], a[96:99], v[48:63]
    ds_read_b64_tr_b16 a[164:165], v7 offset:0
    ds_read_b64_tr_b16 a[166:167], v7 offset:1024
    v_mul_f32 v147, v27, v147
    v_cvt_pk_bf16_f32 v153, v146, v147
    v_exp_f32 v144, -v28
    v_mfma_f32_32x32x16_bf16 v[64:79], a[196:199], a[96:99], v[64:79]
    ds_read_b64_tr_b16 a[168:169], v6 offset:2048
    ds_read_b64_tr_b16 a[170:171], v6 offset:3072
    global_load_lds_dwordx4 v5, s[22:23] offset:3072
    v_exp_f32 v145, -v29
    v_add_f32 v144, 1.0, v144
    v_add_f32 v145, 1.0, v145
    v_rcp_f32 v144, v144
    v_mfma_f32_32x32x16_bf16 v[48:63], a[200:203], a[100:103], v[48:63]
    ds_read_b64_tr_b16 a[172:173], v7 offset:2048
    ds_read_b64_tr_b16 a[174:175], v7 offset:3072
    v_rcp_f32 v145, v145
    v_mul_f32 v144, v28, v144
    v_mul_f32 v145, v29, v145
    v_mfma_f32_32x32x16_bf16 v[64:79], a[204:207], a[100:103], v[64:79]
    s_waitcnt lgkmcnt(9)
    s_add_u32 m0, s21, 16384
    s_add_u32 s22, s22, 65536
    s_addc_u32 s23, s23, 0
    global_load_lds_dwordx4 v2, s[22:23] offset:0
    v_cvt_pk_bf16_f32 v154, v144, v145
    v_exp_f32 v146, -v30
    v_exp_f32 v147, -v31
    v_mfma_f32_32x32x16_bf16 v[48:63], a[208:211], a[104:107], v[48:63]
    v_add_f32 v146, 1.0, v146
    v_add_f32 v147, 1.0, v147
    v_rcp_f32 v146, v146
    v_rcp_f32 v147, v147
    v_mfma_f32_32x32x16_bf16 v[64:79], a[212:215], a[104:107], v[64:79]
    global_load_lds_dwordx4 v3, s[22:23] offset:1024
    v_mul_f32 v146, v30, v146
    v_mul_f32 v147, v31, v147
    v_cvt_pk_bf16_f32 v155, v146, v147
    v_mfma_f32_32x32x16_bf16 v[48:63], a[216:219], a[108:111], v[48:63]
    ds_write_b128 v10, v[152:155] offset:2048
    v_exp_f32 v144, -v32
    v_exp_f32 v145, -v33
    v_mfma_f32_32x32x16_bf16 v[64:79], a[220:223], a[108:111], v[64:79]
    v_add_f32 v144, 1.0, v144
    v_add_f32 v145, 1.0, v145
    v_rcp_f32 v144, v144
    v_mfma_f32_32x32x16_bf16 v[48:63], a[224:227], a[112:115], v[48:63]
    v_rcp_f32 v145, v145
    v_mul_f32 v144, v32, v144
    v_mul_f32 v145, v33, v145
    v_cvt_pk_bf16_f32 v148, v144, v145
    v_mfma_f32_32x32x16_bf16 v[64:79], a[228:231], a[112:115], v[64:79]
    s_waitcnt vmcnt(12)
    ds_read_b64_tr_b16 a[176:177], v6 offset:4096
    ds_read_b64_tr_b16 a[178:179], v6 offset:5120
    global_load_lds_dwordx4 v4, s[22:23] offset:2048
    v_exp_f32 v146, -v34
    v_exp_f32 v147, -v35
    v_add_f32 v146, 1.0, v146
    v_mfma_f32_32x32x16_bf16 v[48:63], a[232:235], a[116:119], v[48:63]
    ds_read_b64_tr_b16 a[180:181], v7 offset:4096
    ds_read_b64_tr_b16 a[182:183], v7 offset:5120
    v_add_f32 v147, 1.0, v147
    v_rcp_f32 v146, v146
    v_rcp_f32 v147, v147
    v_mfma_f32_32x32x16_bf16 v[64:79], a[236:239], a[116:119], v[64:79]
    ds_read_b64_tr_b16 a[184:185], v6 offset:6144
    ds_read_b64_tr_b16 a[186:187], v6 offset:7168
    global_load_lds_dwordx4 v5, s[22:23] offset:3072
    v_mul_f32 v146, v34, v146
    v_mul_f32 v147, v35, v147
    v_cvt_pk_bf16_f32 v149, v146, v147
    v_exp_f32 v144, -v36
    v_mfma_f32_32x32x16_bf16 v[48:63], a[240:243], a[120:123], v[48:63]
    ds_read_b64_tr_b16 a[188:189], v7 offset:6144
    ds_read_b64_tr_b16 a[190:191], v7 offset:7168
    v_exp_f32 v145, -v37
    v_add_f32 v144, 1.0, v144
    v_add_f32 v145, 1.0, v145
    v_mfma_f32_32x32x16_bf16 v[64:79], a[244:247], a[120:123], v[64:79]
    s_waitcnt lgkmcnt(9)
    s_add_u32 m0, s21, 0
    s_add_u32 s22, s22, 65536
    s_addc_u32 s23, s23, 0
    global_load_lds_dwordx4 v2, s[22:23] offset:0
    v_rcp_f32 v144, v144
    v_rcp_f32 v145, v145
    v_mul_f32 v144, v36, v144
    v_mfma_f32_32x32x16_bf16 v[48:63], a[248:251], a[124:127], v[48:63]
    v_mul_f32 v145, v37, v145
    v_cvt_pk_bf16_f32 v150, v144, v145
    v_exp_f32 v146, -v38
    v_mfma_f32_32x32x16_bf16 v[64:79], a[252:255], a[124:127], v[64:79]
    global_load_lds_dwordx4 v3, s[22:23] offset:1024
    v_exp_f32 v147, -v39
    v_add_f32 v146, 1.0, v146
    v_add_f32 v147, 1.0, v147
    v_rcp_f32 v146, v146
    v_mfma_f32_32x32x16_bf16 v[80:95], a[128:131], a[0:3], 0
    s_waitcnt vmcnt(12)
    ds_read_b64_tr_b16 a[192:193], v6 offset:8192
    ds_read_b64_tr_b16 a[194:195], v6 offset:9216
    global_load_lds_dwordx4 v4, s[22:23] offset:2048
    v_rcp_f32 v147, v147
    v_mul_f32 v146, v38, v146
    v_mul_f32 v147, v39, v147
    v_mfma_f32_32x32x16_bf16 v[112:127], a[128:131], a[64:67], 0
    ds_read_b64_tr_b16 a[196:197], v7 offset:8192
    ds_read_b64_tr_b16 a[198:199], v7 offset:9216
    v_cvt_pk_bf16_f32 v151, v146, v147
    ds_write_b128 v10, v[148:151] offset:4096
    v_exp_f32 v144, -v40
    v_mfma_f32_32x32x16_bf16 v[96:111], a[132:135], a[0:3], 0
    ds_read_b64_tr_b16 a[200:201], v6 offset:10240
    ds_read_b64_tr_b16 a[202:203], v6 offset:11264
    v_exp_f32 v145, -v41
    v_add_f32 v144, 1.0, v144
    v_add_f32 v145, 1.0, v145
    v_rcp_f32 v144, v144
    v_mfma_f32_32x32x16_bf16 v[128:143], a[132:135], a[64:67], 0
    ds_read_b64_tr_b16 a[204:205], v7 offset:10240
    ds_read_b64_tr_b16 a[206:207], v7 offset:11264
    v_rcp_f32 v145, v145
    v_mul_f32 v144, v40, v144
    v_mul_f32 v145, v41, v145
    v_mfma_f32_32x32x16_bf16 v[80:95], a[136:139], a[4:7], v[80:95]
    global_load_lds_dwordx4 v5, s[22:23] offset:3072
    v_cvt_pk_bf16_f32 v152, v144, v145
    v_exp_f32 v146, -v42
    v_exp_f32 v147, -v43
    v_mfma_f32_32x32x16_bf16 v[112:127], a[136:139], a[68:71], v[112:127]
    v_add_f32 v146, 1.0, v146
    v_add_f32 v147, 1.0, v147
    v_rcp_f32 v146, v146
    v_mfma_f32_32x32x16_bf16 v[96:111], a[140:143], a[4:7], v[96:111]
    v_rcp_f32 v147, v147
    v_mul_f32 v146, v42, v146
    v_mul_f32 v147, v43, v147
    v_cvt_pk_bf16_f32 v153, v146, v147
    v_mfma_f32_32x32x16_bf16 v[128:143], a[140:143], a[68:71], v[128:143]
    s_waitcnt lgkmcnt(9)
    s_add_u32 m0, s21, 4096
    s_lshl_b32 s34, s26, 18
    s_lshl_b32 s35, s20, 7
    s_add_u32 s34, s34, s35
    s_add_u32 s22, s8, s34
    s_addc_u32 s23, s9, 0
    v_lshl_add_u32 v2, v11, 9, v12
    v_add_u32 v3, 3072, v2
    v_add_u32 v4, 6144, v2
    v_add_u32 v5, 9216, v2
    global_load_lds_dwordx4 v2, s[22:23] offset:0
    v_exp_f32 v144, -v44
    v_exp_f32 v145, -v45
    v_add_f32 v144, 1.0, v144
    v_mfma_f32_32x32x16_bf16 v[80:95], a[144:147], a[8:11], v[80:95]
    global_load_lds_dwordx4 v3, s[22:23] offset:1024
    v_add_f32 v145, 1.0, v145
    v_rcp_f32 v144, v144
    v_rcp_f32 v145, v145
    v_mfma_f32_32x32x16_bf16 v[112:127], a[144:147], a[72:75], v[112:127]
    s_waitcnt vmcnt(10)
    ds_read_b64_tr_b16 a[208:209], v6 offset:12288
    ds_read_b64_tr_b16 a[210:211], v6 offset:13312
    v_mul_f32 v144, v44, v144
    v_mul_f32 v145, v45, v145
    v_cvt_pk_bf16_f32 v154, v144, v145
    v_exp_f32 v146, -v46
    v_mfma_f32_32x32x16_bf16 v[96:111], a[148:151], a[8:11], v[96:111]
    ds_read_b64_tr_b16 a[212:213], v7 offset:12288
    ds_read_b64_tr_b16 a[214:215], v7 offset:13312
    global_load_lds_dwordx4 v4, s[22:23] offset:2048
    v_exp_f32 v147, -v47
    v_add_f32 v146, 1.0, v146
    v_add_f32 v147, 1.0, v147
    v_mfma_f32_32x32x16_bf16 v[128:143], a[148:151], a[72:75], v[128:143]
    ds_read_b64_tr_b16 a[216:217], v6 offset:14336
    ds_read_b64_tr_b16 a[218:219], v6 offset:15360
    v_rcp_f32 v146, v146
    v_rcp_f32 v147, v147
    v_mul_f32 v146, v46, v146
    v_mfma_f32_32x32x16_bf16 v[80:95], a[152:155], a[12:15], v[80:95]
    ds_read_b64_tr_b16 a[220:221], v7 offset:14336
    ds_read_b64_tr_b16 a[222:223], v7 offset:15360
    global_load_lds_dwordx4 v5, s[22:23] offset:3072
    v_mul_f32 v147, v47, v147
    v_cvt_pk_bf16_f32 v155, v146, v147
    ds_write_b128 v10, v[152:155] offset:6144
    v_mfma_f32_32x32x16_bf16 v[112:127], a[152:155], a[76:79], v[112:127]
    v_exp_f32 v144, -v48
    v_exp_f32 v145, -v49
    v_add_f32 v144, 1.0, v144
    v_add_f32 v145, 1.0, v145
    v_mfma_f32_32x32x16_bf16 v[96:111], a[156:159], a[12:15], v[96:111]
    v_rcp_f32 v144, v144
    v_rcp_f32 v145, v145
    v_mul_f32 v144, v48, v144
    v_mfma_f32_32x32x16_bf16 v[128:143], a[156:159], a[76:79], v[128:143]
    v_mul_f32 v145, v49, v145
    v_cvt_pk_bf16_f32 v148, v144, v145
    v_exp_f32 v146, -v50
    v_mfma_f32_32x32x16_bf16 v[80:95], a[160:163], a[16:19], v[80:95]
    s_waitcnt lgkmcnt(9)
    s_add_u32 m0, s21, 8192
    s_add_u32 s22, s22, 16384
    s_addc_u32 s23, s23, 0
    global_load_lds_dwordx4 v2, s[22:23] offset:0
    v_exp_f32 v147, -v51
    v_add_f32 v146, 1.0, v146
    v_add_f32 v147, 1.0, v147
    v_rcp_f32 v146, v146
    v_mfma_f32_32x32x16_bf16 v[112:127], a[160:163], a[80:83], v[112:127]
    global_load_lds_dwordx4 v3, s[22:23] offset:1024
    v_rcp_f32 v147, v147
    v_mul_f32 v146, v50, v146
    v_mul_f32 v147, v51, v147
    v_mfma_f32_32x32x16_bf16 v[96:111], a[164:167], a[16:19], v[96:111]
    s_waitcnt vmcnt(10)
    ds_read_b64_tr_b16 a[224:225], v6 offset:16384
    ds_read_b64_tr_b16 a[226:227], v6 offset:17408
    v_cvt_pk_bf16_f32 v149, v146, v147
    v_exp_f32 v144, -v52
    v_exp_f32 v145, -v53
    v_mfma_f32_32x32x16_bf16 v[128:143], a[164:167], a[80:83], v[128:143]
    ds_read_b64_tr_b16 a[228:229], v7 offset:16384
    ds_read_b64_tr_b16 a[230:231], v7 offset:17408
    global_load_lds_dwordx4 v4, s[22:23] offset:2048
    v_add_f32 v144, 1.0, v144
    v_add_f32 v145, 1.0, v145
    v_rcp_f32 v144, v144
    v_rcp_f32 v145, v145
    v_mfma_f32_32x32x16_bf16 v[80:95], a[168:171], a[20:23], v[80:95]
    ds_read_b64_tr_b16 a[232:233], v6 offset:18432
    ds_read_b64_tr_b16 a[234:235], v6 offset:19456
    v_mul_f32 v144, v52, v144
    v_mul_f32 v145, v53, v145
    v_cvt_pk_bf16_f32 v150, v144, v145
    v_mfma_f32_32x32x16_bf16 v[112:127], a[168:171], a[84:87], v[112:127]
    ds_read_b64_tr_b16 a[236:237], v7 offset:18432
    ds_read_b64_tr_b16 a[238:239], v7 offset:19456
    global_load_lds_dwordx4 v5, s[22:23] offset:3072
    v_exp_f32 v146, -v54
    v_exp_f32 v147, -v55
    v_add_f32 v146, 1.0, v146
    v_mfma_f32_32x32x16_bf16 v[96:111], a[172:175], a[20:23], v[96:111]
    v_add_f32 v147, 1.0, v147
    v_rcp_f32 v146, v146
    v_rcp_f32 v147, v147
    v_mfma_f32_32x32x16_bf16 v[128:143], a[172:175], a[84:87], v[128:143]
    s_waitcnt lgkmcnt(9)
    s_add_u32 m0, s21, 12288
    s_add_u32 s22, s22, 16384
    s_addc_u32 s23, s23, 0
    global_load_lds_dwordx4 v2, s[22:23] offset:0
    v_mul_f32 v146, v54, v146
    v_mul_f32 v147, v55, v147
    v_cvt_pk_bf16_f32 v151, v146, v147
    ds_write_b128 v10, v[148:151] offset:1024
    v_mfma_f32_32x32x16_bf16 v[80:95], a[176:179], a[24:27], v[80:95]
    v_exp_f32 v144, -v56
    v_exp_f32 v145, -v57
    v_add_f32 v144, 1.0, v144
    v_mfma_f32_32x32x16_bf16 v[112:127], a[176:179], a[88:91], v[112:127]
    v_add_f32 v145, 1.0, v145
    v_rcp_f32 v144, v144
    v_rcp_f32 v145, v145
    v_mfma_f32_32x32x16_bf16 v[96:111], a[180:183], a[24:27], v[96:111]
    v_mul_f32 v144, v56, v144
    v_mul_f32 v145, v57, v145
    v_cvt_pk_bf16_f32 v152, v144, v145
    v_exp_f32 v146, -v58
    v_mfma_f32_32x32x16_bf16 v[128:143], a[180:183], a[88:91], v[128:143]
    global_load_lds_dwordx4 v3, s[22:23] offset:1024
    v_exp_f32 v147, -v59
    v_add_f32 v146, 1.0, v146
    v_add_f32 v147, 1.0, v147
    v_mfma_f32_32x32x16_bf16 v[80:95], a[184:187], a[28:31], v[80:95]
    s_waitcnt vmcnt(10)
    ds_read_b64_tr_b16 a[240:241], v6 offset:0
    ds_read_b64_tr_b16 a[242:243], v6 offset:1024
    v_rcp_f32 v146, v146
    v_rcp_f32 v147, v147
    v_mul_f32 v146, v58, v146
    v_mfma_f32_32x32x16_bf16 v[112:127], a[184:187], a[92:95], v[112:127]
    ds_read_b64_tr_b16 a[244:245], v7 offset:0
    ds_read_b64_tr_b16 a[246:247], v7 offset:1024
    global_load_lds_dwordx4 v4, s[22:23] offset:2048
    v_mul_f32 v147, v59, v147
    v_cvt_pk_bf16_f32 v153, v146, v147
    v_exp_f32 v144, -v60
    v_mfma_f32_32x32x16_bf16 v[96:111], a[188:191], a[28:31], v[96:111]
    ds_read_b64_tr_b16 a[248:249], v6 offset:2048
    ds_read_b64_tr_b16 a[250:251], v6 offset:3072
    v_exp_f32 v145, -v61
    v_add_f32 v144, 1.0, v144
    v_add_f32 v145, 1.0, v145
    v_rcp_f32 v144, v144
    v_mfma_f32_32x32x16_bf16 v[128:143], a[188:191], a[92:95], v[128:143]
    ds_read_b64_tr_b16 a[252:253], v7 offset:2048
    ds_read_b64_tr_b16 a[254:255], v7 offset:3072
    global_load_lds_dwordx4 v5, s[22:23] offset:3072
    v_rcp_f32 v145, v145
    v_mul_f32 v144, v60, v144
    v_mul_f32 v145, v61, v145
    v_mfma_f32_32x32x16_bf16 v[80:95], a[192:195], a[32:35], v[80:95]
    v_cvt_pk_bf16_f32 v154, v144, v145
    v_exp_f32 v146, -v62
    v_exp_f32 v147, -v63
    v_mfma_f32_32x32x16_bf16 v[112:127], a[192:195], a[96:99], v[112:127]
    s_waitcnt lgkmcnt(9)
    s_add_u32 m0, s21, 16384
    s_add_u32 s22, s22, 16384
    s_addc_u32 s23, s23, 0
    global_load_lds_dwordx4 v2, s[22:23] offset:0
    v_add_f32 v146, 1.0, v146
    v_add_f32 v147, 1.0, v147
    v_rcp_f32 v146, v146
    v_rcp_f32 v147, v147
    v_mfma_f32_32x32x16_bf16 v[96:111], a[196:199], a[32:35], v[96:111]
    global_load_lds_dwordx4 v3, s[22:23] offset:1024
    v_mul_f32 v146, v62, v146
    v_mul_f32 v147, v63, v147
    v_cvt_pk_bf16_f32 v155, v146, v147
    v_mfma_f32_32x32x16_bf16 v[128:143], a[196:199], a[96:99], v[128:143]
    s_waitcnt vmcnt(10)
    ds_read_b64_tr_b16 a[128:129], v6 offset:4096
    ds_read_b64_tr_b16 a[130:131], v6 offset:5120
    ds_write_b128 v10, v[152:155] offset:3072
    v_exp_f32 v144, -v64
    v_exp_f32 v145, -v65
    v_mfma_f32_32x32x16_bf16 v[80:95], a[200:203], a[36:39], v[80:95]
    ds_read_b64_tr_b16 a[132:133], v7 offset:4096
    ds_read_b64_tr_b16 a[134:135], v7 offset:5120
    v_add_f32 v144, 1.0, v144
    v_add_f32 v145, 1.0, v145
    v_rcp_f32 v144, v144
    v_mfma_f32_32x32x16_bf16 v[112:127], a[200:203], a[100:103], v[112:127]
    ds_read_b64_tr_b16 a[136:137], v6 offset:6144
    ds_read_b64_tr_b16 a[138:139], v6 offset:7168
    v_rcp_f32 v145, v145
    v_mul_f32 v144, v64, v144
    v_mul_f32 v145, v65, v145
    v_cvt_pk_bf16_f32 v148, v144, v145
    v_mfma_f32_32x32x16_bf16 v[96:111], a[204:207], a[36:39], v[96:111]
    ds_read_b64_tr_b16 a[140:141], v7 offset:6144
    ds_read_b64_tr_b16 a[142:143], v7 offset:7168
    global_load_lds_dwordx4 v4, s[22:23] offset:2048
    v_exp_f32 v146, -v66
    v_exp_f32 v147, -v67
    v_add_f32 v146, 1.0, v146
    v_mfma_f32_32x32x16_bf16 v[128:143], a[204:207], a[100:103], v[128:143]
    v_add_f32 v147, 1.0, v147
    v_rcp_f32 v146, v146
    v_rcp_f32 v147, v147
    v_mfma_f32_32x32x16_bf16 v[80:95], a[208:211], a[40:43], v[80:95]
    global_load_lds_dwordx4 v5, s[22:23] offset:3072
    v_mul_f32 v146, v66, v146
    v_mul_f32 v147, v67, v147
    v_cvt_pk_bf16_f32 v149, v146, v147
    v_exp_f32 v144, -v68
    v_mfma_f32_32x32x16_bf16 v[112:127], a[208:211], a[104:107], v[112:127]
    v_exp_f32 v145, -v69
    v_add_f32 v144, 1.0, v144
    v_add_f32 v145, 1.0, v145
    v_mfma_f32_32x32x16_bf16 v[96:111], a[212:215], a[40:43], v[96:111]
    s_waitcnt lgkmcnt(9)
    s_add_u32 m0, s21, 0
    s_add_u32 s22, s22, 16384
    s_addc_u32 s23, s23, 0
    global_load_lds_dwordx4 v2, s[22:23] offset:0
    v_rcp_f32 v144, v144
    v_rcp_f32 v145, v145
    v_mul_f32 v144, v68, v144
    v_mfma_f32_32x32x16_bf16 v[128:143], a[212:215], a[104:107], v[128:143]
    v_mul_f32 v145, v69, v145
    v_cvt_pk_bf16_f32 v150, v144, v145
    v_exp_f32 v146, -v70
    v_mfma_f32_32x32x16_bf16 v[80:95], a[216:219], a[44:47], v[80:95]
    global_load_lds_dwordx4 v3, s[22:23] offset:1024
    v_exp_f32 v147, -v71
    v_add_f32 v146, 1.0, v146
    v_add_f32 v147, 1.0, v147
    v_rcp_f32 v146, v146
    v_mfma_f32_32x32x16_bf16 v[112:127], a[216:219], a[108:111], v[112:127]
    s_waitcnt vmcnt(10)
    ds_read_b64_tr_b16 a[144:145], v6 offset:8192
    ds_read_b64_tr_b16 a[146:147], v6 offset:9216
    v_rcp_f32 v147, v147
    v_mul_f32 v146, v70, v146
    v_mul_f32 v147, v71, v147
    v_mfma_f32_32x32x16_bf16 v[96:111], a[220:223], a[44:47], v[96:111]
    ds_read_b64_tr_b16 a[148:149], v7 offset:8192
    ds_read_b64_tr_b16 a[150:151], v7 offset:9216
    global_load_lds_dwordx4 v4, s[22:23] offset:2048
    v_cvt_pk_bf16_f32 v151, v146, v147
    ds_write_b128 v10, v[148:151] offset:5120
    v_exp_f32 v144, -v72
    v_mfma_f32_32x32x16_bf16 v[128:143], a[220:223], a[108:111], v[128:143]
    ds_read_b64_tr_b16 a[152:153], v6 offset:10240
    ds_read_b64_tr_b16 a[154:155], v6 offset:11264
    v_exp_f32 v145, -v73
    v_add_f32 v144, 1.0, v144
    v_add_f32 v145, 1.0, v145
    v_rcp_f32 v144, v144
    v_mfma_f32_32x32x16_bf16 v[80:95], a[224:227], a[48:51], v[80:95]
    ds_read_b64_tr_b16 a[156:157], v7 offset:10240
    ds_read_b64_tr_b16 a[158:159], v7 offset:11264
    v_rcp_f32 v145, v145
    v_mul_f32 v144, v72, v144
    v_mul_f32 v145, v73, v145
    v_mfma_f32_32x32x16_bf16 v[112:127], a[224:227], a[112:115], v[112:127]
    v_cvt_pk_bf16_f32 v152, v144, v145
    v_exp_f32 v146, -v74
    v_exp_f32 v147, -v75
    v_mfma_f32_32x32x16_bf16 v[96:111], a[228:231], a[48:51], v[96:111]
    global_load_lds_dwordx4 v5, s[22:23] offset:3072
    v_add_f32 v146, 1.0, v146
    v_add_f32 v147, 1.0, v147
    v_rcp_f32 v146, v146
    v_mfma_f32_32x32x16_bf16 v[128:143], a[228:231], a[112:115], v[128:143]
    v_rcp_f32 v147, v147
    v_mul_f32 v146, v74, v146
    v_mul_f32 v147, v75, v147
    v_cvt_pk_bf16_f32 v153, v146, v147
    v_mfma_f32_32x32x16_bf16 v[80:95], a[232:235], a[52:55], v[80:95]
    s_waitcnt lgkmcnt(9)
    s_add_u32 m0, s21, 4096
    s_add_u32 s22, s22, 16384
    s_addc_u32 s23, s23, 0
    global_load_lds_dwordx4 v2, s[22:23] offset:0
    v_exp_f32 v144, -v76
    v_exp_f32 v145, -v77
    v_add_f32 v144, 1.0, v144
    v_mfma_f32_32x32x16_bf16 v[112:127], a[232:235], a[116:119], v[112:127]
    global_load_lds_dwordx4 v3, s[22:23] offset:1024
    v_add_f32 v145, 1.0, v145
    v_rcp_f32 v144, v144
    v_rcp_f32 v145, v145
    v_mfma_f32_32x32x16_bf16 v[96:111], a[236:239], a[52:55], v[96:111]
    s_waitcnt vmcnt(10)
    ds_read_b64_tr_b16 a[160:161], v6 offset:12288
    ds_read_b64_tr_b16 a[162:163], v6 offset:13312
    v_mul_f32 v144, v76, v144
    v_mul_f32 v145, v77, v145
    v_cvt_pk_bf16_f32 v154, v144, v145
    v_exp_f32 v146, -v78
    v_mfma_f32_32x32x16_bf16 v[128:143], a[236:239], a[116:119], v[128:143]
    ds_read_b64_tr_b16 a[164:165], v7 offset:12288
    ds_read_b64_tr_b16 a[166:167], v7 offset:13312
    global_load_lds_dwordx4 v4, s[22:23] offset:2048
    v_exp_f32 v147, -v79
    v_add_f32 v146, 1.0, v146
    v_add_f32 v147, 1.0, v147
    v_mfma_f32_32x32x16_bf16 v[80:95], a[240:243], a[56:59], v[80:95]
    ds_read_b64_tr_b16 a[168:169], v6 offset:14336
    ds_read_b64_tr_b16 a[170:171], v6 offset:15360
    v_rcp_f32 v146, v146
    v_rcp_f32 v147, v147
    v_mul_f32 v146, v78, v146
    v_mfma_f32_32x32x16_bf16 v[112:127], a[240:243], a[120:123], v[112:127]
    ds_read_b64_tr_b16 a[172:173], v7 offset:14336
    ds_read_b64_tr_b16 a[174:175], v7 offset:15360
    global_load_lds_dwordx4 v5, s[22:23] offset:3072
    v_mul_f32 v147, v79, v147
    v_cvt_pk_bf16_f32 v155, v146, v147
    ds_write_b128 v10, v[152:155] offset:7168
    v_mfma_f32_32x32x16_bf16 v[96:111], a[244:247], a[56:59], v[96:111]
    s_waitcnt lgkmcnt(0)
    s_barrier
    v_mfma_f32_32x32x16_bf16 v[128:143], a[244:247], a[120:123], v[128:143]
    ds_read_b128 v[156:159], v1 offset:0
    s_add_u32 m0, s21, 8192
    s_add_u32 s22, s22, 16384
    s_addc_u32 s23, s23, 0
    global_load_lds_dwordx4 v2, s[22:23] offset:0
    v_mfma_f32_32x32x16_bf16 v[80:95], a[248:251], a[60:63], v[80:95]
    ds_read_b128 v[160:163], v1 offset:1024
    global_load_lds_dwordx4 v3, s[22:23] offset:1024
    v_mfma_f32_32x32x16_bf16 v[112:127], a[248:251], a[124:127], v[112:127]
    ds_read_b128 v[164:167], v1 offset:2048
    s_waitcnt vmcnt(10)
    ds_read_b64_tr_b16 a[176:177], v6 offset:16384
    ds_read_b64_tr_b16 a[178:179], v6 offset:17408
    v_mfma_f32_32x32x16_bf16 v[96:111], a[252:255], a[60:63], v[96:111]
    ds_read_b128 v[168:171], v1 offset:3072
    ds_read_b64_tr_b16 a[180:181], v7 offset:16384
    ds_read_b64_tr_b16 a[182:183], v7 offset:17408
    global_load_lds_dwordx4 v4, s[22:23] offset:2048
    v_mfma_f32_32x32x16_bf16 v[128:143], a[252:255], a[124:127], v[128:143]
    ds_read_b64_tr_b16 a[184:185], v6 offset:18432
    ds_read_b64_tr_b16 a[186:187], v6 offset:19456
    s_waitcnt lgkmcnt(9)
    v_mfma_f32_32x32x16_bf16 v[16:31], a[128:131], v[156:159], v[204:219]
    ds_read_b64_tr_b16 a[188:189], v7 offset:18432
    ds_read_b64_tr_b16 a[190:191], v7 offset:19456
    s_waitcnt lgkmcnt(10)
    v_mfma_f32_32x32x16_bf16 v[48:63], a[128:131], v[160:163], 0
    global_load_lds_dwordx4 v5, s[22:23] offset:3072
    v_mfma_f32_32x32x16_bf16 v[32:47], a[132:135], v[156:159], v[220:235]
    ds_read_b128 v[172:175], v1 offset:4096
    v_exp_f32 v144, -v112
    v_exp_f32 v145, -v113
    v_add_f32 v144, 1.0, v144
    v_add_f32 v145, 1.0, v145
    v_rcp_f32 v144, v144
    v_rcp_f32 v145, v145
    v_mul_f32 v144, v112, v144
    v_mul_f32 v145, v113, v145
    v_cvt_pk_bf16_f32 v148, v144, v145
    v_exp_f32 v146, -v114
    v_mfma_f32_32x32x16_bf16 v[64:79], a[132:135], v[160:163], 0
    s_add_u32 m0, s21, 12288
    s_add_u32 s22, s22, 16384
    s_addc_u32 s23, s23, 0
    global_load_lds_dwordx4 v2, s[22:23] offset:0
    v_exp_f32 v147, -v115
    v_add_f32 v146, 1.0, v146
    v_add_f32 v147, 1.0, v147
    v_rcp_f32 v146, v146
    s_waitcnt lgkmcnt(10)
    v_mfma_f32_32x32x16_bf16 v[16:31], a[136:139], v[164:167], v[16:31]
    ds_read_b128 v[176:179], v1 offset:5120
    s_waitcnt vmcnt(9)
    ds_read_b64_tr_b16 a[192:193], v6 offset:0
    ds_read_b64_tr_b16 a[194:195], v6 offset:1024
    global_load_lds_dwordx4 v3, s[22:23] offset:1024
    v_rcp_f32 v147, v147
    v_mul_f32 v146, v114, v146
    v_mul_f32 v147, v115, v147
    s_waitcnt lgkmcnt(10)
    v_mfma_f32_32x32x16_bf16 v[48:63], a[136:139], v[168:171], v[48:63]
    ds_read_b64_tr_b16 a[196:197], v7 offset:0
    ds_read_b64_tr_b16 a[198:199], v7 offset:1024
    global_load_lds_dwordx4 v4, s[22:23] offset:2048
    v_cvt_pk_bf16_f32 v149, v146, v147
    v_exp_f32 v144, -v116
    v_exp_f32 v145, -v117
    v_mfma_f32_32x32x16_bf16 v[32:47], a[140:143], v[164:167], v[32:47]
    ds_read_b128 v[156:159], v1 offset:6144
    ds_read_b64_tr_b16 a[200:201], v6 offset:2048
    ds_read_b64_tr_b16 a[202:203], v6 offset:3072
    v_add_f32 v144, 1.0, v144
    v_add_f32 v145, 1.0, v145
    v_rcp_f32 v144, v144
    v_rcp_f32 v145, v145
    v_mfma_f32_32x32x16_bf16 v[64:79], a[140:143], v[168:171], v[64:79]
    ds_read_b64_tr_b16 a[204:205], v7 offset:2048
    ds_read_b64_tr_b16 a[206:207], v7 offset:3072
    global_load_lds_dwordx4 v5, s[22:23] offset:3072
    v_mul_f32 v144, v116, v144
    v_mul_f32 v145, v117, v145
    v_cvt_pk_bf16_f32 v150, v144, v145
    s_waitcnt lgkmcnt(10)
    v_mfma_f32_32x32x16_bf16 v[16:31], a[144:147], v[172:175], v[16:31]
    ds_read_b128 v[160:163], v1 offset:7168
    v_exp_f32 v146, -v118
    v_exp_f32 v147, -v119
    v_add_f32 v146, 1.0, v146
    s_waitcnt lgkmcnt(10)
    v_mfma_f32_32x32x16_bf16 v[48:63], a[144:147], v[176:179], v[48:63]
    s_add_u32 m0, s21, 16384
    s_add_u32 s22, s22, 16384
    s_addc_u32 s23, s23, 0
    global_load_lds_dwordx4 v2, s[22:23] offset:0
    v_add_f32 v147, 1.0, v147
    v_rcp_f32 v146, v146
    v_rcp_f32 v147, v147
    v_mfma_f32_32x32x16_bf16 v[32:47], a[148:151], v[172:175], v[32:47]
    ds_read_b128 v[164:167], v1 offset:8192
    v_mul_f32 v146, v118, v146
    v_mul_f32 v147, v119, v147
    v_cvt_pk_bf16_f32 v151, v146, v147
    ds_write_b128 v10, v[148:151] offset:33792
    v_mfma_f32_32x32x16_bf16 v[64:79], a[148:151], v[176:179], v[64:79]
    v_exp_f32 v144, -v120
    v_exp_f32 v145, -v121
    v_add_f32 v144, 1.0, v144
    s_waitcnt lgkmcnt(7)
    v_mfma_f32_32x32x16_bf16 v[16:31], a[152:155], v[156:159], v[16:31]
    ds_read_b128 v[168:171], v1 offset:9216
    v_add_f32 v145, 1.0, v145
    v_rcp_f32 v144, v144
    v_rcp_f32 v145, v145
    s_waitcnt lgkmcnt(3)
    v_mfma_f32_32x32x16_bf16 v[48:63], a[152:155], v[160:163], v[48:63]
    s_waitcnt vmcnt(9)
    ds_read_b64_tr_b16 a[208:209], v6 offset:4096
    ds_read_b64_tr_b16 a[210:211], v6 offset:5120
    global_load_lds_dwordx4 v3, s[22:23] offset:1024
    v_mul_f32 v144, v120, v144
    v_mul_f32 v145, v121, v145
    v_cvt_pk_bf16_f32 v152, v144, v145
    v_exp_f32 v146, -v122
    v_mfma_f32_32x32x16_bf16 v[32:47], a[156:159], v[156:159], v[32:47]
    ds_read_b128 v[172:175], v1 offset:10240
    ds_read_b64_tr_b16 a[212:213], v7 offset:4096
    ds_read_b64_tr_b16 a[214:215], v7 offset:5120
    global_load_lds_dwordx4 v4, s[22:23] offset:2048
    v_exp_f32 v147, -v123
    v_add_f32 v146, 1.0, v146
    v_add_f32 v147, 1.0, v147
    v_mfma_f32_32x32x16_bf16 v[64:79], a[156:159], v[160:163], v[64:79]
    ds_read_b64_tr_b16 a[216:217], v6 offset:6144
    ds_read_b64_tr_b16 a[218:219], v6 offset:7168
    v_rcp_f32 v146, v146
    v_rcp_f32 v147, v147
    v_mul_f32 v146, v122, v146
    s_waitcnt lgkmcnt(9)
    v_mfma_f32_32x32x16_bf16 v[16:31], a[160:163], v[164:167], v[16:31]
    ds_read_b128 v[176:179], v1 offset:11264
    ds_read_b64_tr_b16 a[220:221], v7 offset:6144
    ds_read_b64_tr_b16 a[222:223], v7 offset:7168
    global_load_lds_dwordx4 v5, s[22:23] offset:3072
    v_mul_f32 v147, v123, v147
    v_cvt_pk_bf16_f32 v153, v146, v147
    v_exp_f32 v144, -v124
    s_waitcnt lgkmcnt(10)
    v_mfma_f32_32x32x16_bf16 v[48:63], a[160:163], v[168:171], v[48:63]
    v_exp_f32 v145, -v125
    v_add_f32 v144, 1.0, v144
    v_add_f32 v145, 1.0, v145
    v_rcp_f32 v144, v144
    v_mfma_f32_32x32x16_bf16 v[32:47], a[164:167], v[164:167], v[32:47]
    ds_read_b128 v[156:159], v1 offset:12288
    s_add_u32 m0, s21, 0
    s_add_u32 s22, s22, 16384
    s_addc_u32 s23, s23, 0
    global_load_lds_dwordx4 v2, s[22:23] offset:0
    v_rcp_f32 v145, v145
    v_mul_f32 v144, v124, v144
    v_mul_f32 v145, v125, v145
    v_mfma_f32_32x32x16_bf16 v[64:79], a[164:167], v[168:171], v[64:79]
    v_cvt_pk_bf16_f32 v154, v144, v145
    v_exp_f32 v146, -v126
    v_exp_f32 v147, -v127
    s_waitcnt lgkmcnt(8)
    v_mfma_f32_32x32x16_bf16 v[16:31], a[168:171], v[172:175], v[16:31]
    ds_read_b128 v[160:163], v1 offset:13312
    s_waitcnt vmcnt(9)
    ds_read_b64_tr_b16 a[224:225], v6 offset:8192
    ds_read_b64_tr_b16 a[226:227], v6 offset:9216
    global_load_lds_dwordx4 v3, s[22:23] offset:1024
    v_add_f32 v146, 1.0, v146
    v_add_f32 v147, 1.0, v147
    v_rcp_f32 v146, v146
    v_rcp_f32 v147, v147
    s_waitcnt lgkmcnt(6)
    v_mfma_f32_32x32x16_bf16 v[48:63], a[168:171], v[176:179], v[48:63]
    ds_read_b64_tr_b16 a[228:229], v7 offset:8192
    ds_read_b64_tr_b16 a[230:231], v7 offset:9216
    global_load_lds_dwordx4 v4, s[22:23] offset:2048
    v_mul_f32 v146, v126, v146
    v_mul_f32 v147, v127, v147
    v_cvt_pk_bf16_f32 v155, v146, v147
    v_mfma_f32_32x32x16_bf16 v[32:47], a[172:175], v[172:175], v[32:47]
    ds_read_b128 v[164:167], v1 offset:14336
    ds_read_b64_tr_b16 a[232:233], v6 offset:10240
    ds_read_b64_tr_b16 a[234:235], v6 offset:11264
    ds_write_b128 v10, v[152:155] offset:35840
    v_exp_f32 v144, -v128
    v_exp_f32 v145, -v129
    v_mfma_f32_32x32x16_bf16 v[64:79], a[172:175], v[176:179], v[64:79]
    ds_read_b64_tr_b16 a[236:237], v7 offset:10240
    ds_read_b64_tr_b16 a[238:239], v7 offset:11264
    v_add_f32 v144, 1.0, v144
    v_add_f32 v145, 1.0, v145
    v_rcp_f32 v144, v144
    s_waitcnt lgkmcnt(11)
    v_mfma_f32_32x32x16_bf16 v[16:31], a[176:179], v[156:159], v[16:31]
    ds_read_b128 v[168:171], v1 offset:15360
    v_rcp_f32 v145, v145
    v_mul_f32 v144, v128, v144
    v_mul_f32 v145, v129, v145
    v_cvt_pk_bf16_f32 v148, v144, v145
    s_waitcnt lgkmcnt(11)
    v_mfma_f32_32x32x16_bf16 v[48:63], a[176:179], v[160:163], v[48:63]
    global_load_lds_dwordx4 v5, s[22:23] offset:3072
    v_exp_f32 v146, -v130
    v_exp_f32 v147, -v131
    v_add_f32 v146, 1.0, v146
    v_mfma_f32_32x32x16_bf16 v[32:47], a[180:183], v[156:159], v[32:47]
    ds_read_b128 v[172:175], v1 offset:16384
    v_add_f32 v147, 1.0, v147
    v_rcp_f32 v146, v146
    v_rcp_f32 v147, v147
    v_mfma_f32_32x32x16_bf16 v[64:79], a[180:183], v[160:163], v[64:79]
    s_add_u32 m0, s21, 4096
    s_add_u32 s22, s22, 16384
    s_addc_u32 s23, s23, 0
    global_load_lds_dwordx4 v2, s[22:23] offset:0
    v_mul_f32 v146, v130, v146
    v_mul_f32 v147, v131, v147
    v_cvt_pk_bf16_f32 v149, v146, v147
    v_exp_f32 v144, -v132
    s_waitcnt lgkmcnt(7)
    v_mfma_f32_32x32x16_bf16 v[16:31], a[184:187], v[164:167], v[16:31]
    ds_read_b128 v[176:179], v1 offset:17408
    v_exp_f32 v145, -v133
    v_add_f32 v144, 1.0, v144
    v_add_f32 v145, 1.0, v145
    s_waitcnt lgkmcnt(2)
    v_mfma_f32_32x32x16_bf16 v[48:63], a[184:187], v[168:171], v[48:63]
    s_waitcnt vmcnt(9)
    ds_read_b64_tr_b16 a[240:241], v6 offset:12288
    ds_read_b64_tr_b16 a[242:243], v6 offset:13312
    global_load_lds_dwordx4 v3, s[22:23] offset:1024
    v_rcp_f32 v144, v144
    v_rcp_f32 v145, v145
    v_mul_f32 v144, v132, v144
    v_mfma_f32_32x32x16_bf16 v[32:47], a[188:191], v[164:167], v[32:47]
    ds_read_b128 v[156:159], v1 offset:18432
    ds_read_b64_tr_b16 a[244:245], v7 offset:12288
    ds_read_b64_tr_b16 a[246:247], v7 offset:13312
    global_load_lds_dwordx4 v4, s[22:23] offset:2048
    v_mul_f32 v145, v133, v145
    v_cvt_pk_bf16_f32 v150, v144, v145
    v_exp_f32 v146, -v134
    v_mfma_f32_32x32x16_bf16 v[64:79], a[188:191], v[168:171], v[64:79]
    ds_read_b64_tr_b16 a[248:249], v6 offset:14336
    ds_read_b64_tr_b16 a[250:251], v6 offset:15360
    v_exp_f32 v147, -v135
    v_add_f32 v146, 1.0, v146
    v_add_f32 v147, 1.0, v147
    v_rcp_f32 v146, v146
    s_waitcnt lgkmcnt(8)
    v_mfma_f32_32x32x16_bf16 v[16:31], a[192:195], v[172:175], v[16:31]
    ds_read_b128 v[160:163], v1 offset:19456
    ds_read_b64_tr_b16 a[252:253], v7 offset:14336
    ds_read_b64_tr_b16 a[254:255], v7 offset:15360
    global_load_lds_dwordx4 v5, s[22:23] offset:3072
    v_rcp_f32 v147, v147
    v_mul_f32 v146, v134, v146
    v_mul_f32 v147, v135, v147
    s_waitcnt lgkmcnt(10)
    v_mfma_f32_32x32x16_bf16 v[48:63], a[192:195], v[176:179], v[48:63]
    v_cvt_pk_bf16_f32 v151, v146, v147
    ds_write_b128 v10, v[148:151] offset:37888
    v_exp_f32 v144, -v136
    v_mfma_f32_32x32x16_bf16 v[32:47], a[196:199], v[172:175], v[32:47]
    ds_read_b128 v[164:167], v1 offset:20480
    v_exp_f32 v145, -v137
    v_add_f32 v144, 1.0, v144
    v_add_f32 v145, 1.0, v145
    v_rcp_f32 v144, v144
    v_mfma_f32_32x32x16_bf16 v[64:79], a[196:199], v[176:179], v[64:79]
    v_rcp_f32 v145, v145
    v_mul_f32 v144, v136, v144
    v_mul_f32 v145, v137, v145
    s_waitcnt lgkmcnt(9)
    v_mfma_f32_32x32x16_bf16 v[16:31], a[200:203], v[156:159], v[16:31]
    ds_read_b128 v[168:171], v1 offset:21504
    s_add_u32 m0, s21, 8192
    s_add_u32 s22, s22, 16384
    s_addc_u32 s23, s23, 0
    global_load_lds_dwordx4 v2, s[22:23] offset:0
    v_cvt_pk_bf16_f32 v152, v144, v145
    v_exp_f32 v146, -v138
    v_exp_f32 v147, -v139
    s_waitcnt lgkmcnt(5)
    v_mfma_f32_32x32x16_bf16 v[48:63], a[200:203], v[160:163], v[48:63]
    v_add_f32 v146, 1.0, v146
    v_add_f32 v147, 1.0, v147
    v_rcp_f32 v146, v146
    v_mfma_f32_32x32x16_bf16 v[32:47], a[204:207], v[156:159], v[32:47]
    ds_read_b128 v[172:175], v1 offset:22528
    s_waitcnt vmcnt(9)
    ds_read_b64_tr_b16 a[128:129], v6 offset:16384
    ds_read_b64_tr_b16 a[130:131], v6 offset:17408
    global_load_lds_dwordx4 v3, s[22:23] offset:1024
    v_rcp_f32 v147, v147
    v_mul_f32 v146, v138, v146
    v_mul_f32 v147, v139, v147
    v_cvt_pk_bf16_f32 v153, v146, v147
    v_mfma_f32_32x32x16_bf16 v[64:79], a[204:207], v[160:163], v[64:79]
    ds_read_b64_tr_b16 a[132:133], v7 offset:16384
    ds_read_b64_tr_b16 a[134:135], v7 offset:17408
    global_load_lds_dwordx4 v4, s[22:23] offset:2048
    v_exp_f32 v144, -v140
    v_exp_f32 v145, -v141
    v_add_f32 v144, 1.0, v144
    s_waitcnt lgkmcnt(6)
    v_mfma_f32_32x32x16_bf16 v[16:31], a[208:211], v[164:167], v[16:31]
    ds_read_b128 v[176:179], v1 offset:23552
    ds_read_b64_tr_b16 a[136:137], v6 offset:18432
    ds_read_b64_tr_b16 a[138:139], v6 offset:19456
    v_add_f32 v145, 1.0, v145
    v_rcp_f32 v144, v144
    v_rcp_f32 v145, v145
    s_waitcnt lgkmcnt(8)
    v_mfma_f32_32x32x16_bf16 v[48:63], a[208:211], v[168:171], v[48:63]
    ds_read_b64_tr_b16 a[140:141], v7 offset:18432
    ds_read_b64_tr_b16 a[142:143], v7 offset:19456
    global_load_lds_dwordx4 v5, s[22:23] offset:3072
    v_mul_f32 v144, v140, v144
    v_mul_f32 v145, v141, v145
    v_cvt_pk_bf16_f32 v154, v144, v145
    v_exp_f32 v146, -v142
    v_mfma_f32_32x32x16_bf16 v[32:47], a[212:215], v[164:167], v[32:47]
    ds_read_b128 v[156:159], v1 offset:24576
    v_exp_f32 v147, -v143
    v_add_f32 v146, 1.0, v146
    v_add_f32 v147, 1.0, v147
    v_mfma_f32_32x32x16_bf16 v[64:79], a[212:215], v[168:171], v[64:79]
    s_add_u32 m0, s21, 12288
    s_add_u32 s22, s22, 16384
    s_addc_u32 s23, s23, 0
    global_load_lds_dwordx4 v2, s[22:23] offset:0
    v_rcp_f32 v146, v146
    v_rcp_f32 v147, v147
    v_mul_f32 v146, v142, v146
    s_waitcnt lgkmcnt(10)
    v_mfma_f32_32x32x16_bf16 v[16:31], a[216:219], v[172:175], v[16:31]
    ds_read_b128 v[160:163], v1 offset:25600
    global_load_lds_dwordx4 v3, s[22:23] offset:1024
    v_mul_f32 v147, v143, v147
    v_cvt_pk_bf16_f32 v155, v146, v147
    ds_write_b128 v10, v[152:155] offset:39936
    s_waitcnt lgkmcnt(7)
    v_mfma_f32_32x32x16_bf16 v[48:63], a[216:219], v[176:179], v[48:63]
    s_waitcnt vmcnt(10)
    ds_read_b64_tr_b16 a[144:145], v6 offset:0
    ds_read_b64_tr_b16 a[146:147], v6 offset:1024
    v_exp_f32 v144, -v80
    v_exp_f32 v145, -v81
    v_add_f32 v144, 1.0, v144
    v_add_f32 v145, 1.0, v145
    v_mfma_f32_32x32x16_bf16 v[32:47], a[220:223], v[172:175], v[32:47]
    ds_read_b128 v[164:167], v1 offset:26624
    ds_read_b64_tr_b16 a[148:149], v7 offset:0
    ds_read_b64_tr_b16 a[150:151], v7 offset:1024
    v_rcp_f32 v144, v144
    v_rcp_f32 v145, v145
    v_mul_f32 v144, v80, v144
    v_mfma_f32_32x32x16_bf16 v[64:79], a[220:223], v[176:179], v[64:79]
    ds_read_b64_tr_b16 a[152:153], v6 offset:2048
    ds_read_b64_tr_b16 a[154:155], v6 offset:3072
    v_mul_f32 v145, v81, v145
    v_cvt_pk_bf16_f32 v148, v144, v145
    v_exp_f32 v146, -v82
    s_waitcnt lgkmcnt(9)
    v_mfma_f32_32x32x16_bf16 v[16:31], a[224:227], v[156:159], v[16:31]
    ds_read_b128 v[168:171], v1 offset:27648
    ds_read_b64_tr_b16 a[156:157], v7 offset:2048
    ds_read_b64_tr_b16 a[158:159], v7 offset:3072
    global_load_lds_dwordx4 v4, s[22:23] offset:2048
    v_exp_f32 v147, -v83
    v_add_f32 v146, 1.0, v146
    v_add_f32 v147, 1.0, v147
    v_rcp_f32 v146, v146
    s_waitcnt lgkmcnt(11)
    v_mfma_f32_32x32x16_bf16 v[48:63], a[224:227], v[160:163], v[48:63]
    global_load_lds_dwordx4 v5, s[22:23] offset:3072
    v_rcp_f32 v147, v147
    v_mul_f32 v146, v82, v146
    v_mul_f32 v147, v83, v147
    v_mfma_f32_32x32x16_bf16 v[32:47], a[228:231], v[156:159], v[32:47]
    ds_read_b128 v[172:175], v1 offset:28672
    v_cvt_pk_bf16_f32 v149, v146, v147
    v_exp_f32 v144, -v84
    v_exp_f32 v145, -v85
    v_mfma_f32_32x32x16_bf16 v[64:79], a[228:231], v[160:163], v[64:79]
    s_add_u32 m0, s21, 16384
    s_add_u32 s22, s22, 16384
    s_addc_u32 s23, s23, 0
    global_load_lds_dwordx4 v2, s[22:23] offset:0
    v_add_f32 v144, 1.0, v144
    v_add_f32 v145, 1.0, v145
    v_rcp_f32 v144, v144
    v_rcp_f32 v145, v145
    s_waitcnt lgkmcnt(8)
    v_mfma_f32_32x32x16_bf16 v[16:31], a[232:235], v[164:167], v[16:31]
    ds_read_b128 v[176:179], v1 offset:29696
    v_mul_f32 v144, v84, v144
    v_mul_f32 v145, v85, v145
    v_cvt_pk_bf16_f32 v150, v144, v145
    s_waitcnt lgkmcnt(4)
    v_mfma_f32_32x32x16_bf16 v[48:63], a[232:235], v[168:171], v[48:63]
    global_load_lds_dwordx4 v3, s[22:23] offset:1024
    v_exp_f32 v146, -v86
    v_exp_f32 v147, -v87
    v_add_f32 v146, 1.0, v146
    v_mfma_f32_32x32x16_bf16 v[32:47], a[236:239], v[164:167], v[32:47]
    ds_read_b128 v[156:159], v1 offset:30720
    s_waitcnt vmcnt(10)
    ds_read_b64_tr_b16 a[160:161], v6 offset:4096
    ds_read_b64_tr_b16 a[162:163], v6 offset:5120
    v_add_f32 v147, 1.0, v147
    v_rcp_f32 v146, v146
    v_rcp_f32 v147, v147
    v_mfma_f32_32x32x16_bf16 v[64:79], a[236:239], v[168:171], v[64:79]
    ds_read_b64_tr_b16 a[164:165], v7 offset:4096
    ds_read_b64_tr_b16 a[166:167], v7 offset:5120
    global_load_lds_dwordx4 v4, s[22:23] offset:2048
    v_mul_f32 v146, v86, v146
    v_mul_f32 v147, v87, v147
    v_cvt_pk_bf16_f32 v151, v146, v147
    ds_write_b128 v10, v[148:151] offset:32768
    s_waitcnt lgkmcnt(7)
    v_mfma_f32_32x32x16_bf16 v[16:31], a[240:243], v[172:175], v[16:31]
    ds_read_b128 v[160:163], v1 offset:31744
    ds_read_b64_tr_b16 a[168:169], v6 offset:6144
    ds_read_b64_tr_b16 a[170:171], v6 offset:7168
    v_exp_f32 v144, -v88
    v_exp_f32 v145, -v89
    v_add_f32 v144, 1.0, v144
    s_waitcnt lgkmcnt(9)
    v_mfma_f32_32x32x16_bf16 v[48:63], a[240:243], v[176:179], v[48:63]
    ds_read_b64_tr_b16 a[172:173], v7 offset:6144
    ds_read_b64_tr_b16 a[174:175], v7 offset:7168
    v_add_f32 v145, 1.0, v145
    v_rcp_f32 v144, v144
    v_rcp_f32 v145, v145
    v_mfma_f32_32x32x16_bf16 v[32:47], a[244:247], v[172:175], v[32:47]
    global_load_lds_dwordx4 v5, s[22:23] offset:3072
    v_mul_f32 v144, v88, v144
    v_mul_f32 v145, v89, v145
    v_cvt_pk_bf16_f32 v152, v144, v145
    v_exp_f32 v146, -v90
    s_waitcnt lgkmcnt(0)
    s_barrier
    v_mfma_f32_32x32x16_bf16 v[64:79], a[244:247], v[176:179], v[64:79]
    s_waitcnt vmcnt(8)
    ds_read_b64_tr_b16 a[176:177], v6 offset:8192
    ds_read_b64_tr_b16 a[178:179], v6 offset:9216
    s_add_u32 m0, s21, 0
    s_add_u32 s22, s22, 16384
    s_addc_u32 s23, s23, 0
    global_load_lds_dwordx4 v2, s[22:23] offset:0
    v_exp_f32 v147, -v91
    v_add_f32 v146, 1.0, v146
    v_add_f32 v147, 1.0, v147
    v_mfma_f32_32x32x16_bf16 v[16:31], a[248:251], v[156:159], v[16:31]
    ds_read_b128 v[164:167], v1 offset:33792
    ds_read_b64_tr_b16 a[180:181], v7 offset:8192
    ds_read_b64_tr_b16 a[182:183], v7 offset:9216
    global_load_lds_dwordx4 v3, s[22:23] offset:1024
    v_rcp_f32 v146, v146
    v_rcp_f32 v147, v147
    v_mul_f32 v146, v90, v146
    v_mfma_f32_32x32x16_bf16 v[48:63], a[248:251], v[160:163], v[48:63]
    ds_read_b64_tr_b16 a[184:185], v6 offset:10240
    ds_read_b64_tr_b16 a[186:187], v6 offset:11264
    v_mul_f32 v147, v91, v147
    v_cvt_pk_bf16_f32 v153, v146, v147
    v_exp_f32 v144, -v92
    v_mfma_f32_32x32x16_bf16 v[32:47], a[252:255], v[156:159], v[32:47]
    ds_read_b128 v[168:171], v1 offset:35840
    ds_read_b64_tr_b16 a[188:189], v7 offset:10240
    ds_read_b64_tr_b16 a[190:191], v7 offset:11264
    global_load_lds_dwordx4 v4, s[22:23] offset:2048
    v_exp_f32 v145, -v93
    v_add_f32 v144, 1.0, v144
    v_add_f32 v145, 1.0, v145
    v_rcp_f32 v144, v144
    v_mfma_f32_32x32x16_bf16 v[64:79], a[252:255], v[160:163], v[64:79]
    v_rcp_f32 v145, v145
    v_mul_f32 v144, v92, v144
    v_mul_f32 v145, v93, v145
    s_waitcnt lgkmcnt(7)
    v_mfma_f32_32x32x16_bf16 v[48:63], a[128:131], v[164:167], v[48:63]
    ds_read_b128 v[172:175], v1 offset:37888
    global_load_lds_dwordx4 v5, s[22:23] offset:3072
    v_cvt_pk_bf16_f32 v154, v144, v145
    v_exp_f32 v146, -v94
    v_exp_f32 v147, -v95
    v_mfma_f32_32x32x16_bf16 v[64:79], a[132:135], v[164:167], v[64:79]
    v_add_f32 v146, 1.0, v146
    v_add_f32 v147, 1.0, v147
    v_rcp_f32 v146, v146
    v_rcp_f32 v147, v147
    s_waitcnt lgkmcnt(3)
    v_mfma_f32_32x32x16_bf16 v[48:63], a[136:139], v[168:171], v[48:63]
    ds_read_b128 v[176:179], v1 offset:39936
    s_waitcnt vmcnt(8)
    ds_read_b64_tr_b16 a[192:193], v6 offset:12288
    ds_read_b64_tr_b16 a[194:195], v6 offset:13312
    s_add_u32 m0, s21, 4096
    s_add_u32 s22, s22, 16384
    s_addc_u32 s23, s23, 0
    global_load_lds_dwordx4 v2, s[22:23] offset:0
    v_mul_f32 v146, v94, v146
    v_mul_f32 v147, v95, v147
    v_cvt_pk_bf16_f32 v155, v146, v147
    v_mfma_f32_32x32x16_bf16 v[64:79], a[140:143], v[168:171], v[64:79]
    ds_read_b64_tr_b16 a[196:197], v7 offset:12288
    ds_read_b64_tr_b16 a[198:199], v7 offset:13312
    global_load_lds_dwordx4 v3, s[22:23] offset:1024
    ds_write_b128 v10, v[152:155] offset:34816
    v_exp_f32 v144, -v96
    v_exp_f32 v145, -v97
    s_waitcnt lgkmcnt(6)
    v_mfma_f32_32x32x16_bf16 v[48:63], a[144:147], v[172:175], v[48:63]
    ds_read_b128 v[156:159], v1 offset:41984
    ds_read_b64_tr_b16 a[200:201], v6 offset:14336
    ds_read_b64_tr_b16 a[202:203], v6 offset:15360
    v_add_f32 v144, 1.0, v144
    v_add_f32 v145, 1.0, v145
    v_rcp_f32 v144, v144
    v_mfma_f32_32x32x16_bf16 v[64:79], a[148:151], v[172:175], v[64:79]
    ds_read_b64_tr_b16 a[204:205], v7 offset:14336
    ds_read_b64_tr_b16 a[206:207], v7 offset:15360
    v_rcp_f32 v145, v145
    v_mul_f32 v144, v96, v144
    v_mul_f32 v145, v97, v145
    v_cvt_pk_bf16_f32 v148, v144, v145
    s_waitcnt lgkmcnt(10)
    v_mfma_f32_32x32x16_bf16 v[48:63], a[152:155], v[176:179], v[48:63]
    ds_read_b128 v[160:163], v1 offset:44032
    global_load_lds_dwordx4 v4, s[22:23] offset:2048
    v_exp_f32 v146, -v98
    v_exp_f32 v147, -v99
    v_add_f32 v146, 1.0, v146
    v_mfma_f32_32x32x16_bf16 v[64:79], a[156:159], v[176:179], v[64:79]
    v_add_f32 v147, 1.0, v147
    v_rcp_f32 v146, v146
    v_rcp_f32 v147, v147
    s_waitcnt lgkmcnt(5)
    v_mfma_f32_32x32x16_bf16 v[48:63], a[160:163], v[156:159], v[48:63]
    ds_read_b128 v[164:167], v1 offset:46080
    global_load_lds_dwordx4 v5, s[22:23] offset:3072
    v_mul_f32 v146, v98, v146
    v_mul_f32 v147, v99, v147
    v_cvt_pk_bf16_f32 v149, v146, v147
    v_exp_f32 v144, -v100
    v_mfma_f32_32x32x16_bf16 v[64:79], a[164:167], v[156:159], v[64:79]
    v_exp_f32 v145, -v101
    v_add_f32 v144, 1.0, v144
    v_add_f32 v145, 1.0, v145
    s_waitcnt lgkmcnt(1)
    v_mfma_f32_32x32x16_bf16 v[48:63], a[168:171], v[160:163], v[48:63]
    ds_read_b128 v[168:171], v1 offset:48128
    v_rcp_f32 v144, v144
    v_rcp_f32 v145, v145
    v_mul_f32 v144, v100, v144
    v_mfma_f32_32x32x16_bf16 v[64:79], a[172:175], v[160:163], v[64:79]
    s_waitcnt vmcnt(8)
    ds_read_b64_tr_b16 a[208:209], v6 offset:16384
    ds_read_b64_tr_b16 a[210:211], v6 offset:17408
    s_add_u32 m0, s21, 8192
    s_lshl_b32 s34, s26, 8
    s_lshl_b32 s35, s20, 6
    s_add_u32 s34, s34, s35
    s_add_u32 s22, s10, s34
    s_addc_u32 s23, s11, 0
    v_bfe_u32 v2, v0, 2, 4
    v_mul_u32_u24 v2, 1536, v2
    v_and_b32 v3, 3, v0
    v_lshl_add_u32 v2, v3, 4, v2
    v_add_u32 v3, 23552, v2
    v_add_u32 v4, 47104, v2
    v_add_u32 v5, 70656, v2
    global_load_lds_dwordx4 v2, s[22:23] offset:0
    v_mul_f32 v145, v101, v145
    v_cvt_pk_bf16_f32 v150, v144, v145
    v_exp_f32 v146, -v102
    s_waitcnt lgkmcnt(3)
    v_mfma_f32_32x32x16_bf16 v[48:63], a[176:179], v[164:167], v[48:63]
    ds_read_b128 v[172:175], v1 offset:50176
    ds_read_b64_tr_b16 a[212:213], v7 offset:16384
    ds_read_b64_tr_b16 a[214:215], v7 offset:17408
    global_load_lds_dwordx4 v3, s[22:23] offset:1024
    v_exp_f32 v147, -v103
    v_add_f32 v146, 1.0, v146
    v_add_f32 v147, 1.0, v147
    v_rcp_f32 v146, v146
    v_mfma_f32_32x32x16_bf16 v[64:79], a[180:183], v[164:167], v[64:79]
    ds_read_b64_tr_b16 a[216:217], v6 offset:18432
    ds_read_b64_tr_b16 a[218:219], v6 offset:19456
    global_load_lds_dwordx4 v4, s[22:23] offset:2048
    v_rcp_f32 v147, v147
    v_mul_f32 v146, v102, v146
    v_mul_f32 v147, v103, v147
    s_waitcnt lgkmcnt(7)
    v_mfma_f32_32x32x16_bf16 v[48:63], a[184:187], v[168:171], v[48:63]
    ds_read_b128 v[176:179], v1 offset:52224
    ds_read_b64_tr_b16 a[220:221], v7 offset:18432
    ds_read_b64_tr_b16 a[222:223], v7 offset:19456
    v_cvt_pk_bf16_f32 v151, v146, v147
    ds_write_b128 v10, v[148:151] offset:36864
    v_exp_f32 v144, -v104
    v_mfma_f32_32x32x16_bf16 v[64:79], a[188:191], v[168:171], v[64:79]
    global_load_lds_dwordx4 v5, s[22:23] offset:3072
    v_exp_f32 v145, -v105
    v_add_f32 v144, 1.0, v144
    v_add_f32 v145, 1.0, v145
    v_rcp_f32 v144, v144
    s_waitcnt lgkmcnt(8)
    v_mfma_f32_32x32x16_bf16 v[48:63], a[192:195], v[172:175], v[48:63]
    ds_read_b128 v[156:159], v1 offset:54272
    s_add_u32 m0, s21, 12288
    s_add_u32 s22, s22, 98304
    s_addc_u32 s23, s23, 0
    global_load_lds_dwordx4 v2, s[22:23] offset:0
    v_rcp_f32 v145, v145
    v_mul_f32 v144, v104, v144
    v_mul_f32 v145, v105, v145
    v_mfma_f32_32x32x16_bf16 v[64:79], a[196:199], v[172:175], v[64:79]
    global_load_lds_dwordx4 v3, s[22:23] offset:1024
    v_cvt_pk_bf16_f32 v152, v144, v145
    v_exp_f32 v146, -v106
    v_exp_f32 v147, -v107
    s_waitcnt lgkmcnt(4)
    v_mfma_f32_32x32x16_bf16 v[48:63], a[200:203], v[176:179], v[48:63]
    ds_read_b128 v[160:163], v1 offset:56320
    s_waitcnt vmcnt(10)
    ds_read_b64_tr_b16 a[224:225], v6 offset:0
    ds_read_b64_tr_b16 a[226:227], v6 offset:1024
    global_load_lds_dwordx4 v4, s[22:23] offset:2048
    v_add_f32 v146, 1.0, v146
    v_add_f32 v147, 1.0, v147
    v_rcp_f32 v146, v146
    v_mfma_f32_32x32x16_bf16 v[64:79], a[204:207], v[176:179], v[64:79]
    ds_read_b64_tr_b16 a[228:229], v7 offset:0
    ds_read_b64_tr_b16 a[230:231], v7 offset:1024
    global_load_lds_dwordx4 v5, s[22:23] offset:3072
    v_rcp_f32 v147, v147
    v_mul_f32 v146, v106, v146
    v_mul_f32 v147, v107, v147
    v_cvt_pk_bf16_f32 v153, v146, v147
    s_waitcnt lgkmcnt(5)
    v_mfma_f32_32x32x16_bf16 v[48:63], a[208:211], v[156:159], v[48:63]
    ds_read_b128 v[164:167], v1 offset:58368
    ds_read_b64_tr_b16 a[232:233], v6 offset:2048
    ds_read_b64_tr_b16 a[234:235], v6 offset:3072
    s_add_u32 m0, s21, 16384
    s_add_u32 s22, s22, 98304
    s_addc_u32 s23, s23, 0
    global_load_lds_dwordx4 v2, s[22:23] offset:0
    v_exp_f32 v144, -v108
    v_exp_f32 v145, -v109
    v_add_f32 v144, 1.0, v144
    v_mfma_f32_32x32x16_bf16 v[64:79], a[212:215], v[156:159], v[64:79]
    ds_read_b64_tr_b16 a[236:237], v7 offset:2048
    ds_read_b64_tr_b16 a[238:239], v7 offset:3072
    global_load_lds_dwordx4 v3, s[22:23] offset:1024
    v_add_f32 v145, 1.0, v145
    v_rcp_f32 v144, v144
    v_rcp_f32 v145, v145
    s_waitcnt lgkmcnt(9)
    v_mfma_f32_32x32x16_bf16 v[48:63], a[216:219], v[160:163], v[48:63]
    ds_read_b128 v[168:171], v1 offset:60416
    s_waitcnt vmcnt(10)
    ds_read_b64_tr_b16 a[240:241], v6 offset:4096
    ds_read_b64_tr_b16 a[242:243], v6 offset:5120
    global_load_lds_dwordx4 v4, s[22:23] offset:2048
    v_mul_f32 v144, v108, v144
    v_mul_f32 v145, v109, v145
    v_cvt_pk_bf16_f32 v154, v144, v145
    v_exp_f32 v146, -v110
    v_mfma_f32_32x32x16_bf16 v[64:79], a[220:223], v[160:163], v[64:79]
    ds_read_b64_tr_b16 a[244:245], v7 offset:4096
    ds_read_b64_tr_b16 a[246:247], v7 offset:5120
    global_load_lds_dwordx4 v5, s[22:23] offset:3072
    v_exp_f32 v147, -v111
    v_add_f32 v146, 1.0, v146
    v_add_f32 v147, 1.0, v147
    s_waitcnt lgkmcnt(9)
    v_mfma_f32_32x32x16_bf16 v[48:63], a[224:227], v[164:167], v[48:63]
    ds_read_b128 v[172:175], v1 offset:62464
    ds_read_b64_tr_b16 a[248:249], v6 offset:6144
    ds_read_b64_tr_b16 a[250:251], v6 offset:7168
    s_waitcnt lgkmcnt(8)
    s_add_u32 m0, s21, 0
    s_add_u32 s22, s22, 98304
    s_addc_u32 s23, s23, 0
    global_load_lds_dwordx4 v2, s[22:23] offset:0
    v_rcp_f32 v146, v146
    v_rcp_f32 v147, v147
    v_mul_f32 v146, v110, v146
    v_mfma_f32_32x32x16_bf16 v[64:79], a[228:231], v[164:167], v[64:79]
    ds_read_b64_tr_b16 a[252:253], v7 offset:6144
    ds_read_b64_tr_b16 a[254:255], v7 offset:7168
    global_load_lds_dwordx4 v3, s[22:23] offset:1024
    v_mul_f32 v147, v111, v147
    v_cvt_pk_bf16_f32 v155, v146, v147
    ds_write_b128 v10, v[152:155] offset:38912
    s_waitcnt lgkmcnt(10)
    v_mfma_f32_32x32x16_bf16 v[48:63], a[232:235], v[168:171], v[48:63]
    ds_read_b128 v[176:179], v1 offset:64512
    s_waitcnt vmcnt(10)
    ds_read_b64_tr_b16 a[64:65], v254 offset:8192
    ds_read_b64_tr_b16 a[66:67], v254 offset:8704
    global_load_lds_dwordx4 v4, s[22:23] offset:2048
    s_waitcnt lgkmcnt(0)
    s_barrier
    v_mfma_f32_32x32x16_bf16 v[64:79], a[236:239], v[168:171], v[64:79]
    ds_read_b64_tr_b16 a[68:69], v254 offset:9216
    ds_read_b64_tr_b16 a[70:71], v254 offset:9728
    global_load_lds_dwordx4 v5, s[22:23] offset:3072
    v_mfma_f32_32x32x16_bf16 v[48:63], a[240:243], v[172:175], v[48:63]
    ds_read_b128 v[156:159], v1 offset:32768
    ds_read_b64_tr_b16 a[72:73], v254 offset:10240
    ds_read_b64_tr_b16 a[74:75], v254 offset:10752
    s_add_u32 m0, s21, 4096
    s_sub_u32 s22, s22, 294400
    s_subb_u32 s23, s23, 0
    global_load_lds_dwordx4 v2, s[22:23] offset:0
    v_mfma_f32_32x32x16_bf16 v[64:79], a[244:247], v[172:175], v[64:79]
    ds_read_b64_tr_b16 a[76:77], v254 offset:11264
    ds_read_b64_tr_b16 a[78:79], v254 offset:11776
    global_load_lds_dwordx4 v3, s[22:23] offset:1024
    v_mfma_f32_32x32x16_bf16 v[48:63], a[248:251], v[176:179], v[48:63]
    ds_read_b128 v[160:163], v1 offset:34816
    s_waitcnt vmcnt(10)
    ds_read_b64_tr_b16 a[80:81], v254 offset:12288
    ds_read_b64_tr_b16 a[82:83], v254 offset:12800
    global_load_lds_dwordx4 v4, s[22:23] offset:2048
    v_mfma_f32_32x32x16_bf16 v[64:79], a[252:255], v[176:179], v[64:79]
    ds_read_b64_tr_b16 a[84:85], v254 offset:13312
    ds_read_b64_tr_b16 a[86:87], v254 offset:13824
    global_load_lds_dwordx4 v5, s[22:23] offset:3072
    s_waitcnt lgkmcnt(9)
    v_mfma_f32_32x32x16_bf16 v[16:31], a[128:131], v[156:159], v[16:31]
    ds_read_b128 v[164:167], v1 offset:36864
    ds_read_b64_tr_b16 a[88:89], v254 offset:14336
    ds_read_b64_tr_b16 a[90:91], v254 offset:14848
    v_mfma_f32_32x32x16_bf16 v[32:47], a[132:135], v[156:159], v[32:47]
    ds_read_b64_tr_b16 a[92:93], v254 offset:15360
    ds_read_b64_tr_b16 a[94:95], v254 offset:15872
    s_waitcnt lgkmcnt(9)
    v_mfma_f32_32x32x16_bf16 v[16:31], a[136:139], v[160:163], v[16:31]
    ds_read_b128 v[168:171], v1 offset:38912
    v_mfma_f32_32x32x16_bf16 v[32:47], a[140:143], v[160:163], v[32:47]
    v_xor_b32 v248, v245, v244
    v_and_b32 v248, 15, v248
    v_cmp_eq_u32 vcc, 0, v248
    v_readfirstlane_b32 s28, v245
    s_waitcnt lgkmcnt(5)
    v_mfma_f32_32x32x16_bf16 v[16:31], a[144:147], v[164:167], v[16:31]
    ds_read_b128 v[172:175], v1 offset:40960
    v_cvt_pk_bf16_f32 v80, v48, v49
    v_cvt_pk_bf16_f32 v81, v50, v51
    v_cvt_pk_bf16_f32 v82, v52, v53
    v_cvt_pk_bf16_f32 v83, v54, v55
    s_cbranch_vccz standalone__conformer_family_zipformer__speech_kernel_xs0
    global_store_dwordx4 v243, v[80:83], s[96:97] offset:0
standalone__conformer_family_zipformer__speech_kernel_xj0:
    v_mfma_f32_32x32x16_bf16 v[32:47], a[148:151], v[164:167], v[32:47]
    v_cvt_pk_bf16_f32 v84, v56, v57
    v_cvt_pk_bf16_f32 v85, v58, v59
    v_cvt_pk_bf16_f32 v86, v60, v61
    v_cvt_pk_bf16_f32 v87, v62, v63
    s_cbranch_vccz standalone__conformer_family_zipformer__speech_kernel_xs1
    global_store_dwordx4 v243, v[84:87], s[96:97] offset:1024
standalone__conformer_family_zipformer__speech_kernel_xj1:
    s_waitcnt lgkmcnt(1)
    v_mfma_f32_32x32x16_bf16 v[16:31], a[152:155], v[168:171], v[16:31]
    ds_read_b128 v[176:179], v1 offset:43008
    v_cvt_pk_bf16_f32 v88, v64, v65
    v_cvt_pk_bf16_f32 v89, v66, v67
    v_cvt_pk_bf16_f32 v90, v68, v69
    v_cvt_pk_bf16_f32 v91, v70, v71
    s_cbranch_vccz standalone__conformer_family_zipformer__speech_kernel_xs2
    global_store_dwordx4 v243, v[88:91], s[96:97] offset:2048
standalone__conformer_family_zipformer__speech_kernel_xj2:
    v_mfma_f32_32x32x16_bf16 v[32:47], a[156:159], v[168:171], v[32:47]
    v_cvt_pk_bf16_f32 v92, v72, v73
    v_cvt_pk_bf16_f32 v93, v74, v75
    v_cvt_pk_bf16_f32 v94, v76, v77
    v_cvt_pk_bf16_f32 v95, v78, v79
    s_cbranch_vccz standalone__conformer_family_zipformer__speech_kernel_xs3
    global_store_dwordx4 v243, v[92:95], s[96:97] offset:3072
standalone__conformer_family_zipformer__speech_kernel_xj3:
    s_waitcnt lgkmcnt(1)
    v_mfma_f32_32x32x16_bf16 v[16:31], a[160:163], v[172:175], v[16:31]
    ds_read_b128 v[156:159], v1 offset:45056
    s_waitcnt vmcnt(12)
    ds_read_b64_tr_b16 a[96:97], v254 offset:16384
    ds_read_b64_tr_b16 a[98:99], v254 offset:16896
    s_add_u32 m0, s21, 8192
    s_add_u32 s22, s22, 98304
    s_addc_u32 s23, s23, 0
    global_load_lds_dwordx4 v2, s[22:23] offset:0
    v_mfma_f32_32x32x16_bf16 v[32:47], a[164:167], v[172:175], v[32:47]
    ds_read_b64_tr_b16 a[100:101], v254 offset:17408
    ds_read_b64_tr_b16 a[102:103], v254 offset:17920
    global_load_lds_dwordx4 v3, s[22:23] offset:1024
    s_waitcnt lgkmcnt(5)
    v_mfma_f32_32x32x16_bf16 v[16:31], a[168:171], v[176:179], v[16:31]
    ds_read_b128 v[160:163], v1 offset:47104
    ds_read_b64_tr_b16 a[104:105], v254 offset:18432
    ds_read_b64_tr_b16 a[106:107], v254 offset:18944
    v_mfma_f32_32x32x16_bf16 v[32:47], a[172:175], v[176:179], v[32:47]
    ds_read_b64_tr_b16 a[108:109], v254 offset:19456
    ds_read_b64_tr_b16 a[110:111], v254 offset:19968
    s_waitcnt lgkmcnt(9)
    v_mfma_f32_32x32x16_bf16 v[16:31], a[176:179], v[156:159], v[16:31]
    ds_read_b128 v[164:167], v1 offset:49152
    global_load_lds_dwordx4 v4, s[22:23] offset:2048
    v_mfma_f32_32x32x16_bf16 v[32:47], a[180:183], v[156:159], v[32:47]
    s_waitcnt lgkmcnt(5)
    v_mfma_f32_32x32x16_bf16 v[16:31], a[184:187], v[160:163], v[16:31]
    ds_read_b128 v[168:171], v1 offset:51200
    global_load_lds_dwordx4 v5, s[22:23] offset:3072
    v_mfma_f32_32x32x16_bf16 v[32:47], a[188:191], v[160:163], v[32:47]
    s_waitcnt lgkmcnt(1)
    v_mfma_f32_32x32x16_bf16 v[16:31], a[192:195], v[164:167], v[16:31]
    ds_read_b128 v[172:175], v1 offset:53248
    s_waitcnt vmcnt(12)
    ds_read_b64_tr_b16 a[112:113], v254 offset:0
    ds_read_b64_tr_b16 a[114:115], v254 offset:512
    s_add_u32 m0, s21, 12288
    s_add_u32 s22, s22, 98304
    s_addc_u32 s23, s23, 0
    global_load_lds_dwordx4 v2, s[22:23] offset:0
    v_mfma_f32_32x32x16_bf16 v[32:47], a[196:199], v[164:167], v[32:47]
    ds_read_b64_tr_b16 a[116:117], v254 offset:1024
    ds_read_b64_tr_b16 a[118:119], v254 offset:1536
    s_waitcnt lgkmcnt(5)
    v_mfma_f32_32x32x16_bf16 v[16:31], a[200:203], v[168:171], v[16:31]
    ds_read_b128 v[176:179], v1 offset:55296
    ds_read_b64_tr_b16 a[120:121], v254 offset:2048
    ds_read_b64_tr_b16 a[122:123], v254 offset:2560
    global_load_lds_dwordx4 v3, s[22:23] offset:1024
    s_waitcnt vmcnt(6)
    s_cbranch_vccz standalone__conformer_family_zipformer__speech_kernel_xs4
    global_store_dword v241, v245, s[14:15] offset:128
standalone__conformer_family_zipformer__speech_kernel_xj4:
    v_mfma_f32_32x32x16_bf16 v[32:47], a[204:207], v[168:171], v[32:47]
    ds_read_b64_tr_b16 a[124:125], v254 offset:3072
    ds_read_b64_tr_b16 a[126:127], v254 offset:3584
    s_waitcnt lgkmcnt(9)
    v_mfma_f32_32x32x16_bf16 v[16:31], a[208:211], v[172:175], v[16:31]
    ds_read_b128 v[156:159], v1 offset:57344
    global_load_lds_dwordx4 v4, s[22:23] offset:2048
    v_mfma_f32_32x32x16_bf16 v[32:47], a[212:215], v[172:175], v[32:47]
    s_waitcnt lgkmcnt(5)
    v_mfma_f32_32x32x16_bf16 v[16:31], a[216:219], v[176:179], v[16:31]
    ds_read_b128 v[160:163], v1 offset:59392
    global_load_lds_dwordx4 v5, s[22:23] offset:3072
    v_mfma_f32_32x32x16_bf16 v[32:47], a[220:223], v[176:179], v[32:47]
    s_waitcnt lgkmcnt(1)
    v_mfma_f32_32x32x16_bf16 v[16:31], a[224:227], v[156:159], v[16:31]
    ds_read_b128 v[164:167], v1 offset:61440
    v_mfma_f32_32x32x16_bf16 v[32:47], a[228:231], v[156:159], v[32:47]
    ds_read_b64_tr_b16 a[128:129], v254 offset:4096
    ds_read_b64_tr_b16 a[130:131], v254 offset:4608
    s_add_u32 m0, s21, 16384
    s_add_u32 s22, s22, 98304
    s_addc_u32 s23, s23, 0
    global_load_lds_dwordx4 v2, s[22:23] offset:0
    s_waitcnt lgkmcnt(3)
    v_mfma_f32_32x32x16_bf16 v[16:31], a[232:235], v[160:163], v[16:31]
    ds_read_b128 v[168:171], v1 offset:63488
    ds_read_b64_tr_b16 a[132:133], v254 offset:5120
    ds_read_b64_tr_b16 a[134:135], v254 offset:5632
    global_load_lds_dwordx4 v3, s[22:23] offset:1024
    v_mfma_f32_32x32x16_bf16 v[32:47], a[236:239], v[160:163], v[32:47]
    ds_read_b64_tr_b16 a[136:137], v254 offset:6144
    ds_read_b64_tr_b16 a[138:139], v254 offset:6656
    s_waitcnt lgkmcnt(7)
    v_mfma_f32_32x32x16_bf16 v[16:31], a[240:243], v[164:167], v[16:31]
    ds_read_b64_tr_b16 a[140:141], v254 offset:7168
    ds_read_b64_tr_b16 a[142:143], v254 offset:7680
    global_load_dword v246, v240, s[14:15] offset:128 sc1
    v_mfma_f32_32x32x16_bf16 v[32:47], a[244:247], v[164:167], v[32:47]
    global_load_lds_dwordx4 v4, s[22:23] offset:2048
    s_waitcnt lgkmcnt(6)
    v_mfma_f32_32x32x16_bf16 v[16:31], a[248:251], v[168:171], v[16:31]
    v_mfma_f32_32x32x16_bf16 v[32:47], a[252:255], v[168:171], v[32:47]
    global_load_lds_dwordx4 v5, s[22:23] offset:3072
    s_mov_b32 s31, 0x3eb17218
    s_waitcnt vmcnt(2)
    s_mov_b32 s33, 400000
standalone__conformer_family_zipformer__speech_kernel_poll:
    v_readfirstlane_b32 s34, v246
    s_sub_u32 s33, s33, 1
    s_cselect_b32 s34, s27, s34
    s_cmp_lg_u32 s34, s27
    s_cbranch_scc1 standalone__conformer_family_zipformer__speech_kernel_pollc
    global_load_dwordx4 v[96:99], v251, s[96:97] offset:0 sc1
    global_load_dwordx4 v[100:103], v251, s[96:97] offset:1024 sc1
    global_load_dwordx4 v[104:107], v251, s[96:97] offset:2048 sc1
    global_load_dwordx4 v[108:111], v251, s[96:97] offset:3072 sc1
    global_load_dwordx2 v[14:15], v247, s[98:99] sc1
    global_load_dword v245, v240, s[14:15] sc1
    s_waitcnt vmcnt(5)
    v_dot2c_f32_bf16 v16, v96, v252
    ds_read_b64_tr_b16 a[144:145], v254 offset:8192
    ds_read_b64_tr_b16 a[146:147], v254 offset:8704
    s_add_u32 m0, s21, 0
    s_sub_u32 s22, s22, 294400
    s_subb_u32 s23, s23, 0
    global_load_lds_dwordx4 v2, s[22:23] offset:0
    v_dot2c_f32_bf16 v17, v96, v253
    ds_read_b64_tr_b16 a[148:149], v254 offset:9216
    ds_read_b64_tr_b16 a[150:151], v254 offset:9728
    global_load_lds_dwordx4 v3, s[22:23] offset:1024
    v_dot2c_f32_bf16 v18, v97, v252
    ds_read_b64_tr_b16 a[152:153], v254 offset:10240
    ds_read_b64_tr_b16 a[154:155], v254 offset:10752
    v_dot2c_f32_bf16 v19, v97, v253
    ds_read_b64_tr_b16 a[156:157], v254 offset:11264
    ds_read_b64_tr_b16 a[158:159], v254 offset:11776
    v_dot2c_f32_bf16 v20, v98, v252
    ds_read_b64_tr_b16 a[160:161], v254 offset:12288
    ds_read_b64_tr_b16 a[162:163], v254 offset:12800
    v_dot2c_f32_bf16 v21, v98, v253
    ds_read_b64_tr_b16 a[164:165], v254 offset:13312
    ds_read_b64_tr_b16 a[166:167], v254 offset:13824
    v_dot2c_f32_bf16 v22, v99, v252
    ds_read_b64_tr_b16 a[168:169], v254 offset:14336
    ds_read_b64_tr_b16 a[170:171], v254 offset:14848
    v_dot2c_f32_bf16 v23, v99, v253
    ds_read_b64_tr_b16 a[172:173], v254 offset:15360
    ds_read_b64_tr_b16 a[174:175], v254 offset:15872
    global_load_lds_dwordx4 v4, s[22:23] offset:2048
    s_waitcnt vmcnt(7)
    v_dot2c_f32_bf16 v24, v100, v252
    v_dot2c_f32_bf16 v25, v100, v253
    v_dot2c_f32_bf16 v26, v101, v252
    v_dot2c_f32_bf16 v27, v101, v253
    v_dot2c_f32_bf16 v28, v102, v252
    v_dot2c_f32_bf16 v29, v102, v253
    v_dot2c_f32_bf16 v30, v103, v252
    v_dot2c_f32_bf16 v31, v103, v253
    s_waitcnt vmcnt(6)
    v_dot2c_f32_bf16 v32, v104, v252
    v_dot2c_f32_bf16 v33, v104, v253
    v_dot2c_f32_bf16 v34, v105, v252
    v_dot2c_f32_bf16 v35, v105, v253
    v_dot2c_f32_bf16 v36, v106, v252
    v_dot2c_f32_bf16 v37, v106, v253
    global_load_lds_dwordx4 v5, s[22:23] offset:3072
    v_dot2c_f32_bf16 v38, v107, v252
    v_dot2c_f32_bf16 v39, v107, v253
    s_waitcnt vmcnt(6)
    v_dot2c_f32_bf16 v40, v108, v252
    v_dot2c_f32_bf16 v41, v108, v253
    v_dot2c_f32_bf16 v42, v109, v252
    v_dot2c_f32_bf16 v43, v109, v253
    v_dot2c_f32_bf16 v44, v110, v252
    v_dot2c_f32_bf16 v45, v110, v253
    v_dot2c_f32_bf16 v46, v111, v252
    v_dot2c_f32_bf16 v47, v111, v253
    s_nop 2
    v_pk_add_f32 v[196:197], v[16:17], v[18:19]
    v_pk_mul_f32 v[198:199], v[16:17], v[16:17]
    s_waitcnt lgkmcnt(15)
    s_add_u32 m0, s21, 4096
    s_add_u32 s22, s22, 98304
    s_addc_u32 s23, s23, 0
    global_load_lds_dwordx4 v2, s[22:23] offset:0
    v_pk_fma_f32 v[198:199], v[18:19], v[18:19], v[198:199]
    v_pk_add_f32 v[196:197], v[196:197], v[20:21]
    v_pk_fma_f32 v[198:199], v[20:21], v[20:21], v[198:199]
    v_pk_add_f32 v[196:197], v[196:197], v[22:23]
    v_pk_fma_f32 v[198:199], v[22:23], v[22:23], v[198:199]
    v_pk_add_f32 v[196:197], v[196:197], v[24:25]
    v_pk_fma_f32 v[198:199], v[24:25], v[24:25], v[198:199]
    v_pk_add_f32 v[196:197], v[196:197], v[26:27]
    v_pk_fma_f32 v[198:199], v[26:27], v[26:27], v[198:199]
    v_pk_add_f32 v[196:197], v[196:197], v[28:29]
    v_pk_fma_f32 v[198:199], v[28:29], v[28:29], v[198:199]
    v_pk_add_f32 v[196:197], v[196:197], v[30:31]
    v_pk_fma_f32 v[198:199], v[30:31], v[30:31], v[198:199]
    global_load_lds_dwordx4 v3, s[22:23] offset:1024
    v_pk_add_f32 v[196:197], v[196:197], v[32:33]
    v_pk_fma_f32 v[198:199], v[32:33], v[32:33], v[198:199]
    v_pk_add_f32 v[196:197], v[196:197], v[34:35]
    v_pk_fma_f32 v[198:199], v[34:35], v[34:35], v[198:199]
    v_pk_add_f32 v[196:197], v[196:197], v[36:37]
    v_pk_fma_f32 v[198:199], v[36:37], v[36:37], v[198:199]
    ds_read_b64_tr_b16 a[176:177], v254 offset:16384
    ds_read_b64_tr_b16 a[178:179], v254 offset:16896
    v_pk_add_f32 v[196:197], v[196:197], v[38:39]
    ds_read_b64_tr_b16 a[180:181], v254 offset:17408
    ds_read_b64_tr_b16 a[182:183], v254 offset:17920
    v_pk_fma_f32 v[198:199], v[38:39], v[38:39], v[198:199]
    ds_read_b64_tr_b16 a[184:185], v254 offset:18432
    ds_read_b64_tr_b16 a[186:187], v254 offset:18944
    v_pk_add_f32 v[196:197], v[196:197], v[40:41]
    ds_read_b64_tr_b16 a[188:189], v254 offset:19456
    ds_read_b64_tr_b16 a[190:191], v254 offset:19968
    global_load_lds_dwordx4 v4, s[22:23] offset:2048
    v_pk_fma_f32 v[198:199], v[40:41], v[40:41], v[198:199]
    v_pk_add_f32 v[196:197], v[196:197], v[42:43]
    v_pk_fma_f32 v[198:199], v[42:43], v[42:43], v[198:199]
    v_pk_add_f32 v[196:197], v[196:197], v[44:45]
    v_pk_fma_f32 v[198:199], v[44:45], v[44:45], v[198:199]
    v_pk_add_f32 v[196:197], v[196:197], v[46:47]
    v_pk_fma_f32 v[198:199], v[46:47], v[46:47], v[198:199]
    v_add_f32 v196, v196, v197
    v_add_f32 v197, v198, v199
    v_mov_b32 v198, v196
    v_mov_b32 v199, v197
    s_nop 1
    v_permlane32_swap_b32 v196, v198
    v_permlane32_swap_b32 v197, v199
    v_pk_add_f32 v[196:197], v[196:197], v[198:199]
    ds_write_b64 v8, v[196:197] offset:2048
    global_load_lds_dwordx4 v5, s[22:23] offset:3072
    s_waitcnt lgkmcnt(0)
    s_barrier
    ds_read_b64 v[196:197], v9 offset:2048
    ds_read_b64 v[198:199], v9 offset:2304
    ds_read_b64 v[200:201], v9 offset:2560
    ds_read_b64 v[202:203], v9 offset:2816
    s_waitcnt vmcnt(8)
    s_mov_b32 s33, 400000
standalone__conformer_family_zipformer__speech_kernel_tg0:
    v_readfirstlane_b32 s100, v14
    v_readfirstlane_b32 s101, v15
    s_sub_u32 s33, s33, 1
    s_cselect_b32 s101, 1, s101
    s_cmp_eq_u32 s101, 0
    s_cbranch_scc1 standalone__conformer_family_zipformer__speech_kernel_tc0
    v_readfirstlane_b32 s35, v245
    s_nop 0
    s_cmp_lg_u32 s35, s28
    s_cbranch_scc1 standalone__conformer_family_zipformer__speech_kernel_echoc
standalone__conformer_family_zipformer__speech_kernel_echo:
    s_waitcnt vmcnt(4)
    ds_read_b64_tr_b16 a[192:193], v254 offset:0
    ds_read_b64_tr_b16 a[194:195], v254 offset:512
    ds_read_b64_tr_b16 a[196:197], v254 offset:1024
    ds_read_b64_tr_b16 a[198:199], v254 offset:1536
    ds_read_b64_tr_b16 a[200:201], v254 offset:2048
    ds_read_b64_tr_b16 a[202:203], v254 offset:2560
    ds_read_b64_tr_b16 a[204:205], v254 offset:3072
    ds_read_b64_tr_b16 a[206:207], v254 offset:3584
    s_waitcnt vmcnt(0)
    ds_read_b64_tr_b16 a[208:209], v254 offset:4096
    ds_read_b64_tr_b16 a[210:211], v254 offset:4608
    ds_read_b64_tr_b16 a[212:213], v254 offset:5120
    ds_read_b64_tr_b16 a[214:215], v254 offset:5632
    ds_read_b64_tr_b16 a[216:217], v254 offset:6144
    ds_read_b64_tr_b16 a[218:219], v254 offset:6656
    ds_read_b64_tr_b16 a[220:221], v254 offset:7168
    ds_read_b64_tr_b16 a[222:223], v254 offset:7680
    s_mov_b32 s31, 0x3e38aa3b
    s_waitcnt lgkmcnt(15)
    v_pk_add_f32 v[196:197], v[196:197], v[198:199]
    v_pk_add_f32 v[200:201], v[200:201], v[202:203]
    v_pk_add_f32 v[196:197], v[196:197], v[200:201]
    v_mul_f32 v198, 0x3b800000, v196
    s_add_u32 m0, s21, 8192
    s_add_u32 s22, s22, 98304
    s_addc_u32 s23, s23, 0
    global_load_lds_dwordx4 v2, s[22:23] offset:0
    v_mul_f32 v197, 0x3b800000, v197
    v_fma_f32 v197, -v198, v198, v197
    v_max_f32 v197, 0, v197
    v_add_f32 v197, 0x38ae990f, v197
    global_load_lds_dwordx4 v3, s[22:23] offset:1024
    v_rsq_f32 v196, v197
    s_nop 0
    v_mul_f32_e64 v198, -v198, v196
    v_pk_fma_f32 v[112:113], v[16:17], v[196:197], v[198:199] op_sel_hi:[1,0,0]
    global_load_lds_dwordx4 v4, s[22:23] offset:2048
    v_pk_fma_f32 v[114:115], v[18:19], v[196:197], v[198:199] op_sel_hi:[1,0,0]
    v_pk_fma_f32 v[116:117], v[20:21], v[196:197], v[198:199] op_sel_hi:[1,0,0]
    v_pk_fma_f32 v[118:119], v[22:23], v[196:197], v[198:199] op_sel_hi:[1,0,0]
    v_pk_fma_f32 v[120:121], v[24:25], v[196:197], v[198:199] op_sel_hi:[1,0,0]
    global_load_lds_dwordx4 v5, s[22:23] offset:3072
    v_pk_fma_f32 v[122:123], v[26:27], v[196:197], v[198:199] op_sel_hi:[1,0,0]
    v_pk_fma_f32 v[124:125], v[28:29], v[196:197], v[198:199] op_sel_hi:[1,0,0]
    v_pk_fma_f32 v[126:127], v[30:31], v[196:197], v[198:199] op_sel_hi:[1,0,0]
    v_pk_fma_f32 v[128:129], v[32:33], v[196:197], v[198:199] op_sel_hi:[1,0,0]
    s_add_u32 m0, s21, 12288
    s_add_u32 s22, s22, 98304
    s_addc_u32 s23, s23, 0
    global_load_lds_dwordx4 v2, s[22:23] offset:0
    v_pk_fma_f32 v[130:131], v[34:35], v[196:197], v[198:199] op_sel_hi:[1,0,0]
    v_pk_fma_f32 v[132:133], v[36:37], v[196:197], v[198:199] op_sel_hi:[1,0,0]
    v_pk_fma_f32 v[134:135], v[38:39], v[196:197], v[198:199] op_sel_hi:[1,0,0]
    v_pk_fma_f32 v[136:137], v[40:41], v[196:197], v[198:199] op_sel_hi:[1,0,0]
    global_load_lds_dwordx4 v3, s[22:23] offset:1024
    v_pk_fma_f32 v[138:139], v[42:43], v[196:197], v[198:199] op_sel_hi:[1,0,0]
    v_pk_fma_f32 v[140:141], v[44:45], v[196:197], v[198:199] op_sel_hi:[1,0,0]
    v_pk_fma_f32 v[142:143], v[46:47], v[196:197], v[198:199] op_sel_hi:[1,0,0]
    v_cvt_pk_bf16_f32 v48, v112, v113
    global_load_lds_dwordx4 v4, s[22:23] offset:2048
    v_cvt_pk_bf16_f32 v49, v114, v115
    v_cvt_pk_bf16_f32 v50, v116, v117
    v_cvt_pk_bf16_f32 v51, v118, v119
    s_cbranch_vccz standalone__conformer_family_zipformer__speech_kernel_xs8
    global_store_dwordx4 v251, v[48:51], s[96:97] offset:0
standalone__conformer_family_zipformer__speech_kernel_xj8:
    ds_write_b128 v236, v[48:51] offset:0
    global_load_lds_dwordx4 v5, s[22:23] offset:3072
    v_cvt_pk_bf16_f32 v52, v120, v121
    v_cvt_pk_bf16_f32 v53, v122, v123
    v_cvt_pk_bf16_f32 v54, v124, v125
    v_cvt_pk_bf16_f32 v55, v126, v127
    s_cbranch_vccz standalone__conformer_family_zipformer__speech_kernel_xs9
    global_store_dwordx4 v251, v[52:55], s[96:97] offset:1024
standalone__conformer_family_zipformer__speech_kernel_xj9:
    ds_write_b128 v236, v[52:55] offset:1024
    v_cvt_pk_bf16_f32 v56, v128, v129
    v_cvt_pk_bf16_f32 v57, v130, v131
    v_cvt_pk_bf16_f32 v58, v132, v133
    v_cvt_pk_bf16_f32 v59, v134, v135
    s_cbranch_vccz standalone__conformer_family_zipformer__speech_kernel_xs10
    global_store_dwordx4 v251, v[56:59], s[96:97] offset:2048
standalone__conformer_family_zipformer__speech_kernel_xj10:
    ds_write_b128 v236, v[56:59] offset:2048
    v_cvt_pk_bf16_f32 v60, v136, v137
    v_cvt_pk_bf16_f32 v61, v138, v139
    v_cvt_pk_bf16_f32 v62, v140, v141
    v_cvt_pk_bf16_f32 v63, v142, v143
    s_cbranch_vccz standalone__conformer_family_zipformer__speech_kernel_xs11
    global_store_dwordx4 v251, v[60:63], s[96:97] offset:3072
standalone__conformer_family_zipformer__speech_kernel_xj11:
    ds_write_b128 v236, v[60:63] offset:3072
    s_waitcnt lgkmcnt(0)
    s_barrier
    ds_read_b128 a[0:3], v1 offset:0
    ds_read_b128 a[4:7], v1 offset:1024
    ds_read_b128 a[8:11], v1 offset:2048
    ds_read_b128 a[12:15], v1 offset:3072
    s_mov_b32 s30, 0x3eb17218
    s_waitcnt lgkmcnt(3)
    v_mfma_f32_32x32x16_bf16 v[204:219], a[64:67], a[0:3], 0
    ds_read_b128 a[16:19], v1 offset:4096
    s_lshl_b32 s46, s52, 12
    s_add_u32 s46, s46, s51
    s_add_u32 s46, s46, 0
    v_add_u32 v156, s46, v1
    s_waitcnt lgkmcnt(3)
    v_mfma_f32_32x32x16_bf16 v[204:219], a[68:71], a[4:7], v[204:219]
    ds_read_b128 a[20:23], v1 offset:5120
    s_lshl_b32 s46, s52, 13
    s_add_u32 s46, s46, s51
    s_add_u32 s46, s46, 4198400
    v_add_u32 v157, s46, v1
    s_waitcnt lgkmcnt(3)
    v_mfma_f32_32x32x16_bf16 v[204:219], a[72:75], a[8:11], v[204:219]
    ds_read_b128 a[24:27], v1 offset:6144
    s_lshl_b32 s46, s53, 12
    s_add_u32 s46, s46, s51
    s_add_u32 s46, s46, 0
    v_add_u32 v158, s46, v1
    s_waitcnt lgkmcnt(3)
    v_mfma_f32_32x32x16_bf16 v[204:219], a[76:79], a[12:15], v[204:219]
    ds_read_b128 a[28:31], v1 offset:7168
    s_lshl_b32 s46, s53, 13
    s_add_u32 s46, s46, s51
    s_add_u32 s46, s46, 4198400
    v_add_u32 v159, s46, v1
    s_waitcnt lgkmcnt(3)
    v_mfma_f32_32x32x16_bf16 v[204:219], a[80:83], a[16:19], v[204:219]
    ds_read_b128 a[32:35], v1 offset:8192
    v_mul_f32 v16, s30, v16
    v_mul_f32 v17, s30, v17
    v_cvt_pk_bf16_f32 v180, v16, v17
    v_mul_f32 v18, s30, v18
    s_waitcnt lgkmcnt(3)
    v_mfma_f32_32x32x16_bf16 v[204:219], a[84:87], a[20:23], v[204:219]
    ds_read_b128 a[36:39], v1 offset:9216
    v_mul_f32 v19, s30, v19
    v_cvt_pk_bf16_f32 v181, v18, v19
    v_mul_f32 v20, s30, v20
    v_mul_f32 v21, s30, v21
    s_waitcnt lgkmcnt(3)
    v_mfma_f32_32x32x16_bf16 v[204:219], a[88:91], a[24:27], v[204:219]
    ds_read_b128 a[40:43], v1 offset:10240
    v_cvt_pk_bf16_f32 v182, v20, v21
    v_mul_f32 v22, s30, v22
    v_mul_f32 v23, s30, v23
    v_cvt_pk_bf16_f32 v183, v22, v23
    s_waitcnt vmcnt(0)
    s_cbranch_vccz standalone__conformer_family_zipformer__speech_kernel_xs12
    global_store_dwordx2 v241, v[14:15], s[14:15] offset:192
standalone__conformer_family_zipformer__speech_kernel_xj12:
    s_waitcnt lgkmcnt(3)
    v_mfma_f32_32x32x16_bf16 v[204:219], a[92:95], a[28:31], v[204:219]
    ds_read_b128 a[44:47], v1 offset:11264
    v_mul_f32 v24, s30, v24
    v_mul_f32 v25, s30, v25
    v_cvt_pk_bf16_f32 v184, v24, v25
    v_mul_f32 v26, s30, v26
    s_waitcnt lgkmcnt(3)
    v_mfma_f32_32x32x16_bf16 v[204:219], a[96:99], a[32:35], v[204:219]
    ds_read_b128 a[48:51], v1 offset:12288
    v_mul_f32 v27, s30, v27
    v_cvt_pk_bf16_f32 v185, v26, v27
    v_mul_f32 v28, s30, v28
    v_mul_f32 v29, s30, v29
    s_waitcnt lgkmcnt(3)
    v_mfma_f32_32x32x16_bf16 v[204:219], a[100:103], a[36:39], v[204:219]
    ds_read_b128 a[52:55], v1 offset:13312
    v_cvt_pk_bf16_f32 v186, v28, v29
    v_mul_f32 v30, s30, v30
    v_mul_f32 v31, s30, v31
    v_cvt_pk_bf16_f32 v187, v30, v31
    s_waitcnt lgkmcnt(3)
    v_mfma_f32_32x32x16_bf16 v[204:219], a[104:107], a[40:43], v[204:219]
    ds_read_b128 a[56:59], v1 offset:14336
    v_mul_f32 v32, s30, v32
    v_mul_f32 v33, s30, v33
    v_cvt_pk_bf16_f32 v188, v32, v33
    v_mul_f32 v34, s30, v34
    s_waitcnt lgkmcnt(3)
    v_mfma_f32_32x32x16_bf16 v[204:219], a[108:111], a[44:47], v[204:219]
    ds_read_b128 a[60:63], v1 offset:15360
    v_mul_f32 v35, s30, v35
    v_cvt_pk_bf16_f32 v189, v34, v35
    v_mul_f32 v36, s30, v36
    v_mul_f32 v37, s30, v37
    s_waitcnt lgkmcnt(3)
    v_mfma_f32_32x32x16_bf16 v[204:219], a[112:115], a[48:51], v[204:219]
    v_cvt_pk_bf16_f32 v190, v36, v37
    v_mul_f32 v38, s30, v38
    v_mul_f32 v39, s30, v39
    v_cvt_pk_bf16_f32 v191, v38, v39
    s_waitcnt lgkmcnt(2)
    v_mfma_f32_32x32x16_bf16 v[204:219], a[116:119], a[52:55], v[204:219]
    v_mul_f32 v40, s30, v40
    v_mul_f32 v41, s30, v41
    v_cvt_pk_bf16_f32 v192, v40, v41
    v_mul_f32 v42, s30, v42
    s_waitcnt lgkmcnt(1)
    v_mfma_f32_32x32x16_bf16 v[204:219], a[120:123], a[56:59], v[204:219]
    v_mul_f32 v43, s30, v43
    v_cvt_pk_bf16_f32 v193, v42, v43
    v_mul_f32 v44, s30, v44
    v_mul_f32 v45, s30, v45
    s_waitcnt lgkmcnt(0)
    v_mfma_f32_32x32x16_bf16 v[204:219], a[124:127], a[60:63], v[204:219]
    v_cvt_pk_bf16_f32 v194, v44, v45
    v_mul_f32 v46, s30, v46
    v_mul_f32 v47, s30, v47
    v_cvt_pk_bf16_f32 v195, v46, v47
    v_mfma_f32_32x32x16_bf16 v[220:235], a[128:131], a[0:3], 0
    ds_read_b64_tr_b16 a[224:225], v254 offset:8192
    ds_read_b64_tr_b16 a[226:227], v254 offset:8704
    global_load_dwordx2 v[244:245], v240, s[14:15] offset:192 sc1
    v_mfma_f32_32x32x16_bf16 v[220:235], a[132:135], a[4:7], v[220:235]
    ds_read_b64_tr_b16 a[228:229], v254 offset:9216
    ds_read_b64_tr_b16 a[230:231], v254 offset:9728
    v_mfma_f32_32x32x16_bf16 v[220:235], a[136:139], a[8:11], v[220:235]
    ds_read_b64_tr_b16 a[232:233], v254 offset:10240
    ds_read_b64_tr_b16 a[234:235], v254 offset:10752
    v_mfma_f32_32x32x16_bf16 v[220:235], a[140:143], a[12:15], v[220:235]
    ds_read_b64_tr_b16 a[236:237], v254 offset:11264
    ds_read_b64_tr_b16 a[238:239], v254 offset:11776
    v_mul_f32 v204, s31, v204
    v_mul_f32 v205, s31, v205
    v_mul_f32 v206, s31, v206
    v_mul_f32 v207, s31, v207
    v_mfma_f32_32x32x16_bf16 v[220:235], a[144:147], a[16:19], v[220:235]
    v_mul_f32 v208, s31, v208
    v_mul_f32 v209, s31, v209
    v_mul_f32 v210, s31, v210
    v_mul_f32 v211, s31, v211
    v_mfma_f32_32x32x16_bf16 v[220:235], a[148:151], a[20:23], v[220:235]
    v_mul_f32 v212, s31, v212
    v_mul_f32 v213, s31, v213
    v_mul_f32 v214, s31, v214
    v_mul_f32 v215, s31, v215
    v_mfma_f32_32x32x16_bf16 v[220:235], a[152:155], a[24:27], v[220:235]
    v_mul_f32 v216, s31, v216
    v_mul_f32 v217, s31, v217
    v_mul_f32 v218, s31, v218
    v_mfma_f32_32x32x16_bf16 v[220:235], a[156:159], a[28:31], v[220:235]
    v_mul_f32 v219, s31, v219
    v_cvt_pk_bf16_f32 v64, v204, v205
    v_cvt_pk_bf16_f32 v65, v206, v207
    v_cvt_pk_bf16_f32 v66, v208, v209
    v_mfma_f32_32x32x16_bf16 v[220:235], a[160:163], a[32:35], v[220:235]
    v_cvt_pk_bf16_f32 v67, v210, v211
    v_cvt_pk_bf16_f32 v68, v212, v213
    v_cvt_pk_bf16_f32 v69, v214, v215
    v_mfma_f32_32x32x16_bf16 v[220:235], a[164:167], a[36:39], v[220:235]
    ds_read_b64_tr_b16 a[240:241], v254 offset:12288
    ds_read_b64_tr_b16 a[242:243], v254 offset:12800
    v_cvt_pk_bf16_f32 v70, v216, v217
    v_cvt_pk_bf16_f32 v71, v218, v219
    v_mfma_f32_32x32x16_bf16 v[220:235], a[168:171], a[40:43], v[220:235]
    ds_read_b64_tr_b16 a[244:245], v254 offset:13312
    ds_read_b64_tr_b16 a[246:247], v254 offset:13824
    v_mfma_f32_32x32x16_bf16 v[220:235], a[172:175], a[44:47], v[220:235]
    ds_read_b64_tr_b16 a[248:249], v254 offset:14336
    ds_read_b64_tr_b16 a[250:251], v254 offset:14848
    s_waitcnt vmcnt(0)
    s_mov_b32 s33, 400000
standalone__conformer_family_zipformer__speech_kernel_p2:
    v_readfirstlane_b32 s34, v244
    v_readfirstlane_b32 s35, v245
    s_sub_u32 s33, s33, 1
    s_cselect_b64 s[34:35], s[100:101], s[34:35]
    s_cmp_lg_u64 s[34:35], s[100:101]
    s_cbranch_scc1 standalone__conformer_family_zipformer__speech_kernel_p2c
    s_lshl_b32 s46, s20, 12
    s_add_u32 m0, s46, 16384
    s_nop 0
    global_load_lds_dwordx4 v243, s[96:97] offset:0 sc1
    global_load_lds_dwordx4 v243, s[96:97] offset:1024 sc1
    global_load_lds_dwordx4 v243, s[96:97] offset:2048 sc1
    global_load_lds_dwordx4 v243, s[96:97] offset:3072 sc1
    v_mfma_f32_32x32x16_bf16 v[220:235], a[176:179], a[48:51], v[220:235]
    ds_read_b64_tr_b16 a[252:253], v254 offset:15360
    ds_read_b64_tr_b16 a[254:255], v254 offset:15872
    global_store_dwordx4 v237, v[180:183], s[14:15] offset:0 sc1
    v_mfma_f32_32x32x16_bf16 v[220:235], a[180:183], a[52:55], v[220:235]
    v_mfma_f32_32x32x16_bf16 v[220:235], a[184:187], a[56:59], v[220:235]
    global_store_dwordx4 v237, v[184:187], s[14:15] offset:1024 sc1
    v_mfma_f32_32x32x16_bf16 v[220:235], a[188:191], a[60:63], v[220:235]
    v_mfma_f32_32x32x16_bf16 v[204:219], a[0:3], a[192:195], 0
    global_store_dwordx4 v237, v[188:191], s[14:15] offset:2048 sc1
    v_mfma_f32_32x32x16_bf16 v[204:219], a[4:7], a[196:199], v[204:219]
    v_mfma_f32_32x32x16_bf16 v[204:219], a[8:11], a[200:203], v[204:219]
    global_store_dwordx4 v237, v[192:195], s[14:15] offset:3072 sc1
    v_mfma_f32_32x32x16_bf16 v[204:219], a[12:15], a[204:207], v[204:219]
    v_cvt_pk_bf16_f32 v72, v220, v221
    v_cvt_pk_bf16_f32 v73, v222, v223
    v_mfma_f32_32x32x16_bf16 v[204:219], a[16:19], a[208:211], v[204:219]
    global_store_dwordx4 v156, v[64:67], s[14:15] offset:0 sc1
    v_cvt_pk_bf16_f32 v74, v224, v225
    v_mfma_f32_32x32x16_bf16 v[204:219], a[20:23], a[212:215], v[204:219]
    v_cvt_pk_bf16_f32 v75, v226, v227
    v_mfma_f32_32x32x16_bf16 v[204:219], a[24:27], a[216:219], v[204:219]
    global_store_dwordx4 v156, v[68:71], s[14:15] offset:1024 sc1
    v_cvt_pk_bf16_f32 v76, v228, v229
    v_mfma_f32_32x32x16_bf16 v[204:219], a[28:31], a[220:223], v[204:219]
    v_cvt_pk_bf16_f32 v77, v230, v231
    v_cvt_pk_bf16_f32 v78, v232, v233
    s_waitcnt lgkmcnt(8)
    v_mfma_f32_32x32x16_bf16 v[204:219], a[32:35], a[224:227], v[204:219]
    global_store_dwordx4 v157, v[72:75], s[14:15] offset:-4096 sc1
    v_cvt_pk_bf16_f32 v79, v234, v235
    v_mfma_f32_32x32x16_bf16 v[204:219], a[36:39], a[228:231], v[204:219]
    v_mfma_f32_32x32x16_bf16 v[204:219], a[40:43], a[232:235], v[204:219]
    global_store_dwordx4 v157, v[76:79], s[14:15] offset:-3072 sc1
    v_mfma_f32_32x32x16_bf16 v[204:219], a[44:47], a[236:239], v[204:219]
    s_waitcnt lgkmcnt(4)
    v_mfma_f32_32x32x16_bf16 v[204:219], a[48:51], a[240:243], v[204:219]
    v_mfma_f32_32x32x16_bf16 v[204:219], a[52:55], a[244:247], v[204:219]
    s_waitcnt lgkmcnt(2)
    v_mfma_f32_32x32x16_bf16 v[204:219], a[56:59], a[248:251], v[204:219]
    s_waitcnt lgkmcnt(0)
    v_mfma_f32_32x32x16_bf16 v[204:219], a[60:63], a[252:255], v[204:219]
    s_waitcnt vmcnt(8)
    s_barrier
    ds_read_b128 v[80:83], v1 offset:16384
    ds_read_b128 v[84:87], v1 offset:17408
    ds_read_b128 v[88:91], v1 offset:18432
    ds_read_b128 v[92:95], v1 offset:19456
    s_waitcnt lgkmcnt(3)
    v_mfma_f32_32x32x16_bf16 v[220:235], a[64:67], v[80:83], 0
    ds_read_b128 v[96:99], v1 offset:20480
    s_waitcnt lgkmcnt(3)
    v_mfma_f32_32x32x16_bf16 v[220:235], a[68:71], v[84:87], v[220:235]
    ds_read_b128 v[100:103], v1 offset:21504
    s_waitcnt lgkmcnt(3)
    v_mfma_f32_32x32x16_bf16 v[220:235], a[72:75], v[88:91], v[220:235]
    ds_read_b128 v[104:107], v1 offset:22528
    s_waitcnt lgkmcnt(3)
    v_mfma_f32_32x32x16_bf16 v[220:235], a[76:79], v[92:95], v[220:235]
    ds_read_b128 v[108:111], v1 offset:23552
    v_cvt_pk_bf16_f32 v180, v204, v205
    v_cvt_pk_bf16_f32 v181, v206, v207
    s_waitcnt lgkmcnt(3)
    v_mfma_f32_32x32x16_bf16 v[220:235], a[80:83], v[96:99], v[220:235]
    ds_read_b128 v[112:115], v1 offset:24576
    v_cvt_pk_bf16_f32 v182, v208, v209
    s_waitcnt lgkmcnt(3)
    v_mfma_f32_32x32x16_bf16 v[220:235], a[84:87], v[100:103], v[220:235]
    ds_read_b128 v[116:119], v1 offset:25600
    v_cvt_pk_bf16_f32 v183, v210, v211
    s_waitcnt lgkmcnt(3)
    v_mfma_f32_32x32x16_bf16 v[220:235], a[88:91], v[104:107], v[220:235]
    ds_read_b128 v[120:123], v1 offset:26624
    global_store_dwordx4 v157, v[180:183], s[14:15] offset:0 sc1
    v_cvt_pk_bf16_f32 v184, v212, v213
    s_waitcnt lgkmcnt(3)
    v_mfma_f32_32x32x16_bf16 v[220:235], a[92:95], v[108:111], v[220:235]
    ds_read_b128 v[124:127], v1 offset:27648
    v_cvt_pk_bf16_f32 v185, v214, v215
    v_cvt_pk_bf16_f32 v186, v216, v217
    s_waitcnt lgkmcnt(3)
    v_mfma_f32_32x32x16_bf16 v[220:235], a[96:99], v[112:115], v[220:235]
    ds_read_b128 v[128:131], v1 offset:28672
    v_cvt_pk_bf16_f32 v187, v218, v219
    s_waitcnt lgkmcnt(3)
    v_mfma_f32_32x32x16_bf16 v[220:235], a[100:103], v[116:119], v[220:235]
    ds_read_b128 v[132:135], v1 offset:29696
    s_waitcnt lgkmcnt(3)
    v_mfma_f32_32x32x16_bf16 v[220:235], a[104:107], v[120:123], v[220:235]
    ds_read_b128 v[136:139], v1 offset:30720
    global_store_dwordx4 v157, v[184:187], s[14:15] offset:1024 sc1
    s_waitcnt lgkmcnt(3)
    v_mfma_f32_32x32x16_bf16 v[220:235], a[108:111], v[124:127], v[220:235]
    ds_read_b128 v[140:143], v1 offset:31744
    s_waitcnt lgkmcnt(3)
    v_mfma_f32_32x32x16_bf16 v[220:235], a[112:115], v[128:131], v[220:235]
    s_waitcnt lgkmcnt(2)
    v_mfma_f32_32x32x16_bf16 v[220:235], a[116:119], v[132:135], v[220:235]
    s_waitcnt lgkmcnt(1)
    v_mfma_f32_32x32x16_bf16 v[220:235], a[120:123], v[136:139], v[220:235]
    s_waitcnt lgkmcnt(0)
    v_mfma_f32_32x32x16_bf16 v[220:235], a[124:127], v[140:143], v[220:235]
    v_mfma_f32_32x32x16_bf16 v[204:219], a[128:131], v[80:83], 0
    v_mfma_f32_32x32x16_bf16 v[204:219], a[132:135], v[84:87], v[204:219]
    v_mfma_f32_32x32x16_bf16 v[204:219], a[136:139], v[88:91], v[204:219]
    v_mfma_f32_32x32x16_bf16 v[204:219], a[140:143], v[92:95], v[204:219]
    v_mul_f32 v220, s31, v220
    v_mul_f32 v221, s31, v221
    v_mul_f32 v222, s31, v222
    v_mul_f32 v223, s31, v223
    v_mfma_f32_32x32x16_bf16 v[204:219], a[144:147], v[96:99], v[204:219]
    v_mul_f32 v224, s31, v224
    v_mul_f32 v225, s31, v225
    v_mul_f32 v226, s31, v226
    v_mul_f32 v227, s31, v227
    v_mfma_f32_32x32x16_bf16 v[204:219], a[148:151], v[100:103], v[204:219]
    v_mul_f32 v228, s31, v228
    v_mul_f32 v229, s31, v229
    v_mul_f32 v230, s31, v230
    v_mul_f32 v231, s31, v231
    v_mfma_f32_32x32x16_bf16 v[204:219], a[152:155], v[104:107], v[204:219]
    v_mul_f32 v232, s31, v232
    v_mul_f32 v233, s31, v233
    v_mul_f32 v234, s31, v234
    v_mfma_f32_32x32x16_bf16 v[204:219], a[156:159], v[108:111], v[204:219]
    v_mul_f32 v235, s31, v235
    v_cvt_pk_bf16_f32 v188, v220, v221
    v_cvt_pk_bf16_f32 v189, v222, v223
    v_cvt_pk_bf16_f32 v190, v224, v225
    v_mfma_f32_32x32x16_bf16 v[204:219], a[160:163], v[112:115], v[204:219]
    v_cvt_pk_bf16_f32 v191, v226, v227
    v_cvt_pk_bf16_f32 v192, v228, v229
    v_cvt_pk_bf16_f32 v193, v230, v231
    v_mfma_f32_32x32x16_bf16 v[204:219], a[164:167], v[116:119], v[204:219]
    v_cvt_pk_bf16_f32 v194, v232, v233
    v_cvt_pk_bf16_f32 v195, v234, v235
    v_mfma_f32_32x32x16_bf16 v[204:219], a[168:171], v[120:123], v[204:219]
    global_store_dwordx4 v158, v[188:191], s[14:15] offset:0 sc1
    v_mfma_f32_32x32x16_bf16 v[204:219], a[172:175], v[124:127], v[204:219]
    v_mfma_f32_32x32x16_bf16 v[204:219], a[176:179], v[128:131], v[204:219]
    global_store_dwordx4 v158, v[192:195], s[14:15] offset:1024 sc1
    v_mfma_f32_32x32x16_bf16 v[204:219], a[180:183], v[132:135], v[204:219]
    v_mfma_f32_32x32x16_bf16 v[204:219], a[184:187], v[136:139], v[204:219]
    v_mfma_f32_32x32x16_bf16 v[204:219], a[188:191], v[140:143], v[204:219]
    v_mfma_f32_32x32x16_bf16 v[220:235], v[80:83], a[192:195], 0
    v_mfma_f32_32x32x16_bf16 v[220:235], v[84:87], a[196:199], v[220:235]
    v_mfma_f32_32x32x16_bf16 v[220:235], v[88:91], a[200:203], v[220:235]
    v_mfma_f32_32x32x16_bf16 v[220:235], v[92:95], a[204:207], v[220:235]
    v_cvt_pk_bf16_f32 v180, v204, v205
    v_cvt_pk_bf16_f32 v181, v206, v207
    v_mfma_f32_32x32x16_bf16 v[220:235], v[96:99], a[208:211], v[220:235]
    v_cvt_pk_bf16_f32 v182, v208, v209
    v_mfma_f32_32x32x16_bf16 v[220:235], v[100:103], a[212:215], v[220:235]
    v_cvt_pk_bf16_f32 v183, v210, v211
    v_mfma_f32_32x32x16_bf16 v[220:235], v[104:107], a[216:219], v[220:235]
    global_store_dwordx4 v159, v[180:183], s[14:15] offset:-4096 sc1
    v_cvt_pk_bf16_f32 v184, v212, v213
    v_mfma_f32_32x32x16_bf16 v[220:235], v[108:111], a[220:223], v[220:235]
    v_cvt_pk_bf16_f32 v185, v214, v215
    v_cvt_pk_bf16_f32 v186, v216, v217
    v_mfma_f32_32x32x16_bf16 v[220:235], v[112:115], a[224:227], v[220:235]
    v_cvt_pk_bf16_f32 v187, v218, v219
    v_mfma_f32_32x32x16_bf16 v[220:235], v[116:119], a[228:231], v[220:235]
    v_mfma_f32_32x32x16_bf16 v[220:235], v[120:123], a[232:235], v[220:235]
    global_store_dwordx4 v159, v[184:187], s[14:15] offset:-3072 sc1
    v_mfma_f32_32x32x16_bf16 v[220:235], v[124:127], a[236:239], v[220:235]
    v_mfma_f32_32x32x16_bf16 v[220:235], v[128:131], a[240:243], v[220:235]
    v_mfma_f32_32x32x16_bf16 v[220:235], v[132:135], a[244:247], v[220:235]
    v_mfma_f32_32x32x16_bf16 v[220:235], v[136:139], a[248:251], v[220:235]
    v_mfma_f32_32x32x16_bf16 v[220:235], v[140:143], a[252:255], v[220:235]
    s_nop 7
    s_nop 3
    v_cvt_pk_bf16_f32 v188, v220, v221
    v_cvt_pk_bf16_f32 v189, v222, v223
    v_cvt_pk_bf16_f32 v190, v224, v225
    v_cvt_pk_bf16_f32 v191, v226, v227
    global_store_dwordx4 v159, v[188:191], s[14:15] offset:0 sc1
    v_cvt_pk_bf16_f32 v192, v228, v229
    v_cvt_pk_bf16_f32 v193, v230, v231
    v_cvt_pk_bf16_f32 v194, v232, v233
    v_cvt_pk_bf16_f32 v195, v234, v235
    global_store_dwordx4 v159, v[192:195], s[14:15] offset:1024 sc1
    s_branch standalone__conformer_family_zipformer__speech_kernel_b
standalone__conformer_family_zipformer__speech_kernel_cprep:
    s_sub_u32 s31, s30, 26
    s_lshl_b32 s31, s31, 2
    s_add_u32 s31, s31, s20
    s_lshr_b32 s32, s31, 1
    s_and_b32 s33, s31, 1
    s_waitcnt lgkmcnt(0)
    s_cmp_lg_u32 s31, 0
    s_cbranch_scc1 standalone__conformer_family_zipformer__speech_kernel_tagd
    v_mov_b32 v248, 46137344
    v_mov_b32 v247, 0
    global_load_dwordx2 v[14:15], v248, s[14:15] sc1
    s_waitcnt vmcnt(0)
    v_and_b32 v14, 0xffffff00, v14
    v_add_u32 v14, 0x100, v14
    v_or_b32 v15, 0x80000000, v15
    global_store_dwordx2 v248, v[14:15], s[14:15] sc1
    global_store_dwordx2 v247, v[14:15], s[98:99] sc1
standalone__conformer_family_zipformer__speech_kernel_tagd:
    s_cmp_lg_u32 s32, 0
    s_cbranch_scc1 standalone__conformer_family_zipformer__speech_kernel_n0
    s_load_dwordx2 s[6:7], s[0:1], 32
    s_mov_b32 s34, 0
    s_movk_i32 s35, 512
    s_movk_i32 s36, 0
    s_movk_i32 s37, 402
    s_movk_i32 s38, 2048
    s_mov_b32 s39, 1024
    s_branch standalone__conformer_family_zipformer__speech_kernel_go
standalone__conformer_family_zipformer__speech_kernel_n0:
    s_cmp_lg_u32 s32, 1
    s_cbranch_scc1 standalone__conformer_family_zipformer__speech_kernel_n1
    s_load_dwordx2 s[6:7], s[0:1], 40
    s_mov_b32 s34, 0
    s_movk_i32 s35, 1024
    s_movk_i32 s36, 32
    s_movk_i32 s37, 402
    s_movk_i32 s38, 2048
    s_mov_b32 s39, 32768
    s_branch standalone__conformer_family_zipformer__speech_kernel_go
standalone__conformer_family_zipformer__speech_kernel_n1:
    s_cmp_lg_u32 s32, 2
    s_cbranch_scc1 standalone__conformer_family_zipformer__speech_kernel_n2
    s_load_dwordx2 s[6:7], s[0:1], 40
    s_mov_b32 s34, 512
    s_movk_i32 s35, 1024
    s_movk_i32 s36, 33
    s_movk_i32 s37, 402
    s_movk_i32 s38, 2048
    s_mov_b32 s39, 32768
    s_branch standalone__conformer_family_zipformer__speech_kernel_go
standalone__conformer_family_zipformer__speech_kernel_n2:
    s_cmp_lg_u32 s32, 3
    s_cbranch_scc1 standalone__conformer_family_zipformer__speech_kernel_n3
    s_load_dwordx2 s[6:7], s[0:1], 56
    s_mov_b32 s34, 0
    s_movk_i32 s35, 512
    s_movk_i32 s36, 114
    s_movk_i32 s37, 402
    s_movk_i32 s38, 2048
    s_mov_b32 s39, 1024
    s_branch standalone__conformer_family_zipformer__speech_kernel_go
standalone__conformer_family_zipformer__speech_kernel_n3:
    s_cmp_lg_u32 s32, 4
    s_cbranch_scc1 standalone__conformer_family_zipformer__speech_kernel_n4
    s_load_dwordx2 s[6:7], s[0:1], 64
    s_mov_b32 s34, 0
    s_movk_i32 s35, 2048
    s_movk_i32 s36, 146
    s_movk_i32 s37, 402
    s_movk_i32 s38, 2048
    s_mov_b32 s39, 1024
    s_branch standalone__conformer_family_zipformer__speech_kernel_go
standalone__conformer_family_zipformer__speech_kernel_n4:
    s_cmp_lg_u32 s32, 5
    s_cbranch_scc1 standalone__conformer_family_zipformer__speech_kernel_n5
    s_load_dwordx2 s[6:7], s[0:1], 64
    s_mov_b32 s34, 512
    s_movk_i32 s35, 2048
    s_movk_i32 s36, 178
    s_movk_i32 s37, 402
    s_movk_i32 s38, 2048
    s_mov_b32 s39, 1024
    s_branch standalone__conformer_family_zipformer__speech_kernel_go
standalone__conformer_family_zipformer__speech_kernel_n5:
    s_cmp_lg_u32 s32, 6
    s_cbranch_scc1 standalone__conformer_family_zipformer__speech_kernel_n6
    s_load_dwordx2 s[6:7], s[0:1], 64
    s_mov_b32 s34, 1024
    s_movk_i32 s35, 2048
    s_movk_i32 s36, 274
    s_movk_i32 s37, 402
    s_movk_i32 s38, 2048
    s_mov_b32 s39, 1024
    s_branch standalone__conformer_family_zipformer__speech_kernel_go
standalone__conformer_family_zipformer__speech_kernel_n6:
    s_cmp_lg_u32 s32, 7
    s_cbranch_scc1 standalone__conformer_family_zipformer__speech_kernel_n7
    s_load_dwordx2 s[6:7], s[0:1], 64
    s_mov_b32 s34, 1536
    s_movk_i32 s35, 2048
    s_movk_i32 s36, 306
    s_movk_i32 s37, 402
    s_movk_i32 s38, 2048
    s_mov_b32 s39, 1024
    s_branch standalone__conformer_family_zipformer__speech_kernel_go
standalone__conformer_family_zipformer__speech_kernel_n7:
    s_cmp_lg_u32 s32, 8
    s_cbranch_scc1 standalone__conformer_family_zipformer__speech_kernel_n8
    s_load_dwordx2 s[6:7], s[0:1], 72
    s_mov_b32 s34, 0
    s_movk_i32 s35, 512
    s_movk_i32 s36, 210
    s_movk_i32 s37, 402
    s_movk_i32 s38, 2048
    s_mov_b32 s39, 1024
    s_branch standalone__conformer_family_zipformer__speech_kernel_go
standalone__conformer_family_zipformer__speech_kernel_n8:
    s_cmp_lg_u32 s32, 9
    s_cbranch_scc1 standalone__conformer_family_zipformer__speech_kernel_n9
    s_load_dwordx2 s[6:7], s[0:1], 72
    s_mov_b32 s34, 131072
    s_movk_i32 s35, 512
    s_movk_i32 s36, 242
    s_movk_i32 s37, 402
    s_movk_i32 s38, 2048
    s_mov_b32 s39, 1024
    s_branch standalone__conformer_family_zipformer__speech_kernel_go
standalone__conformer_family_zipformer__speech_kernel_n9:
    s_cmp_lg_u32 s32, 10
    s_cbranch_scc1 standalone__conformer_family_zipformer__speech_kernel_n10
    s_load_dwordx2 s[6:7], s[0:1], 72
    s_mov_b32 s34, 262144
    s_movk_i32 s35, 512
    s_movk_i32 s36, 338
    s_movk_i32 s37, 402
    s_movk_i32 s38, 2048
    s_mov_b32 s39, 1024
    s_branch standalone__conformer_family_zipformer__speech_kernel_go
standalone__conformer_family_zipformer__speech_kernel_n10:
    s_load_dwordx2 s[6:7], s[0:1], 72
    s_mov_b32 s34, 393216
    s_movk_i32 s35, 512
    s_movk_i32 s36, 370
    s_movk_i32 s37, 402
    s_movk_i32 s38, 2048
    s_mov_b32 s39, 1024
standalone__conformer_family_zipformer__speech_kernel_go:
    s_lshl_b32 s21, s20, 15
    v_bfe_u32 v196, v0, 2, 2
    v_bfe_u32 v197, v0, 5, 1
    v_lshl_add_u32 v197, v197, 2, v196
    v_lshlrev_b32 v197, 7, v197
    v_lshrrev_b32 v196, 1, v196
    v_lshl_add_u32 v197, v196, 6, v197
    v_bfe_u32 v196, v0, 4, 1
    v_lshl_add_u32 v197, v196, 5, v197
    v_and_b32 v196, 3, v0
    v_lshl_add_u32 v197, v196, 3, v197
    v_add_u32 v6, s21, v197
    v_xor_b32 v7, 64, v6
    v_mul_lo_u32 v2, v11, s35
    v_add_u32 v2, v2, v12
    s_lshl_b32 s44, s35, 3
    s_sub_u32 s44, s44, 1024
    v_add_u32 v3, s44, v2
    v_add_u32 v4, s44, v3
    v_add_u32 v5, s44, v4
    s_lshl_b32 s44, s33, 8
    s_add_u32 s34, s34, s44
    s_lshl_b32 s44, s33, 1
    s_mul_i32 s44, s44, s37
    s_add_u32 s36, s36, s44
    s_lshl_b32 s36, s36, 10
    s_lshl_b32 s37, s37, 10
    s_lshl_b32 s35, s35, 5
    s_add_u32 s8, s14, 27262976
    s_addc_u32 s9, s15, 0
    s_mov_b32 s10, 1646592
    s_mov_b32 s11, 0x20000
    s_mov_b32 s45, 2
    s_waitcnt lgkmcnt(0)
    s_add_u32 s6, s6, s34
    s_addc_u32 s7, s7, 0
standalone__conformer_family_zipformer__speech_kernel_round:
    s_mov_b64 s[22:23], s[6:7]
    s_mov_b32 m0, s21
    s_mov_b32 s46, 8
standalone__conformer_family_zipformer__speech_kernel_iss:
    global_load_lds_dwordx4 v2, s[22:23] offset:0
    global_load_lds_dwordx4 v3, s[22:23] offset:1024
    global_load_lds_dwordx4 v4, s[22:23] offset:2048
    global_load_lds_dwordx4 v5, s[22:23] offset:3072
    s_add_u32 s22, s22, s35
    s_addc_u32 s23, s23, 0
    s_add_u32 m0, m0, 4096
    s_sub_u32 s46, s46, 1
    s_cmp_lg_u32 s46, 0
    s_cbranch_scc1 standalone__conformer_family_zipformer__speech_kernel_iss
    v_mov_b32 v196, v6
    v_mov_b32 v197, v7
    s_mov_b32 s47, s36
    s_mov_b32 s46, 8
standalone__conformer_family_zipformer__speech_kernel_cv:
    s_waitcnt vmcnt(28)
    ds_read_b64_tr_b16 v[16:17], v196 offset:0
    ds_read_b64_tr_b16 v[18:19], v196 offset:1024
    ds_read_b64_tr_b16 v[20:21], v197 offset:0
    ds_read_b64_tr_b16 v[22:23], v197 offset:1024
    ds_read_b64_tr_b16 v[24:25], v196 offset:2048
    ds_read_b64_tr_b16 v[26:27], v196 offset:3072
    ds_read_b64_tr_b16 v[28:29], v197 offset:2048
    ds_read_b64_tr_b16 v[30:31], v197 offset:3072
    v_add_u32 v196, 4096, v196
    v_add_u32 v197, 4096, v197
    s_add_u32 s44, s47, s39
    s_waitcnt lgkmcnt(0)
    buffer_store_dwordx4 v[16:19], v1, s[8:11], s47 offen sc1
    buffer_store_dwordx4 v[20:23], v1, s[8:11], s44 offen sc1
    s_add_u32 s47, s47, s38
    s_add_u32 s44, s44, s38
    buffer_store_dwordx4 v[24:27], v1, s[8:11], s47 offen sc1
    buffer_store_dwordx4 v[28:31], v1, s[8:11], s44 offen sc1
    s_add_u32 s47, s47, s38
    s_add_u32 s44, s44, s38
    s_sub_u32 s46, s46, 1
    s_cmp_lg_u32 s46, 0
    s_cbranch_scc1 standalone__conformer_family_zipformer__speech_kernel_cv
    s_add_u32 s6, s6, 128
    s_addc_u32 s7, s7, 0
    s_add_u32 s36, s36, s37
    s_sub_u32 s45, s45, 1
    s_cmp_lg_u32 s45, 0
    s_cbranch_scc1 standalone__conformer_family_zipformer__speech_kernel_round
    s_load_dwordx2 s[6:7], s[0:1], 48
    s_mul_i32 s31, s31, 3
    s_mov_b32 s45, 3
    s_waitcnt lgkmcnt(0)
    s_mov_b32 s16, s6
    s_mov_b32 s17, s7
    s_mov_b32 s18, 15872
    s_mov_b32 s19, 0x20000
standalone__conformer_family_zipformer__speech_kernel_tz:
    s_mul_i32 s32, s31, 3641
    s_lshr_b32 s32, s32, 16
    s_mul_i32 s33, s32, 18
    s_sub_u32 s33, s31, s33
    s_cmp_ge_u32 s33, 9
    s_cselect_b32 s34, 1, 0
    s_mul_i32 s35, s34, 9
    s_sub_u32 s35, s33, s35
    v_and_b32 v2, 3, v0
    v_bfe_u32 v3, v0, 2, 4
    s_lshl_b32 s36, s32, 1
    s_add_u32 s36, s36, s34
    s_lshl_b32 s36, s36, 6
    v_lshl_add_u32 v3, v3, 1, s36
    s_lshl_b32 s35, s35, 2
    s_sub_u32 s35, s35, 1
    v_sub_u32 v2, s35, v2
    v_add_u32 v4, 0, v2
    v_min_u32 v4, 31, v4
    v_lshl_add_u32 v5, v4, 9, v3
    v_add_u32 v4, 1, v2
    v_min_u32 v4, 31, v4
    v_lshl_add_u32 v6, v4, 9, v3
    v_add_u32 v4, 2, v2
    v_min_u32 v4, 31, v4
    v_lshl_add_u32 v7, v4, 9, v3
    v_add_u32 v4, 3, v2
    v_min_u32 v4, 31, v4
    v_lshl_add_u32 v8, v4, 9, v3
    s_mul_i32 s36, s32, 402
    s_add_u32 s36, s36, s33
    s_add_u32 s36, s36, 96
    s_lshl_b32 s36, s36, 10
    buffer_load_ushort v16, v5, s[16:19], 0 offen offset:0
    buffer_load_ushort v17, v6, s[16:19], 0 offen offset:0
    buffer_load_ushort v18, v7, s[16:19], 0 offen offset:0
    buffer_load_ushort v19, v8, s[16:19], 0 offen offset:0
    buffer_load_ushort v20, v5, s[16:19], 0 offen offset:32
    buffer_load_ushort v21, v6, s[16:19], 0 offen offset:32
    buffer_load_ushort v22, v7, s[16:19], 0 offen offset:32
    buffer_load_ushort v23, v8, s[16:19], 0 offen offset:32
    s_waitcnt vmcnt(0)
    v_lshl_or_b32 v24, v17, 16, v16
    v_lshl_or_b32 v25, v19, 16, v18
    v_lshl_or_b32 v26, v21, 16, v20
    v_lshl_or_b32 v27, v23, 16, v22
    buffer_store_dwordx4 v[24:27], v1, s[8:11], s36 offen sc1
    s_add_u32 s31, s31, 1
    s_sub_u32 s45, s45, 1
    s_cmp_lg_u32 s45, 0
    s_cbranch_scc1 standalone__conformer_family_zipformer__speech_kernel_tz
    v_mov_b32 v247, 0
    global_load_dwordx2 v[14:15], v247, s[98:99] sc1
    s_waitcnt vmcnt(0)
    s_mov_b32 s33, 400000
standalone__conformer_family_zipformer__speech_kernel_tg1:
    v_readfirstlane_b32 s100, v14
    v_readfirstlane_b32 s101, v15
    s_sub_u32 s33, s33, 1
    s_cselect_b32 s101, 1, s101
    s_cmp_eq_u32 s101, 0
    s_cbranch_scc1 standalone__conformer_family_zipformer__speech_kernel_tc1
    s_sub_u32 s62, s30, 26
    s_lshl_b32 s62, s62, 2
    s_add_u32 s62, s62, s20
    s_lshl_b32 s62, s62, 7
    s_add_u32 s62, s62, 45216768
    s_branch standalone__conformer_family_zipformer__speech_kernel_b
standalone__conformer_family_zipformer__speech_kernel_xs0:
    global_store_dwordx4 v243, v[80:83], s[96:97] offset:0 sc1
    s_branch standalone__conformer_family_zipformer__speech_kernel_xj0
standalone__conformer_family_zipformer__speech_kernel_xs1:
    global_store_dwordx4 v243, v[84:87], s[96:97] offset:1024 sc1
    s_branch standalone__conformer_family_zipformer__speech_kernel_xj1
standalone__conformer_family_zipformer__speech_kernel_xs2:
    global_store_dwordx4 v243, v[88:91], s[96:97] offset:2048 sc1
    s_branch standalone__conformer_family_zipformer__speech_kernel_xj2
standalone__conformer_family_zipformer__speech_kernel_xs3:
    global_store_dwordx4 v243, v[92:95], s[96:97] offset:3072 sc1
    s_branch standalone__conformer_family_zipformer__speech_kernel_xj3
standalone__conformer_family_zipformer__speech_kernel_xs4:
    global_store_dword v241, v245, s[14:15] offset:128 sc1
    s_branch standalone__conformer_family_zipformer__speech_kernel_xj4
standalone__conformer_family_zipformer__speech_kernel_pollc:
    global_load_dword v246, v240, s[14:15] offset:128 sc1
    global_load_dword v245, v240, s[14:15] sc1
    s_waitcnt vmcnt(0)
    v_readfirstlane_b32 s35, v245
    s_nop 0
    s_cmp_eq_u32 s35, s28
    s_cbranch_scc1 standalone__conformer_family_zipformer__speech_kernel_poll
    s_mov_b32 s28, s35
    s_mov_b64 vcc, 0
    global_store_dwordx4 v243, v[80:83], s[96:97] offset:0 sc1
    global_store_dwordx4 v243, v[84:87], s[96:97] offset:1024 sc1
    global_store_dwordx4 v243, v[88:91], s[96:97] offset:2048 sc1
    global_store_dwordx4 v243, v[92:95], s[96:97] offset:3072 sc1
    s_waitcnt vmcnt(0)
    global_store_dword v241, v245, s[14:15] offset:128 sc1
    s_branch standalone__conformer_family_zipformer__speech_kernel_poll
standalone__conformer_family_zipformer__speech_kernel_tc0:
    global_load_dwordx2 v[14:15], v247, s[98:99] sc1
    s_waitcnt vmcnt(0)
    s_branch standalone__conformer_family_zipformer__speech_kernel_tg0
standalone__conformer_family_zipformer__speech_kernel_echoc:
    s_mov_b64 vcc, 0
    global_store_dwordx4 v243, v[80:83], s[96:97] offset:0 sc1
    global_store_dwordx4 v243, v[84:87], s[96:97] offset:1024 sc1
    global_store_dwordx4 v243, v[88:91], s[96:97] offset:2048 sc1
    global_store_dwordx4 v243, v[92:95], s[96:97] offset:3072 sc1
    s_waitcnt vmcnt(0)
    global_store_dword v241, v245, s[14:15] offset:128 sc1
    s_branch standalone__conformer_family_zipformer__speech_kernel_echo
standalone__conformer_family_zipformer__speech_kernel_xs8:
    global_store_dwordx4 v251, v[48:51], s[96:97] offset:0 sc1
    s_branch standalone__conformer_family_zipformer__speech_kernel_xj8
standalone__conformer_family_zipformer__speech_kernel_xs9:
    global_store_dwordx4 v251, v[52:55], s[96:97] offset:1024 sc1
    s_branch standalone__conformer_family_zipformer__speech_kernel_xj9
standalone__conformer_family_zipformer__speech_kernel_xs10:
    global_store_dwordx4 v251, v[56:59], s[96:97] offset:2048 sc1
    s_branch standalone__conformer_family_zipformer__speech_kernel_xj10
standalone__conformer_family_zipformer__speech_kernel_xs11:
    global_store_dwordx4 v251, v[60:63], s[96:97] offset:3072 sc1
    s_branch standalone__conformer_family_zipformer__speech_kernel_xj11
standalone__conformer_family_zipformer__speech_kernel_xs12:
    global_store_dwordx2 v241, v[14:15], s[14:15] offset:192 sc1
    s_branch standalone__conformer_family_zipformer__speech_kernel_xj12
standalone__conformer_family_zipformer__speech_kernel_p2c:
    global_load_dwordx2 v[244:245], v240, s[14:15] offset:192 sc1
    s_waitcnt vmcnt(0)
    s_branch standalone__conformer_family_zipformer__speech_kernel_p2
standalone__conformer_family_zipformer__speech_kernel_tc1:
    global_load_dwordx2 v[14:15], v247, s[98:99] sc1
    s_waitcnt vmcnt(0)
    s_branch standalone__conformer_family_zipformer__speech_kernel_tg1
standalone__conformer_family_zipformer__speech_kernel_b:
    s_mov_b64 s[4:5], s[14:15]
    s_mov_b64 s[6:7], s[96:97]
    v_mov_b32 v10, s62
    v_mov_b32 v12, s100
    v_mov_b32 v13, s101
    s_and_b32 s21, s2, 7
    s_lshr_b32 s22, s2, 3
    s_mul_i32 s31, s21, 512000
    s_mul_i32 s32, s21, 1024000
    s_add_u32 s32, s32, 4194304
    s_mov_b32 s28, 31
    s_lshl_b32 s25, s20, 13
    s_add_u32 s25, s25, 4096
    s_lshl_b32 s26, s28, 15
    s_add_u32 s26, s26, s25
    s_mov_b32 s30, s25
    s_lshl_b32 s33, s22, 14
    s_sub_u32 s28, s28, 1
    s_mov_b32 s29, 0
    s_add_u32 s8, s4, s31
    s_addc_u32 s9, s5, 0
    s_mov_b32 s10, 512000
    s_mov_b32 s11, 0x20000
    s_add_u32 s12, s4, s32
    s_addc_u32 s13, s5, 0
    s_lshl_b32 s34, s20, 12
    s_add_u32 s33, s33, s34
    s_add_u32 m0, s34, 8192
    s_mov_b32 s23, s30
    v_add_u32 v2, s23, v1
    s_add_u32 s16, s4, 12582912
    s_addc_u32 s17, s5, 0
    s_mov_b32 s18, 4096000
    s_mov_b32 s19, 0x20000
    s_lshl_b32 s35, s22, 2
    s_add_u32 s35, s35, s20
    s_mul_i32 s36, s22, 7936
    s_cmp_ge_u32 s22, 19
    s_cselect_b32 s37, -1280, 0
    s_add_u32 s36, s36, s37
    s_cmp_ge_u32 s22, 26
    s_cselect_b32 s37, 75520, 0
    s_add_u32 s36, s36, s37
    s_mul_i32 s37, s20, 411648
    s_add_u32 s36, s36, s37
    s_add_u32 s36, s36, 27262976
    s_add_u32 s44, s4, s36
    s_addc_u32 s45, s5, 0
    s_lshl_b32 s36, s21, 7
    s_add_u32 s36, s36, s35
    s_lshl_b32 s36, s36, 12
    s_min_u32 s37, s36, 4091904
    s_add_u32 s52, s6, s37
    s_addc_u32 s53, s7, 0
    s_add_u32 s36, s36, 16777216
    s_add_u32 s46, s4, s36
    s_addc_u32 s47, s5, 0
    s_getpc_b64 s[50:51]
attn_pc:
    s_add_u32 s50, s50, attn_fin-attn_pc
    s_addc_u32 s51, s51, 0
    s_lshl_b32 s35, s35, 8
    s_min_u32 s35, s35, (standalone__conformer_family_zipformer__speech_kernel_end-attn_fin-196)&0xffffff80
    v_lshrrev_b32 v3, 4, v1
    v_and_b32 v4, 6, v3
    v_mov_b32 v5, 0x3f803f80
    v_cmp_eq_u32 vcc, 0, v4
    s_nop 1
    v_cndmask_b32 v176, 0, v5, vcc
    v_cndmask_b32 v177, 0, v5, vcc
    v_cmp_eq_u32 vcc, 4, v4
    s_nop 1
    v_cndmask_b32 v178, 0, v5, vcc
    v_cndmask_b32 v179, 0, v5, vcc
    v_and_b32 v4, 1, v3
    v_cmp_eq_u32 vcc, 0, v4
    v_mov_b32 v5, 0x44444444
    v_mov_b32 v6, 0xeeeeeeee
    v_cndmask_b32 v180, v6, v5, vcc
    v_and_b32 v3, 63, v0
    v_lshl_add_u32 v4, v3, 2, s20
    v_min_u32 v4, 124, v4
    s_lshl_b32 s36, s22, 2
    s_add_u32 s36, s36, s20
    s_min_u32 s36, s36, 124
    v_mov_b32 v5, s36
    v_cmp_eq_u32 vcc, 32, v3
    s_mul_i32 s36, s21, 125
    s_nop 0
    v_cndmask_b32 v4, v4, v5, vcc
    v_add_u32 v4, s36, v4
    v_add_u32 v5, 967, v3
    v_cmp_lt_u32 vcc, 32, v3
    s_nop 1
    v_cndmask_b32 v4, v4, v5, vcc
    v_lshlrev_b32 v4, 7, v4
    v_add_u32 v11, 45088768, v4
    v_lshrrev_b32 v3, 1, v1
    s_lshl_b32 s36, s20, 11
    v_add_u32 v208, s36, v3
    s_add_u32 s36, s20, 0
    s_and_b32 s36, s36, 3
    s_lshl_b32 s37, s36, 11
    s_lshl_b32 s38, s20, 9
    s_add_u32 s37, s37, s38
    v_add_u32 v209, s37, v3
    s_add_u32 s36, s20, 1
    s_and_b32 s36, s36, 3
    s_lshl_b32 s37, s36, 11
    s_lshl_b32 s38, s20, 9
    s_add_u32 s37, s37, s38
    v_add_u32 v210, s37, v3
    s_lshl_b32 s37, s20, 2
    s_add_u32 s36, s36, s37
    s_lshl_b32 s36, s36, 13
    s_add_u32 s36, s36, 8192
    v_add_u32 v213, s36, v1
    s_add_u32 s36, s20, 2
    s_and_b32 s36, s36, 3
    s_lshl_b32 s37, s36, 11
    s_lshl_b32 s38, s20, 9
    s_add_u32 s37, s37, s38
    v_add_u32 v211, s37, v3
    s_lshl_b32 s37, s20, 2
    s_add_u32 s36, s36, s37
    s_lshl_b32 s36, s36, 13
    s_add_u32 s36, s36, 8192
    v_add_u32 v214, s36, v1
    s_add_u32 s36, s20, 3
    s_and_b32 s36, s36, 3
    s_lshl_b32 s37, s36, 11
    s_lshl_b32 s38, s20, 9
    s_add_u32 s37, s37, s38
    v_add_u32 v212, s37, v3
    s_lshl_b32 s37, s20, 2
    s_add_u32 s36, s36, s37
    s_lshl_b32 s36, s36, 13
    s_add_u32 s36, s36, 8192
    v_add_u32 v215, s36, v1
    s_lshl_b32 s36, s20, 13
    s_add_u32 s36, s36, 8192
    v_add_u32 v216, s36, v1
    v_add_u32 v217, 65536, v216
    v_mov_b32 v218, 0x5f800000
    s_lshl_b32 s56, s22, 2
    s_add_u32 s56, s56, s20
    s_cmp_ge_u32 s56, 125
    s_cselect_b32 s36, 0x40000000, 0
    s_lshr_b32 s37, s21, 2
    s_mul_i32 s37, s37, 125
    s_add_u32 s56, s56, s37
    s_lshl_b32 s56, s56, 2
    s_and_b32 s37, s21, 3
    s_add_u32 s56, s56, s37
    s_lshl_b32 s39, s56, 7
    s_or_b32 s39, s39, s36
    s_lshl_b32 s56, s56, 12
    s_or_b32 s56, s56, s36
    v_accvgpr_write_b32 a0, 0
    v_accvgpr_write_b32 a1, 0
    v_accvgpr_write_b32 a2, 0
    v_accvgpr_write_b32 a3, 0
    v_accvgpr_write_b32 a4, 0
    v_accvgpr_write_b32 a5, 0
    v_accvgpr_write_b32 a6, 0
    v_accvgpr_write_b32 a7, 0
    v_accvgpr_write_b32 a8, 0
    v_accvgpr_write_b32 a9, 0
    v_accvgpr_write_b32 a10, 0
    v_accvgpr_write_b32 a11, 0
    v_accvgpr_write_b32 a12, 0
    v_accvgpr_write_b32 a13, 0
    v_accvgpr_write_b32 a14, 0
    v_accvgpr_write_b32 a15, 0
    v_accvgpr_write_b32 a16, 0
    v_accvgpr_write_b32 a17, 0
    v_accvgpr_write_b32 a18, 0
    v_accvgpr_write_b32 a19, 0
    v_accvgpr_write_b32 a20, 0
    v_accvgpr_write_b32 a21, 0
    v_accvgpr_write_b32 a22, 0
    v_accvgpr_write_b32 a23, 0
    v_accvgpr_write_b32 a24, 0
    v_accvgpr_write_b32 a25, 0
    v_accvgpr_write_b32 a26, 0
    v_accvgpr_write_b32 a27, 0
    v_accvgpr_write_b32 a28, 0
    v_accvgpr_write_b32 a29, 0
    v_accvgpr_write_b32 a30, 0
    v_accvgpr_write_b32 a31, 0
    v_accvgpr_write_b32 a32, 0
    v_accvgpr_write_b32 a33, 0
    v_accvgpr_write_b32 a34, 0
    v_accvgpr_write_b32 a35, 0
    v_accvgpr_write_b32 a36, 0
    v_accvgpr_write_b32 a37, 0
    v_accvgpr_write_b32 a38, 0
    v_accvgpr_write_b32 a39, 0
    s_waitcnt vmcnt(0)
    s_barrier
    global_store_dwordx2 v10, v[12:13], s[4:5] sc1
    s_mov_b32 s62, 3
    s_mov_b32 s63, 1
    s_mov_b32 exec_hi, 0x1ffffff
    s_mov_b32 s36, 400000
    global_load_dwordx2 v[14:15], v11, s[4:5] sc1
    s_mov_b64 exec, -1
    v_accvgpr_write_b32 a40, 0
    v_accvgpr_write_b32 a41, 0
    v_accvgpr_write_b32 a42, 0
    v_accvgpr_write_b32 a43, 0
    v_accvgpr_write_b32 a44, 0
    v_accvgpr_write_b32 a45, 0
    v_accvgpr_write_b32 a46, 0
    v_accvgpr_write_b32 a47, 0
    v_accvgpr_write_b32 a48, 0
    v_accvgpr_write_b32 a49, 0
    v_accvgpr_write_b32 a50, 0
    v_accvgpr_write_b32 a51, 0
    v_accvgpr_write_b32 a52, 0
    v_accvgpr_write_b32 a53, 0
    v_accvgpr_write_b32 a54, 0
    v_accvgpr_write_b32 a55, 0
    v_accvgpr_write_b32 a56, 0
    v_accvgpr_write_b32 a57, 0
    v_accvgpr_write_b32 a58, 0
    v_accvgpr_write_b32 a59, 0
    v_accvgpr_write_b32 a60, 0
    v_accvgpr_write_b32 a61, 0
    v_accvgpr_write_b32 a62, 0
    v_accvgpr_write_b32 a63, 0
    v_accvgpr_write_b32 a64, 0
    v_accvgpr_write_b32 a65, 0
    v_accvgpr_write_b32 a66, 0
    v_accvgpr_write_b32 a67, 0
    v_accvgpr_write_b32 a68, 0
    v_accvgpr_write_b32 a69, 0
    v_accvgpr_write_b32 a70, 0
    v_accvgpr_write_b32 a71, 0
    v_accvgpr_write_b32 a72, 0
    v_accvgpr_write_b32 a73, 0
    v_accvgpr_write_b32 a74, 0
    v_accvgpr_write_b32 a75, 0
    v_accvgpr_write_b32 a76, 0
    v_accvgpr_write_b32 a77, 0
    v_accvgpr_write_b32 a78, 0
    v_accvgpr_write_b32 a79, 0
    v_accvgpr_write_b32 a80, 0
    v_accvgpr_write_b32 a81, 0
    v_accvgpr_write_b32 a82, 0
    v_accvgpr_write_b32 a83, 0
    v_accvgpr_write_b32 a84, 0
    v_accvgpr_write_b32 a85, 0
    v_accvgpr_write_b32 a86, 0
    v_accvgpr_write_b32 a87, 0
    v_accvgpr_write_b32 a88, 0
    v_accvgpr_write_b32 a89, 0
    v_accvgpr_write_b32 a90, 0
    v_accvgpr_write_b32 a91, 0
    v_accvgpr_write_b32 a92, 0
    v_accvgpr_write_b32 a93, 0
    v_accvgpr_write_b32 a94, 0
    v_accvgpr_write_b32 a95, 0
    v_accvgpr_write_b32 a96, 0
    v_accvgpr_write_b32 a97, 0
    v_accvgpr_write_b32 a98, 0
    v_accvgpr_write_b32 a99, 0
    v_accvgpr_write_b32 a100, 0
    v_accvgpr_write_b32 a101, 0
    v_accvgpr_write_b32 a102, 0
    v_accvgpr_write_b32 a103, 0
    v_accvgpr_write_b32 a104, 0
    v_accvgpr_write_b32 a105, 0
    v_accvgpr_write_b32 a106, 0
    v_accvgpr_write_b32 a107, 0
    v_accvgpr_write_b32 a108, 0
    v_accvgpr_write_b32 a109, 0
    v_accvgpr_write_b32 a110, 0
    v_accvgpr_write_b32 a111, 0
    v_accvgpr_write_b32 a112, 0
    v_accvgpr_write_b32 a113, 0
    v_accvgpr_write_b32 a114, 0
    v_accvgpr_write_b32 a115, 0
    v_accvgpr_write_b32 a116, 0
    v_accvgpr_write_b32 a117, 0
    v_accvgpr_write_b32 a118, 0
    v_accvgpr_write_b32 a119, 0
    v_accvgpr_write_b32 a120, 0
    v_accvgpr_write_b32 a121, 0
    v_accvgpr_write_b32 a122, 0
    v_accvgpr_write_b32 a123, 0
    v_accvgpr_write_b32 a124, 0
    v_accvgpr_write_b32 a125, 0
    v_accvgpr_write_b32 a126, 0
    v_accvgpr_write_b32 a127, 0
    v_accvgpr_write_b32 a240, 0
    v_accvgpr_write_b32 a241, 0
    v_accvgpr_write_b32 a242, 0
    v_accvgpr_write_b32 a243, 0
    v_accvgpr_write_b32 a244, 0
    v_accvgpr_write_b32 a245, 0
    v_accvgpr_write_b32 a246, 0
    v_accvgpr_write_b32 a247, 0
    v_accvgpr_write_b32 a248, 0
    v_accvgpr_write_b32 a249, 0
    v_accvgpr_write_b32 a250, 0
    v_accvgpr_write_b32 a251, 0
    s_mov_b32 exec_hi, 0x1ffffff
    s_waitcnt vmcnt(0)
    v_cmp_ne_u64 s[58:59], s[100:101], v[14:15]
    s_nop 3
    s_cmp_eq_u64 s[58:59], 0
    s_cbranch_scc1 attn_wb
    s_mov_b64 exec, s[58:59]
attn_wa:
    global_load_dwordx2 v[12:13], v11, s[4:5] sc1
    s_waitcnt vmcnt(0)
    v_cmp_ne_u64 s[58:59], s[100:101], v[12:13]
    s_sub_u32 s36, s36, 1
    s_cbranch_scc1 attn_wb
    s_nop 1
    s_and_b64 s[54:55], s[58:59], exec
    s_cbranch_scc0 attn_wb
    s_mov_b64 exec, s[58:59]
    s_sleep 3
    s_branch attn_wa
attn_wb:
    s_mov_b64 exec, -1
    buffer_load_dwordx4 v1, s[8:11], s33 offen offset:0 lds
    buffer_load_dwordx4 v1, s[8:11], s33 offen offset:1024 lds
    buffer_load_dwordx4 v1, s[8:11], s33 offen offset:2048 lds
    buffer_load_dwordx4 v1, s[8:11], s33 offen offset:3072 lds
    global_load_dwordx4 a[192:195], v2, s[12:13] offset:-4096
    global_load_dwordx4 a[196:199], v2, s[12:13] offset:-3072
    global_load_dwordx4 a[200:203], v2, s[12:13] offset:-2048
    global_load_dwordx4 a[204:207], v2, s[12:13] offset:-1024
    v_accvgpr_write_b32 a252, 0
    v_accvgpr_write_b32 a253, 0
    v_accvgpr_write_b32 a254, 0
    v_accvgpr_write_b32 a255, 0
    v_mov_b32 v88, 0
    v_mov_b32 v89, 0
    v_mov_b32 v90, 0
    v_mov_b32 v91, 0
    v_mov_b32 v92, 0
    v_mov_b32 v93, 0
    v_mov_b32 v94, 0
    v_mov_b32 v95, 0
    v_mov_b32 v160, 0
    v_mov_b32 v161, 0
    v_mov_b32 v162, 0
    v_mov_b32 v163, 0
    v_mov_b32 v164, 0
    v_mov_b32 v165, 0
    v_mov_b32 v166, 0
    v_mov_b32 v167, 0
    v_mov_b32 v168, 0
    v_mov_b32 v169, 0
    v_mov_b32 v170, 0
    v_mov_b32 v171, 0
    v_mov_b32 v172, 0
    v_mov_b32 v173, 0
    v_mov_b32 v174, 0
    v_mov_b32 v175, 0
    v_mov_b32 v78, 0
    v_mov_b32 v79, 0
    s_mov_b32 s27, s28
    s_mov_b32 s48, 0
    s_mov_b32 s49, 0
    v_add_u32 v3, s34, v1
    v_lshrrev_b32 v4, 2, v1
    s_lshl_b32 s36, s20, 8
    v_add_u32 v5, s36, v4
    s_waitcnt vmcnt(4)
    ds_read_b128 v[32:35], v3 offset:8192
    ds_read_b128 v[36:39], v3 offset:9216
    ds_read_b128 v[40:43], v3 offset:10240
    ds_read_b128 v[44:47], v3 offset:11264
    s_barrier
    ds_read_b128 a[128:131], v1 offset:8192
    ds_read_b128 a[132:135], v1 offset:9216
    ds_read_b128 a[136:139], v1 offset:10240
    ds_read_b128 a[140:143], v1 offset:11264
    ds_read_b128 a[144:147], v1 offset:12288
    ds_read_b128 a[148:151], v1 offset:13312
    ds_read_b128 a[152:155], v1 offset:14336
    ds_read_b128 a[156:159], v1 offset:15360
    s_waitcnt vmcnt(0) lgkmcnt(8)
    v_mfma_f32_32x32x16_bf16 v[16:31], a[192:195], v[32:35], 0
    ds_read_b128 a[160:163], v1 offset:16384
    ds_read_b128 a[164:167], v1 offset:17408
    v_mfma_f32_32x32x16_bf16 v[16:31], a[196:199], v[36:39], v[16:31]
    ds_read_b128 a[168:171], v1 offset:18432
    ds_read_b128 a[172:175], v1 offset:19456
    v_mfma_f32_32x32x16_bf16 v[16:31], a[200:203], v[40:43], v[16:31]
    ds_read_b128 a[176:179], v1 offset:20480
    ds_read_b128 a[180:183], v1 offset:21504
    v_mfma_f32_32x32x16_bf16 v[16:31], a[204:207], v[44:47], v[16:31]
    ds_read_b128 a[184:187], v1 offset:22528
    ds_read_b128 a[188:191], v1 offset:23552
    global_load_dwordx4 a[224:227], v2, s[12:13] offset:0
    global_load_dwordx4 a[228:231], v2, s[12:13] offset:1024
    global_load_dwordx4 a[232:235], v2, s[12:13] offset:2048
    global_load_dwordx4 a[236:239], v2, s[12:13] offset:3072
    s_add_u32 s23, s23, 32768
    s_cmp_ge_u32 s23, s26
    s_cselect_b32 s23, s25, s23
    v_add_u32 v2, s23, v1
    global_load_dwordx4 a[208:211], v2, s[12:13] offset:-4096
    global_load_dwordx4 a[212:215], v2, s[12:13] offset:-3072
    global_load_dwordx4 a[216:219], v2, s[12:13] offset:-2048
    global_load_dwordx4 a[220:223], v2, s[12:13] offset:-1024
    v_max3_f32 v184, v16, v17, v18
    v_max3_f32 v184, v184, v19, v20
    v_max3_f32 v184, v184, v21, v22
    v_max3_f32 v184, v184, v23, v24
    v_max3_f32 v184, v184, v25, v26
    v_max3_f32 v184, v184, v27, v28
    v_max3_f32 v184, v184, v29, v30
    v_max_f32 v184, v184, v31
    v_mov_b32 v188, v184
    s_nop 1
    v_permlane32_swap_b32 v184, v188
    v_max_f32 v184, v184, v188
    ds_write_b32 v5, v184
    s_waitcnt lgkmcnt(0)
    s_barrier
    ds_read_b32 v184, v4 offset:0
    ds_read_b32 v185, v4 offset:256
    ds_read_b32 v186, v4 offset:512
    ds_read_b32 v187, v4 offset:768
    s_waitcnt lgkmcnt(3)
    v_sub_f32 v96, 0, v184
    v_sub_f32 v97, 0, v184
    v_sub_f32 v98, 0, v184
    v_sub_f32 v99, 0, v184
    v_sub_f32 v100, 0, v184
    v_sub_f32 v101, 0, v184
    v_sub_f32 v102, 0, v184
    v_sub_f32 v103, 0, v184
    v_sub_f32 v104, 0, v184
    v_sub_f32 v105, 0, v184
    v_sub_f32 v106, 0, v184
    v_sub_f32 v107, 0, v184
    v_sub_f32 v108, 0, v184
    v_sub_f32 v109, 0, v184
    v_sub_f32 v110, 0, v184
    v_sub_f32 v111, 0, v184
    s_waitcnt lgkmcnt(0)
    s_nop 0
    v_mfma_f32_32x32x16_bf16 v[16:31], a[192:195], a[128:131], v[96:111]
    v_sub_f32 v112, 0, v185
    v_sub_f32 v113, 0, v185
    v_sub_f32 v114, 0, v185
    v_sub_f32 v115, 0, v185
    v_sub_f32 v116, 0, v185
    v_sub_f32 v117, 0, v185
    v_sub_f32 v118, 0, v185
    v_sub_f32 v119, 0, v185
    v_sub_f32 v120, 0, v185
    v_sub_f32 v121, 0, v185
    v_sub_f32 v122, 0, v185
    v_sub_f32 v123, 0, v185
    v_mfma_f32_32x32x16_bf16 v[16:31], a[196:199], a[132:135], v[16:31]
    v_sub_f32 v124, 0, v185
    v_sub_f32 v125, 0, v185
    v_sub_f32 v126, 0, v185
    v_sub_f32 v127, 0, v185
    v_sub_f32 v128, 0, v186
    v_sub_f32 v129, 0, v186
    v_sub_f32 v130, 0, v186
    v_sub_f32 v131, 0, v186
    v_sub_f32 v132, 0, v186
    v_sub_f32 v133, 0, v186
    v_sub_f32 v134, 0, v186
    v_sub_f32 v135, 0, v186
    v_mfma_f32_32x32x16_bf16 v[16:31], a[200:203], a[136:139], v[16:31]
    v_sub_f32 v136, 0, v186
    v_sub_f32 v137, 0, v186
    v_sub_f32 v138, 0, v186
    v_sub_f32 v139, 0, v186
    v_sub_f32 v140, 0, v186
    v_sub_f32 v141, 0, v186
    v_sub_f32 v142, 0, v186
    v_sub_f32 v143, 0, v186
    v_sub_f32 v144, 0, v187
    v_sub_f32 v145, 0, v187
    v_sub_f32 v146, 0, v187
    v_sub_f32 v147, 0, v187
    v_mfma_f32_32x32x16_bf16 v[16:31], a[204:207], a[140:143], v[16:31]
    v_sub_f32 v148, 0, v187
    v_sub_f32 v149, 0, v187
    v_sub_f32 v150, 0, v187
    v_sub_f32 v151, 0, v187
    v_sub_f32 v152, 0, v187
    v_sub_f32 v153, 0, v187
    v_sub_f32 v154, 0, v187
    v_sub_f32 v155, 0, v187
    v_sub_f32 v156, 0, v187
    v_sub_f32 v157, 0, v187
    v_sub_f32 v158, 0, v187
    v_sub_f32 v159, 0, v187
    s_load_dwordx2 s[60:61], s[50:51], s35 offset:60
    s_load_dwordx2 s[60:61], s[50:51], s35 offset:188
    s_load_dwordx2 s[60:61], s[46:47], 4028
    s_load_dwordx2 s[60:61], s[52:53], 4028
    s_branch attn_loop
attn_pass:
    s_mov_b32 s23, s30
    v_add_u32 v2, s23, v1
    global_load_dwordx4 a[192:195], v2, s[12:13] offset:-4096
    global_load_dwordx4 a[196:199], v2, s[12:13] offset:-3072
    global_load_dwordx4 a[200:203], v2, s[12:13] offset:-2048
    global_load_dwordx4 a[204:207], v2, s[12:13] offset:-1024
    global_load_dwordx4 a[224:227], v2, s[12:13] offset:0
    global_load_dwordx4 a[228:231], v2, s[12:13] offset:1024
    global_load_dwordx4 a[232:235], v2, s[12:13] offset:2048
    global_load_dwordx4 a[236:239], v2, s[12:13] offset:3072
    s_add_u32 s23, s23, 32768
    s_cmp_ge_u32 s23, s26
    s_cselect_b32 s23, s25, s23
    v_add_u32 v2, s23, v1
    global_load_dwordx4 a[208:211], v2, s[12:13] offset:-4096
    global_load_dwordx4 a[212:215], v2, s[12:13] offset:-3072
    global_load_dwordx4 a[216:219], v2, s[12:13] offset:-2048
    global_load_dwordx4 a[220:223], v2, s[12:13] offset:-1024
    v_accvgpr_write_b32 a0, 0
    v_accvgpr_write_b32 a1, 0
    v_accvgpr_write_b32 a2, 0
    v_accvgpr_write_b32 a3, 0
    v_accvgpr_write_b32 a4, 0
    v_accvgpr_write_b32 a5, 0
    v_accvgpr_write_b32 a6, 0
    v_accvgpr_write_b32 a7, 0
    v_accvgpr_write_b32 a8, 0
    v_accvgpr_write_b32 a9, 0
    v_accvgpr_write_b32 a10, 0
    v_accvgpr_write_b32 a11, 0
    v_accvgpr_write_b32 a12, 0
    v_accvgpr_write_b32 a13, 0
    v_accvgpr_write_b32 a14, 0
    v_accvgpr_write_b32 a15, 0
    v_accvgpr_write_b32 a16, 0
    v_accvgpr_write_b32 a17, 0
    v_accvgpr_write_b32 a18, 0
    v_accvgpr_write_b32 a19, 0
    v_accvgpr_write_b32 a20, 0
    v_accvgpr_write_b32 a21, 0
    v_accvgpr_write_b32 a22, 0
    v_accvgpr_write_b32 a23, 0
    v_accvgpr_write_b32 a24, 0
    v_accvgpr_write_b32 a25, 0
    v_accvgpr_write_b32 a26, 0
    v_accvgpr_write_b32 a27, 0
    v_accvgpr_write_b32 a28, 0
    v_accvgpr_write_b32 a29, 0
    v_accvgpr_write_b32 a30, 0
    v_accvgpr_write_b32 a31, 0
    v_accvgpr_write_b32 a32, 0
    v_accvgpr_write_b32 a33, 0
    v_accvgpr_write_b32 a34, 0
    v_accvgpr_write_b32 a35, 0
    v_accvgpr_write_b32 a36, 0
    v_accvgpr_write_b32 a37, 0
    v_accvgpr_write_b32 a38, 0
    v_accvgpr_write_b32 a39, 0
    v_accvgpr_write_b32 a40, 0
    v_accvgpr_write_b32 a41, 0
    v_accvgpr_write_b32 a42, 0
    v_accvgpr_write_b32 a43, 0
    v_accvgpr_write_b32 a44, 0
    v_accvgpr_write_b32 a45, 0
    v_accvgpr_write_b32 a46, 0
    v_accvgpr_write_b32 a47, 0
    v_accvgpr_write_b32 a48, 0
    v_accvgpr_write_b32 a49, 0
    v_accvgpr_write_b32 a50, 0
    v_accvgpr_write_b32 a51, 0
    v_accvgpr_write_b32 a52, 0
    v_accvgpr_write_b32 a53, 0
    v_accvgpr_write_b32 a54, 0
    v_accvgpr_write_b32 a55, 0
    v_accvgpr_write_b32 a56, 0
    v_accvgpr_write_b32 a57, 0
    v_accvgpr_write_b32 a58, 0
    v_accvgpr_write_b32 a59, 0
    v_accvgpr_write_b32 a60, 0
    v_accvgpr_write_b32 a61, 0
    v_accvgpr_write_b32 a62, 0
    v_accvgpr_write_b32 a63, 0
    v_accvgpr_write_b32 a64, 0
    v_accvgpr_write_b32 a65, 0
    v_accvgpr_write_b32 a66, 0
    v_accvgpr_write_b32 a67, 0
    v_accvgpr_write_b32 a68, 0
    v_accvgpr_write_b32 a69, 0
    v_accvgpr_write_b32 a70, 0
    v_accvgpr_write_b32 a71, 0
    v_accvgpr_write_b32 a72, 0
    v_accvgpr_write_b32 a73, 0
    v_accvgpr_write_b32 a74, 0
    v_accvgpr_write_b32 a75, 0
    v_accvgpr_write_b32 a76, 0
    v_accvgpr_write_b32 a77, 0
    v_accvgpr_write_b32 a78, 0
    v_accvgpr_write_b32 a79, 0
    v_accvgpr_write_b32 a80, 0
    v_accvgpr_write_b32 a81, 0
    v_accvgpr_write_b32 a82, 0
    v_accvgpr_write_b32 a83, 0
    v_accvgpr_write_b32 a84, 0
    v_accvgpr_write_b32 a85, 0
    v_accvgpr_write_b32 a86, 0
    v_accvgpr_write_b32 a87, 0
    v_accvgpr_write_b32 a88, 0
    v_accvgpr_write_b32 a89, 0
    v_accvgpr_write_b32 a90, 0
    v_accvgpr_write_b32 a91, 0
    v_accvgpr_write_b32 a92, 0
    v_accvgpr_write_b32 a93, 0
    v_accvgpr_write_b32 a94, 0
    v_accvgpr_write_b32 a95, 0
    v_accvgpr_write_b32 a96, 0
    v_accvgpr_write_b32 a97, 0
    v_accvgpr_write_b32 a98, 0
    v_accvgpr_write_b32 a99, 0
    v_accvgpr_write_b32 a100, 0
    v_accvgpr_write_b32 a101, 0
    v_accvgpr_write_b32 a102, 0
    v_accvgpr_write_b32 a103, 0
    v_accvgpr_write_b32 a104, 0
    v_accvgpr_write_b32 a105, 0
    v_accvgpr_write_b32 a106, 0
    v_accvgpr_write_b32 a107, 0
    v_accvgpr_write_b32 a108, 0
    v_accvgpr_write_b32 a109, 0
    v_accvgpr_write_b32 a110, 0
    v_accvgpr_write_b32 a111, 0
    v_accvgpr_write_b32 a112, 0
    v_accvgpr_write_b32 a113, 0
    v_accvgpr_write_b32 a114, 0
    v_accvgpr_write_b32 a115, 0
    v_accvgpr_write_b32 a116, 0
    v_accvgpr_write_b32 a117, 0
    v_accvgpr_write_b32 a118, 0
    v_accvgpr_write_b32 a119, 0
    v_accvgpr_write_b32 a120, 0
    v_accvgpr_write_b32 a121, 0
    v_accvgpr_write_b32 a122, 0
    v_accvgpr_write_b32 a123, 0
    v_accvgpr_write_b32 a124, 0
    v_accvgpr_write_b32 a125, 0
    v_accvgpr_write_b32 a126, 0
    v_accvgpr_write_b32 a127, 0
    v_accvgpr_write_b32 a240, 0
    v_accvgpr_write_b32 a241, 0
    v_accvgpr_write_b32 a242, 0
    v_accvgpr_write_b32 a243, 0
    v_accvgpr_write_b32 a244, 0
    v_accvgpr_write_b32 a245, 0
    v_accvgpr_write_b32 a246, 0
    v_accvgpr_write_b32 a247, 0
    v_accvgpr_write_b32 a248, 0
    v_accvgpr_write_b32 a249, 0
    v_accvgpr_write_b32 a250, 0
    v_accvgpr_write_b32 a251, 0
    v_accvgpr_write_b32 a252, 0
    v_accvgpr_write_b32 a253, 0
    v_accvgpr_write_b32 a254, 0
    v_accvgpr_write_b32 a255, 0
    v_mov_b32 v88, 0
    v_mov_b32 v89, 0
    v_mov_b32 v90, 0
    v_mov_b32 v91, 0
    v_mov_b32 v92, 0
    v_mov_b32 v93, 0
    v_mov_b32 v94, 0
    v_mov_b32 v95, 0
    v_mov_b32 v160, 0
    v_mov_b32 v161, 0
    v_mov_b32 v162, 0
    v_mov_b32 v163, 0
    v_mov_b32 v164, 0
    v_mov_b32 v165, 0
    v_mov_b32 v166, 0
    v_mov_b32 v167, 0
    v_mov_b32 v168, 0
    v_mov_b32 v169, 0
    v_mov_b32 v170, 0
    v_mov_b32 v171, 0
    v_mov_b32 v172, 0
    v_mov_b32 v173, 0
    v_mov_b32 v174, 0
    v_mov_b32 v175, 0
    v_mov_b32 v78, 0
    v_mov_b32 v79, 0
    s_mov_b32 s27, s28
    s_mov_b32 s48, 0
    s_mov_b32 s49, 0
    s_waitcnt vmcnt(8)
    v_mfma_f32_32x32x16_bf16 v[16:31], a[192:195], a[128:131], v[96:111]
    v_mfma_f32_32x32x16_bf16 v[16:31], a[196:199], a[132:135], v[16:31]
    v_mfma_f32_32x32x16_bf16 v[16:31], a[200:203], a[136:139], v[16:31]
    v_mfma_f32_32x32x16_bf16 v[16:31], a[204:207], a[140:143], v[16:31]
    s_nop 7
    s_nop 3
.p2align 6
attn_loop:
    v_mfma_f32_32x32x16_bf16 v[32:47], a[192:195], a[144:147], v[112:127]
    v_exp_f32 v16, v16
    v_exp_f32 v17, v17
    v_cvt_pk_bf16_f32 v95, v78, v79
    v_mfma_f32_32x32x16_bf16 v[32:47], a[196:199], a[148:151], v[32:47]
    v_exp_f32 v18, v18
    v_exp_f32 v19, v19
    v_cvt_pk_bf16_f32 v80, v16, v17
    v_mfma_f32_32x32x16_bf16 v[32:47], a[200:203], a[152:155], v[32:47]
    v_exp_f32 v20, v20
    v_exp_f32 v21, v21
    v_cvt_pk_bf16_f32 v81, v18, v19
    v_mfma_f32_32x32x16_bf16 v[32:47], a[204:207], a[156:159], v[32:47]
    v_exp_f32 v22, v22
    v_exp_f32 v23, v23
    v_cvt_pk_bf16_f32 v82, v20, v21
    v_mfma_f32_32x32x16_bf16 a[96:111], a[240:243], v[88:91], a[96:111]
    v_exp_f32 v24, v24
    v_exp_f32 v25, v25
    v_cvt_pk_bf16_f32 v83, v22, v23
    v_mfma_f32_32x32x16_bf16 a[112:127], a[248:251], v[88:91], a[112:127]
    v_exp_f32 v26, v26
    v_exp_f32 v27, v27
    v_cvt_pk_bf16_f32 v84, v24, v25
    v_mfma_f32_32x32x16_bf16 a[96:111], a[244:247], v[92:95], a[96:111]
    v_exp_f32 v28, v28
    v_exp_f32 v29, v29
    v_cvt_pk_bf16_f32 v85, v26, v27
    v_mfma_f32_32x32x16_bf16 a[112:127], a[252:255], v[92:95], a[112:127]
    v_exp_f32 v30, v30
    v_exp_f32 v31, v31
    v_cvt_pk_bf16_f32 v86, v28, v29
    v_smfmac_f32_16x16x64_bf16 v[172:175], v[176:179], v[88:95], v180
    s_load_dwordx2 s[60:61], s[46:47], s49 offset:60
    v_mfma_f32_32x32x16_bf16 v[48:63], a[192:195], a[160:163], v[128:143]
    v_exp_f32 v32, v32
    v_exp_f32 v33, v33
    v_cvt_pk_bf16_f32 v87, v30, v31
    v_mfma_f32_32x32x16_bf16 v[48:63], a[196:199], a[164:167], v[48:63]
    v_exp_f32 v34, v34
    v_exp_f32 v35, v35
    v_cvt_pk_bf16_f32 v88, v32, v33
    v_mfma_f32_32x32x16_bf16 v[48:63], a[200:203], a[168:171], v[48:63]
    v_exp_f32 v36, v36
    v_exp_f32 v37, v37
    v_cvt_pk_bf16_f32 v89, v34, v35
    v_mfma_f32_32x32x16_bf16 v[48:63], a[204:207], a[172:175], v[48:63]
    s_waitcnt vmcnt(4)
    v_exp_f32 v38, v38
    v_exp_f32 v39, v39
    v_cvt_pk_bf16_f32 v90, v36, v37
    v_mfma_f32_32x32x16_bf16 a[0:15], a[224:227], v[80:83], a[0:15]
    global_load_dwordx4 a[240:243], v2, s[12:13] offset:0
    v_exp_f32 v40, v40
    v_exp_f32 v41, v41
    v_cvt_pk_bf16_f32 v91, v38, v39
    v_mfma_f32_32x32x16_bf16 a[16:31], a[232:235], v[80:83], a[16:31]
    global_load_dwordx4 a[244:247], v2, s[12:13] offset:1024
    v_exp_f32 v42, v42
    v_exp_f32 v43, v43
    v_cvt_pk_bf16_f32 v92, v40, v41
    v_mfma_f32_32x32x16_bf16 a[0:15], a[228:231], v[84:87], a[0:15]
    global_load_dwordx4 a[248:251], v2, s[12:13] offset:2048
    v_exp_f32 v44, v44
    v_exp_f32 v45, v45
    v_cvt_pk_bf16_f32 v93, v42, v43
    v_mfma_f32_32x32x16_bf16 a[16:31], a[236:239], v[84:87], a[16:31]
    global_load_dwordx4 a[252:255], v2, s[12:13] offset:3072
    v_exp_f32 v46, v46
    v_exp_f32 v47, v47
    v_cvt_pk_bf16_f32 v94, v44, v45
    v_smfmac_f32_16x16x64_bf16 v[160:163], v[176:179], v[80:87], v180
    s_load_dwordx2 s[60:61], s[44:45], s48 offset:60
    v_mfma_f32_32x32x16_bf16 v[64:79], a[192:195], a[176:179], v[144:159]
    s_add_u32 s23, s23, 32768
    v_exp_f32 v48, v48
    v_exp_f32 v49, v49
    v_cvt_pk_bf16_f32 v95, v46, v47
    v_mfma_f32_32x32x16_bf16 v[64:79], a[196:199], a[180:183], v[64:79]
    s_cmp_ge_u32 s23, s26
    v_exp_f32 v50, v50
    v_exp_f32 v51, v51
    v_cvt_pk_bf16_f32 v80, v48, v49
    v_mfma_f32_32x32x16_bf16 v[64:79], a[200:203], a[184:187], v[64:79]
    s_cselect_b32 s23, s25, s23
    v_exp_f32 v52, v52
    v_exp_f32 v53, v53
    v_cvt_pk_bf16_f32 v81, v50, v51
    v_mfma_f32_32x32x16_bf16 v[64:79], a[204:207], a[188:191], v[64:79]
    s_cmp_eq_u32 s27, 1
    v_exp_f32 v54, v54
    v_exp_f32 v55, v55
    v_cvt_pk_bf16_f32 v82, v52, v53
    v_mfma_f32_32x32x16_bf16 a[32:47], a[224:227], v[88:91], a[32:47]
    s_cselect_b32 s23, 1019904, s23
    v_exp_f32 v56, v56
    v_exp_f32 v57, v57
    v_cvt_pk_bf16_f32 v83, v54, v55
    v_mfma_f32_32x32x16_bf16 a[48:63], a[232:235], v[88:91], a[48:63]
    v_add_u32 v2, s23, v1
    v_exp_f32 v58, v58
    v_exp_f32 v59, v59
    v_cvt_pk_bf16_f32 v84, v56, v57
    v_mfma_f32_32x32x16_bf16 a[32:47], a[228:231], v[92:95], a[32:47]
    s_waitcnt vmcnt(4)
    v_exp_f32 v60, v60
    v_exp_f32 v61, v61
    v_cvt_pk_bf16_f32 v85, v58, v59
    v_mfma_f32_32x32x16_bf16 a[48:63], a[236:239], v[92:95], a[48:63]
    s_sub_u32 s27, s27, 1
    v_exp_f32 v62, v62
    v_exp_f32 v63, v63
    v_cvt_pk_bf16_f32 v86, v60, v61
    v_smfmac_f32_16x16x64_bf16 v[164:167], v[176:179], v[88:95], v180
    s_load_dwordx2 s[60:61], s[52:53], s49 offset:60
    v_mfma_f32_32x32x16_bf16 v[16:31], a[208:211], a[128:131], v[96:111]
    s_add_u32 s49, s49, 128
    v_exp_f32 v64, v64
    v_exp_f32 v65, v65
    v_cvt_pk_bf16_f32 v87, v62, v63
    v_mfma_f32_32x32x16_bf16 v[16:31], a[212:215], a[132:135], v[16:31]
    global_load_dwordx4 a[192:195], v2, s[12:13] offset:-4096
    v_exp_f32 v66, v66
    v_exp_f32 v67, v67
    v_cvt_pk_bf16_f32 v88, v64, v65
    v_mfma_f32_32x32x16_bf16 v[16:31], a[216:219], a[136:139], v[16:31]
    global_load_dwordx4 a[196:199], v2, s[12:13] offset:-3072
    v_exp_f32 v68, v68
    v_exp_f32 v69, v69
    v_cvt_pk_bf16_f32 v89, v66, v67
    v_mfma_f32_32x32x16_bf16 v[16:31], a[220:223], a[140:143], v[16:31]
    global_load_dwordx4 a[200:203], v2, s[12:13] offset:-2048
    v_exp_f32 v70, v70
    v_exp_f32 v71, v71
    v_cvt_pk_bf16_f32 v90, v68, v69
    v_mfma_f32_32x32x16_bf16 a[64:79], a[224:227], v[80:83], a[64:79]
    global_load_dwordx4 a[204:207], v2, s[12:13] offset:-1024
    v_exp_f32 v72, v72
    v_exp_f32 v73, v73
    v_cvt_pk_bf16_f32 v91, v70, v71
    v_mfma_f32_32x32x16_bf16 a[80:95], a[232:235], v[80:83], a[80:95]
    s_add_u32 s48, s48, 256
    v_exp_f32 v74, v74
    v_exp_f32 v75, v75
    v_cvt_pk_bf16_f32 v92, v72, v73
    v_mfma_f32_32x32x16_bf16 a[64:79], a[228:231], v[84:87], a[64:79]
    v_exp_f32 v76, v76
    v_exp_f32 v77, v77
    v_cvt_pk_bf16_f32 v93, v74, v75
    v_mfma_f32_32x32x16_bf16 a[80:95], a[236:239], v[84:87], a[80:95]
    s_cmp_lt_i32 s27, 0
    v_exp_f32 v78, v78
    v_exp_f32 v79, v79
    v_cvt_pk_bf16_f32 v94, v76, v77
    v_smfmac_f32_16x16x64_bf16 v[168:171], v[176:179], v[80:87], v180
    s_load_dwordx2 s[60:61], s[44:45], s48 offset:-68
    s_cbranch_scc1 attn_exit0
attn_loop1:
    v_mfma_f32_32x32x16_bf16 v[32:47], a[208:211], a[144:147], v[112:127]
    v_exp_f32 v16, v16
    v_exp_f32 v17, v17
    v_cvt_pk_bf16_f32 v95, v78, v79
    v_mfma_f32_32x32x16_bf16 v[32:47], a[212:215], a[148:151], v[32:47]
    v_exp_f32 v18, v18
    v_exp_f32 v19, v19
    v_cvt_pk_bf16_f32 v80, v16, v17
    v_mfma_f32_32x32x16_bf16 v[32:47], a[216:219], a[152:155], v[32:47]
    v_exp_f32 v20, v20
    v_exp_f32 v21, v21
    v_cvt_pk_bf16_f32 v81, v18, v19
    v_mfma_f32_32x32x16_bf16 v[32:47], a[220:223], a[156:159], v[32:47]
    v_exp_f32 v22, v22
    v_exp_f32 v23, v23
    v_cvt_pk_bf16_f32 v82, v20, v21
    v_mfma_f32_32x32x16_bf16 a[96:111], a[224:227], v[88:91], a[96:111]
    v_exp_f32 v24, v24
    v_exp_f32 v25, v25
    v_cvt_pk_bf16_f32 v83, v22, v23
    v_mfma_f32_32x32x16_bf16 a[112:127], a[232:235], v[88:91], a[112:127]
    v_exp_f32 v26, v26
    v_exp_f32 v27, v27
    v_cvt_pk_bf16_f32 v84, v24, v25
    v_mfma_f32_32x32x16_bf16 a[96:111], a[228:231], v[92:95], a[96:111]
    v_exp_f32 v28, v28
    v_exp_f32 v29, v29
    v_cvt_pk_bf16_f32 v85, v26, v27
    v_mfma_f32_32x32x16_bf16 a[112:127], a[236:239], v[92:95], a[112:127]
    v_exp_f32 v30, v30
    v_exp_f32 v31, v31
    v_cvt_pk_bf16_f32 v86, v28, v29
    v_smfmac_f32_16x16x64_bf16 v[172:175], v[176:179], v[88:95], v180
    s_load_dwordx2 s[60:61], s[46:47], s49 offset:60
    v_mfma_f32_32x32x16_bf16 v[48:63], a[208:211], a[160:163], v[128:143]
    v_exp_f32 v32, v32
    v_exp_f32 v33, v33
    v_cvt_pk_bf16_f32 v87, v30, v31
    v_mfma_f32_32x32x16_bf16 v[48:63], a[212:215], a[164:167], v[48:63]
    v_exp_f32 v34, v34
    v_exp_f32 v35, v35
    v_cvt_pk_bf16_f32 v88, v32, v33
    v_mfma_f32_32x32x16_bf16 v[48:63], a[216:219], a[168:171], v[48:63]
    v_exp_f32 v36, v36
    v_exp_f32 v37, v37
    v_cvt_pk_bf16_f32 v89, v34, v35
    v_mfma_f32_32x32x16_bf16 v[48:63], a[220:223], a[172:175], v[48:63]
    s_waitcnt vmcnt(4)
    v_exp_f32 v38, v38
    v_exp_f32 v39, v39
    v_cvt_pk_bf16_f32 v90, v36, v37
    v_mfma_f32_32x32x16_bf16 a[0:15], a[240:243], v[80:83], a[0:15]
    global_load_dwordx4 a[224:227], v2, s[12:13] offset:0
    v_exp_f32 v40, v40
    v_exp_f32 v41, v41
    v_cvt_pk_bf16_f32 v91, v38, v39
    v_mfma_f32_32x32x16_bf16 a[16:31], a[248:251], v[80:83], a[16:31]
    global_load_dwordx4 a[228:231], v2, s[12:13] offset:1024
    v_exp_f32 v42, v42
    v_exp_f32 v43, v43
    v_cvt_pk_bf16_f32 v92, v40, v41
    v_mfma_f32_32x32x16_bf16 a[0:15], a[244:247], v[84:87], a[0:15]
    global_load_dwordx4 a[232:235], v2, s[12:13] offset:2048
    v_exp_f32 v44, v44
    v_exp_f32 v45, v45
    v_cvt_pk_bf16_f32 v93, v42, v43
    v_mfma_f32_32x32x16_bf16 a[16:31], a[252:255], v[84:87], a[16:31]
    global_load_dwordx4 a[236:239], v2, s[12:13] offset:3072
    v_exp_f32 v46, v46
    v_exp_f32 v47, v47
    v_cvt_pk_bf16_f32 v94, v44, v45
    v_smfmac_f32_16x16x64_bf16 v[160:163], v[176:179], v[80:87], v180
    s_load_dwordx2 s[60:61], s[44:45], s48 offset:60
    v_mfma_f32_32x32x16_bf16 v[64:79], a[208:211], a[176:179], v[144:159]
    s_add_u32 s23, s23, 32768
    v_exp_f32 v48, v48
    v_exp_f32 v49, v49
    v_cvt_pk_bf16_f32 v95, v46, v47
    v_mfma_f32_32x32x16_bf16 v[64:79], a[212:215], a[180:183], v[64:79]
    s_cmp_ge_u32 s23, s26
    v_exp_f32 v50, v50
    v_exp_f32 v51, v51
    v_cvt_pk_bf16_f32 v80, v48, v49
    v_mfma_f32_32x32x16_bf16 v[64:79], a[216:219], a[184:187], v[64:79]
    s_cselect_b32 s23, s25, s23
    v_exp_f32 v52, v52
    v_exp_f32 v53, v53
    v_cvt_pk_bf16_f32 v81, v50, v51
    v_mfma_f32_32x32x16_bf16 v[64:79], a[220:223], a[188:191], v[64:79]
    s_cmp_eq_u32 s27, 1
    v_exp_f32 v54, v54
    v_exp_f32 v55, v55
    v_cvt_pk_bf16_f32 v82, v52, v53
    v_mfma_f32_32x32x16_bf16 a[32:47], a[240:243], v[88:91], a[32:47]
    s_cselect_b32 s23, 1019904, s23
    v_exp_f32 v56, v56
    v_exp_f32 v57, v57
    v_cvt_pk_bf16_f32 v83, v54, v55
    v_mfma_f32_32x32x16_bf16 a[48:63], a[248:251], v[88:91], a[48:63]
    v_add_u32 v2, s23, v1
    v_exp_f32 v58, v58
    v_exp_f32 v59, v59
    v_cvt_pk_bf16_f32 v84, v56, v57
    v_mfma_f32_32x32x16_bf16 a[32:47], a[244:247], v[92:95], a[32:47]
    s_waitcnt vmcnt(4)
    v_exp_f32 v60, v60
    v_exp_f32 v61, v61
    v_cvt_pk_bf16_f32 v85, v58, v59
    v_mfma_f32_32x32x16_bf16 a[48:63], a[252:255], v[92:95], a[48:63]
    s_sub_u32 s27, s27, 1
    v_exp_f32 v62, v62
    v_exp_f32 v63, v63
    v_cvt_pk_bf16_f32 v86, v60, v61
    v_smfmac_f32_16x16x64_bf16 v[164:167], v[176:179], v[88:95], v180
    s_load_dwordx2 s[60:61], s[52:53], s49 offset:60
    v_mfma_f32_32x32x16_bf16 v[16:31], a[192:195], a[128:131], v[96:111]
    s_add_u32 s49, s49, 128
    v_exp_f32 v64, v64
    v_exp_f32 v65, v65
    v_cvt_pk_bf16_f32 v87, v62, v63
    v_mfma_f32_32x32x16_bf16 v[16:31], a[196:199], a[132:135], v[16:31]
    global_load_dwordx4 a[208:211], v2, s[12:13] offset:-4096
    v_exp_f32 v66, v66
    v_exp_f32 v67, v67
    v_cvt_pk_bf16_f32 v88, v64, v65
    v_mfma_f32_32x32x16_bf16 v[16:31], a[200:203], a[136:139], v[16:31]
    global_load_dwordx4 a[212:215], v2, s[12:13] offset:-3072
    v_exp_f32 v68, v68
    v_exp_f32 v69, v69
    v_cvt_pk_bf16_f32 v89, v66, v67
    v_mfma_f32_32x32x16_bf16 v[16:31], a[204:207], a[140:143], v[16:31]
    global_load_dwordx4 a[216:219], v2, s[12:13] offset:-2048
    v_exp_f32 v70, v70
    v_exp_f32 v71, v71
    v_cvt_pk_bf16_f32 v90, v68, v69
    v_mfma_f32_32x32x16_bf16 a[64:79], a[240:243], v[80:83], a[64:79]
    global_load_dwordx4 a[220:223], v2, s[12:13] offset:-1024
    v_exp_f32 v72, v72
    v_exp_f32 v73, v73
    v_cvt_pk_bf16_f32 v91, v70, v71
    v_mfma_f32_32x32x16_bf16 a[80:95], a[248:251], v[80:83], a[80:95]
    s_add_u32 s48, s48, 256
    v_exp_f32 v74, v74
    v_exp_f32 v75, v75
    v_cvt_pk_bf16_f32 v92, v72, v73
    v_mfma_f32_32x32x16_bf16 a[64:79], a[244:247], v[84:87], a[64:79]
    v_exp_f32 v76, v76
    v_exp_f32 v77, v77
    v_cvt_pk_bf16_f32 v93, v74, v75
    v_mfma_f32_32x32x16_bf16 a[80:95], a[252:255], v[84:87], a[80:95]
    v_exp_f32 v78, v78
    v_exp_f32 v79, v79
    v_cvt_pk_bf16_f32 v94, v76, v77
    v_smfmac_f32_16x16x64_bf16 v[168:171], v[176:179], v[80:87], v180
    s_load_dwordx2 s[60:61], s[44:45], s48 offset:-68
    s_branch attn_loop
attn_exit0:
    v_cvt_pk_bf16_f32 v95, v78, v79
    s_load_dwordx2 s[60:61], s[50:51], s35 offset:60
    s_load_dwordx2 s[60:61], s[50:51], s35 offset:188
    s_cmp_lg_u32 s20, 0
    s_cbranch_scc1 attn_tail1
    v_mfma_f32_32x32x16_bf16 a[96:111], a[224:227], v[88:91], a[96:111]
    ds_write_b128 v216, a[32:35] offset:32768
    v_mfma_f32_32x32x16_bf16 a[112:127], a[232:235], v[88:91], a[112:127]
    ds_write_b128 v216, a[36:39] offset:33792
    ds_write_b128 v216, a[40:43] offset:34816
    v_mfma_f32_32x32x16_bf16 a[96:111], a[228:231], v[92:95], a[96:111]
    ds_write_b128 v216, a[44:47] offset:35840
    v_mfma_f32_32x32x16_bf16 a[112:127], a[236:239], v[92:95], a[112:127]
    ds_write_b128 v216, a[48:51] offset:36864
    ds_write_b128 v216, a[52:55] offset:37888
    v_smfmac_f32_16x16x64_bf16 v[172:175], v[176:179], v[88:95], v180
    ds_write_b128 v216, a[56:59] offset:38912
    ds_write_b128 v216, a[60:63] offset:39936
    v_exp_f32 v16, v16
    v_exp_f32 v17, v17
    v_exp_f32 v18, v18
    ds_write_b128 v217, a[64:67] offset:0
    v_exp_f32 v19, v19
    v_cvt_pk_bf16_f32 v80, v16, v17
    v_exp_f32 v20, v20
    ds_write_b128 v217, a[68:71] offset:1024
    v_exp_f32 v21, v21
    v_cvt_pk_bf16_f32 v81, v18, v19
    v_exp_f32 v22, v22
    ds_write_b128 v217, a[72:75] offset:2048
    v_exp_f32 v23, v23
    v_cvt_pk_bf16_f32 v82, v20, v21
    v_exp_f32 v24, v24
    ds_write_b128 v217, a[76:79] offset:3072
    v_exp_f32 v25, v25
    v_cvt_pk_bf16_f32 v83, v22, v23
    v_exp_f32 v26, v26
    ds_write_b128 v217, a[80:83] offset:4096
    v_exp_f32 v27, v27
    v_cvt_pk_bf16_f32 v84, v24, v25
    v_exp_f32 v28, v28
    ds_write_b128 v217, a[84:87] offset:5120
    v_exp_f32 v29, v29
    v_cvt_pk_bf16_f32 v85, v26, v27
    v_exp_f32 v30, v30
    ds_write_b128 v217, a[88:91] offset:6144
    v_exp_f32 v31, v31
    v_cvt_pk_bf16_f32 v86, v28, v29
    ds_write_b128 v217, a[92:95] offset:7168
    s_nop 0
    v_cvt_pk_bf16_f32 v87, v30, v31
    s_waitcnt vmcnt(4)
    v_mfma_f32_32x32x16_bf16 a[0:15], a[240:243], v[80:83], a[0:15]
    ds_write_b128 v217, a[96:99] offset:32768
    v_mfma_f32_32x32x16_bf16 a[16:31], a[248:251], v[80:83], a[16:31]
    ds_write_b128 v217, a[100:103] offset:33792
    ds_write_b128 v217, a[104:107] offset:34816
    v_mfma_f32_32x32x16_bf16 a[0:15], a[244:247], v[84:87], a[0:15]
    ds_write_b128 v217, a[108:111] offset:35840
    v_mfma_f32_32x32x16_bf16 a[16:31], a[252:255], v[84:87], a[16:31]
    ds_write_b128 v217, a[112:115] offset:36864
    ds_write_b128 v217, a[116:119] offset:37888
    v_smfmac_f32_16x16x64_bf16 v[160:163], v[176:179], v[80:87], v180
    ds_write_b128 v217, a[120:123] offset:38912
    ds_write_b128 v217, a[124:127] offset:39936
    v_mov_b32 v192, v96
    v_mov_b32 v194, v112
    v_mov_b32 v196, v128
    v_mov_b32 v198, v144
    s_nop 5
    v_accvgpr_read_b32 v16, a0
    v_accvgpr_read_b32 v17, a1
    v_accvgpr_read_b32 v18, a2
    v_accvgpr_read_b32 v19, a3
    v_accvgpr_read_b32 v20, a4
    v_accvgpr_read_b32 v21, a5
    v_accvgpr_read_b32 v22, a6
    v_accvgpr_read_b32 v23, a7
    v_accvgpr_read_b32 v24, a8
    v_accvgpr_read_b32 v25, a9
    v_accvgpr_read_b32 v26, a10
    v_accvgpr_read_b32 v27, a11
    v_accvgpr_read_b32 v28, a12
    v_accvgpr_read_b32 v29, a13
    v_accvgpr_read_b32 v30, a14
    v_accvgpr_read_b32 v31, a15
    v_accvgpr_read_b32 v32, a16
    v_accvgpr_read_b32 v33, a17
    v_accvgpr_read_b32 v34, a18
    v_accvgpr_read_b32 v35, a19
    v_accvgpr_read_b32 v36, a20
    v_accvgpr_read_b32 v37, a21
    v_accvgpr_read_b32 v38, a22
    v_accvgpr_read_b32 v39, a23
    v_accvgpr_read_b32 v40, a24
    v_accvgpr_read_b32 v41, a25
    v_accvgpr_read_b32 v42, a26
    v_accvgpr_read_b32 v43, a27
    v_accvgpr_read_b32 v44, a28
    v_accvgpr_read_b32 v45, a29
    v_accvgpr_read_b32 v46, a30
    v_accvgpr_read_b32 v47, a31
    s_branch attn_done
attn_tail1:
    s_cmp_lg_u32 s20, 1
    s_cbranch_scc1 attn_tail2
    v_mfma_f32_32x32x16_bf16 v[32:47], a[208:211], a[144:147], v[112:127]
    ds_write_b128 v216, a[0:3] offset:0
    v_mfma_f32_32x32x16_bf16 v[32:47], a[212:215], a[148:151], v[32:47]
    ds_write_b128 v216, a[4:7] offset:1024
    ds_write_b128 v216, a[8:11] offset:2048
    v_mfma_f32_32x32x16_bf16 v[32:47], a[216:219], a[152:155], v[32:47]
    ds_write_b128 v216, a[12:15] offset:3072
    ds_write_b128 v216, a[16:19] offset:4096
    v_mfma_f32_32x32x16_bf16 v[32:47], a[220:223], a[156:159], v[32:47]
    ds_write_b128 v216, a[20:23] offset:5120
    ds_write_b128 v216, a[24:27] offset:6144
    v_mfma_f32_32x32x16_bf16 a[96:111], a[224:227], v[88:91], a[96:111]
    ds_write_b128 v216, a[28:31] offset:7168
    v_mfma_f32_32x32x16_bf16 a[112:127], a[232:235], v[88:91], a[112:127]
    ds_write_b128 v217, a[64:67] offset:0
    ds_write_b128 v217, a[68:71] offset:1024
    v_mfma_f32_32x32x16_bf16 a[96:111], a[228:231], v[92:95], a[96:111]
    ds_write_b128 v217, a[72:75] offset:2048
    ds_write_b128 v217, a[76:79] offset:3072
    v_mfma_f32_32x32x16_bf16 a[112:127], a[236:239], v[92:95], a[112:127]
    ds_write_b128 v217, a[80:83] offset:4096
    ds_write_b128 v217, a[84:87] offset:5120
    v_smfmac_f32_16x16x64_bf16 v[172:175], v[176:179], v[88:95], v180
    ds_write_b128 v217, a[88:91] offset:6144
    ds_write_b128 v217, a[92:95] offset:7168
    v_exp_f32 v32, v32
    v_exp_f32 v33, v33
    v_exp_f32 v34, v34
    v_exp_f32 v35, v35
    v_cvt_pk_bf16_f32 v80, v32, v33
    v_exp_f32 v36, v36
    v_exp_f32 v37, v37
    v_cvt_pk_bf16_f32 v81, v34, v35
    v_exp_f32 v38, v38
    v_exp_f32 v39, v39
    v_cvt_pk_bf16_f32 v82, v36, v37
    v_exp_f32 v40, v40
    v_exp_f32 v41, v41
    v_cvt_pk_bf16_f32 v83, v38, v39
    ds_write_b128 v217, a[96:99] offset:32768
    v_exp_f32 v42, v42
    v_exp_f32 v43, v43
    v_cvt_pk_bf16_f32 v84, v40, v41
    ds_write_b128 v217, a[100:103] offset:33792
    v_exp_f32 v44, v44
    v_exp_f32 v45, v45
    v_cvt_pk_bf16_f32 v85, v42, v43
    ds_write_b128 v217, a[104:107] offset:34816
    v_exp_f32 v46, v46
    v_exp_f32 v47, v47
    v_cvt_pk_bf16_f32 v86, v44, v45
    ds_write_b128 v217, a[108:111] offset:35840
    s_nop 0
    v_cvt_pk_bf16_f32 v87, v46, v47
    s_waitcnt vmcnt(4)
    v_mfma_f32_32x32x16_bf16 a[32:47], a[240:243], v[80:83], a[32:47]
    v_mfma_f32_32x32x16_bf16 a[48:63], a[248:251], v[80:83], a[48:63]
    ds_write_b128 v217, a[112:115] offset:36864
    v_mfma_f32_32x32x16_bf16 a[32:47], a[244:247], v[84:87], a[32:47]
    ds_write_b128 v217, a[116:119] offset:37888
    v_mfma_f32_32x32x16_bf16 a[48:63], a[252:255], v[84:87], a[48:63]
    ds_write_b128 v217, a[120:123] offset:38912
    v_smfmac_f32_16x16x64_bf16 v[164:167], v[176:179], v[80:87], v180
    ds_write_b128 v217, a[124:127] offset:39936
    v_mov_b32 v192, v96
    v_mov_b32 v194, v112
    v_mov_b32 v196, v128
    v_mov_b32 v198, v144
    s_nop 5
    v_accvgpr_read_b32 v16, a32
    v_accvgpr_read_b32 v17, a33
    v_accvgpr_read_b32 v18, a34
    v_accvgpr_read_b32 v19, a35
    v_accvgpr_read_b32 v20, a36
    v_accvgpr_read_b32 v21, a37
    v_accvgpr_read_b32 v22, a38
    v_accvgpr_read_b32 v23, a39
    v_accvgpr_read_b32 v24, a40
    v_accvgpr_read_b32 v25, a41
    v_accvgpr_read_b32 v26, a42
    v_accvgpr_read_b32 v27, a43
    v_accvgpr_read_b32 v28, a44
    v_accvgpr_read_b32 v29, a45
    v_accvgpr_read_b32 v30, a46
    v_accvgpr_read_b32 v31, a47
    v_accvgpr_read_b32 v32, a48
    v_accvgpr_read_b32 v33, a49
    v_accvgpr_read_b32 v34, a50
    v_accvgpr_read_b32 v35, a51
    v_accvgpr_read_b32 v36, a52
    v_accvgpr_read_b32 v37, a53
    v_accvgpr_read_b32 v38, a54
    v_accvgpr_read_b32 v39, a55
    v_accvgpr_read_b32 v40, a56
    v_accvgpr_read_b32 v41, a57
    v_accvgpr_read_b32 v42, a58
    v_accvgpr_read_b32 v43, a59
    v_accvgpr_read_b32 v44, a60
    v_accvgpr_read_b32 v45, a61
    v_accvgpr_read_b32 v46, a62
    v_accvgpr_read_b32 v47, a63
    s_branch attn_done
attn_tail2:
    s_cmp_lg_u32 s20, 2
    s_cbranch_scc1 attn_tail3
    v_mfma_f32_32x32x16_bf16 v[32:47], a[208:211], a[160:163], v[128:143]
    ds_write_b128 v216, a[0:3] offset:0
    v_mfma_f32_32x32x16_bf16 v[32:47], a[212:215], a[164:167], v[32:47]
    ds_write_b128 v216, a[4:7] offset:1024
    ds_write_b128 v216, a[8:11] offset:2048
    v_mfma_f32_32x32x16_bf16 v[32:47], a[216:219], a[168:171], v[32:47]
    ds_write_b128 v216, a[12:15] offset:3072
    ds_write_b128 v216, a[16:19] offset:4096
    v_mfma_f32_32x32x16_bf16 v[32:47], a[220:223], a[172:175], v[32:47]
    ds_write_b128 v216, a[20:23] offset:5120
    ds_write_b128 v216, a[24:27] offset:6144
    v_mfma_f32_32x32x16_bf16 a[96:111], a[224:227], v[88:91], a[96:111]
    ds_write_b128 v216, a[28:31] offset:7168
    v_mfma_f32_32x32x16_bf16 a[112:127], a[232:235], v[88:91], a[112:127]
    ds_write_b128 v216, a[32:35] offset:32768
    ds_write_b128 v216, a[36:39] offset:33792
    v_mfma_f32_32x32x16_bf16 a[96:111], a[228:231], v[92:95], a[96:111]
    ds_write_b128 v216, a[40:43] offset:34816
    ds_write_b128 v216, a[44:47] offset:35840
    v_mfma_f32_32x32x16_bf16 a[112:127], a[236:239], v[92:95], a[112:127]
    ds_write_b128 v216, a[48:51] offset:36864
    ds_write_b128 v216, a[52:55] offset:37888
    v_smfmac_f32_16x16x64_bf16 v[172:175], v[176:179], v[88:95], v180
    ds_write_b128 v216, a[56:59] offset:38912
    ds_write_b128 v216, a[60:63] offset:39936
    v_exp_f32 v32, v32
    v_exp_f32 v33, v33
    v_exp_f32 v34, v34
    v_exp_f32 v35, v35
    v_cvt_pk_bf16_f32 v80, v32, v33
    v_exp_f32 v36, v36
    v_exp_f32 v37, v37
    v_cvt_pk_bf16_f32 v81, v34, v35
    v_exp_f32 v38, v38
    v_exp_f32 v39, v39
    v_cvt_pk_bf16_f32 v82, v36, v37
    v_exp_f32 v40, v40
    v_exp_f32 v41, v41
    v_cvt_pk_bf16_f32 v83, v38, v39
    ds_write_b128 v217, a[96:99] offset:32768
    v_exp_f32 v42, v42
    v_exp_f32 v43, v43
    v_cvt_pk_bf16_f32 v84, v40, v41
    ds_write_b128 v217, a[100:103] offset:33792
    v_exp_f32 v44, v44
    v_exp_f32 v45, v45
    v_cvt_pk_bf16_f32 v85, v42, v43
    ds_write_b128 v217, a[104:107] offset:34816
    v_exp_f32 v46, v46
    v_exp_f32 v47, v47
    v_cvt_pk_bf16_f32 v86, v44, v45
    ds_write_b128 v217, a[108:111] offset:35840
    s_nop 0
    v_cvt_pk_bf16_f32 v87, v46, v47
    s_waitcnt vmcnt(4)
    v_mfma_f32_32x32x16_bf16 a[64:79], a[240:243], v[80:83], a[64:79]
    v_mfma_f32_32x32x16_bf16 a[80:95], a[248:251], v[80:83], a[80:95]
    ds_write_b128 v217, a[112:115] offset:36864
    v_mfma_f32_32x32x16_bf16 a[64:79], a[244:247], v[84:87], a[64:79]
    ds_write_b128 v217, a[116:119] offset:37888
    v_mfma_f32_32x32x16_bf16 a[80:95], a[252:255], v[84:87], a[80:95]
    ds_write_b128 v217, a[120:123] offset:38912
    v_smfmac_f32_16x16x64_bf16 v[168:171], v[176:179], v[80:87], v180
    ds_write_b128 v217, a[124:127] offset:39936
    v_mov_b32 v192, v96
    v_mov_b32 v194, v112
    v_mov_b32 v196, v128
    v_mov_b32 v198, v144
    s_nop 5
    v_accvgpr_read_b32 v16, a64
    v_accvgpr_read_b32 v17, a65
    v_accvgpr_read_b32 v18, a66
    v_accvgpr_read_b32 v19, a67
    v_accvgpr_read_b32 v20, a68
    v_accvgpr_read_b32 v21, a69
    v_accvgpr_read_b32 v22, a70
    v_accvgpr_read_b32 v23, a71
    v_accvgpr_read_b32 v24, a72
    v_accvgpr_read_b32 v25, a73
    v_accvgpr_read_b32 v26, a74
    v_accvgpr_read_b32 v27, a75
    v_accvgpr_read_b32 v28, a76
    v_accvgpr_read_b32 v29, a77
    v_accvgpr_read_b32 v30, a78
    v_accvgpr_read_b32 v31, a79
    v_accvgpr_read_b32 v32, a80
    v_accvgpr_read_b32 v33, a81
    v_accvgpr_read_b32 v34, a82
    v_accvgpr_read_b32 v35, a83
    v_accvgpr_read_b32 v36, a84
    v_accvgpr_read_b32 v37, a85
    v_accvgpr_read_b32 v38, a86
    v_accvgpr_read_b32 v39, a87
    v_accvgpr_read_b32 v40, a88
    v_accvgpr_read_b32 v41, a89
    v_accvgpr_read_b32 v42, a90
    v_accvgpr_read_b32 v43, a91
    v_accvgpr_read_b32 v44, a92
    v_accvgpr_read_b32 v45, a93
    v_accvgpr_read_b32 v46, a94
    v_accvgpr_read_b32 v47, a95
    s_branch attn_done
attn_tail3:
    v_mfma_f32_32x32x16_bf16 v[32:47], a[208:211], a[176:179], v[144:159]
    ds_write_b128 v216, a[0:3] offset:0
    v_mfma_f32_32x32x16_bf16 v[32:47], a[212:215], a[180:183], v[32:47]
    ds_write_b128 v216, a[4:7] offset:1024
    ds_write_b128 v216, a[8:11] offset:2048
    v_mfma_f32_32x32x16_bf16 v[32:47], a[216:219], a[184:187], v[32:47]
    ds_write_b128 v216, a[12:15] offset:3072
    ds_write_b128 v216, a[16:19] offset:4096
    v_mfma_f32_32x32x16_bf16 v[32:47], a[220:223], a[188:191], v[32:47]
    ds_write_b128 v216, a[20:23] offset:5120
    ds_write_b128 v216, a[24:27] offset:6144
    v_mfma_f32_32x32x16_bf16 a[96:111], a[224:227], v[88:91], a[96:111]
    ds_write_b128 v216, a[28:31] offset:7168
    v_mfma_f32_32x32x16_bf16 a[112:127], a[232:235], v[88:91], a[112:127]
    ds_write_b128 v216, a[32:35] offset:32768
    ds_write_b128 v216, a[36:39] offset:33792
    v_mfma_f32_32x32x16_bf16 a[96:111], a[228:231], v[92:95], a[96:111]
    ds_write_b128 v216, a[40:43] offset:34816
    ds_write_b128 v216, a[44:47] offset:35840
    v_mfma_f32_32x32x16_bf16 a[112:127], a[236:239], v[92:95], a[112:127]
    ds_write_b128 v216, a[48:51] offset:36864
    ds_write_b128 v216, a[52:55] offset:37888
    v_smfmac_f32_16x16x64_bf16 v[172:175], v[176:179], v[88:95], v180
    ds_write_b128 v216, a[56:59] offset:38912
    ds_write_b128 v216, a[60:63] offset:39936
    v_exp_f32 v32, v32
    v_exp_f32 v33, v33
    v_exp_f32 v34, v34
    v_exp_f32 v35, v35
    v_cvt_pk_bf16_f32 v80, v32, v33
    v_exp_f32 v36, v36
    v_exp_f32 v37, v37
    v_cvt_pk_bf16_f32 v81, v34, v35
    v_exp_f32 v38, v38
    v_exp_f32 v39, v39
    v_cvt_pk_bf16_f32 v82, v36, v37
    v_exp_f32 v40, v40
    v_exp_f32 v41, v41
    v_cvt_pk_bf16_f32 v83, v38, v39
    ds_write_b128 v217, a[64:67] offset:0
    v_exp_f32 v42, v42
    v_exp_f32 v43, v43
    v_cvt_pk_bf16_f32 v84, v40, v41
    ds_write_b128 v217, a[68:71] offset:1024
    v_exp_f32 v44, v44
    v_exp_f32 v45, v45
    v_cvt_pk_bf16_f32 v85, v42, v43
    ds_write_b128 v217, a[72:75] offset:2048
    v_exp_f32 v46, v46
    v_exp_f32 v47, v47
    v_cvt_pk_bf16_f32 v86, v44, v45
    ds_write_b128 v217, a[76:79] offset:3072
    s_nop 0
    v_cvt_pk_bf16_f32 v87, v46, v47
    s_waitcnt vmcnt(4)
    v_mfma_f32_32x32x16_bf16 a[96:111], a[240:243], v[80:83], a[96:111]
    v_mfma_f32_32x32x16_bf16 a[112:127], a[248:251], v[80:83], a[112:127]
    ds_write_b128 v217, a[80:83] offset:4096
    v_mfma_f32_32x32x16_bf16 a[96:111], a[244:247], v[84:87], a[96:111]
    ds_write_b128 v217, a[84:87] offset:5120
    v_mfma_f32_32x32x16_bf16 a[112:127], a[252:255], v[84:87], a[112:127]
    ds_write_b128 v217, a[88:91] offset:6144
    v_smfmac_f32_16x16x64_bf16 v[172:175], v[176:179], v[80:87], v180
    ds_write_b128 v217, a[92:95] offset:7168
    v_mov_b32 v192, v96
    v_mov_b32 v194, v112
    v_mov_b32 v196, v128
    v_mov_b32 v198, v144
    s_nop 5
    v_accvgpr_read_b32 v16, a96
    v_accvgpr_read_b32 v17, a97
    v_accvgpr_read_b32 v18, a98
    v_accvgpr_read_b32 v19, a99
    v_accvgpr_read_b32 v20, a100
    v_accvgpr_read_b32 v21, a101
    v_accvgpr_read_b32 v22, a102
    v_accvgpr_read_b32 v23, a103
    v_accvgpr_read_b32 v24, a104
    v_accvgpr_read_b32 v25, a105
    v_accvgpr_read_b32 v26, a106
    v_accvgpr_read_b32 v27, a107
    v_accvgpr_read_b32 v28, a108
    v_accvgpr_read_b32 v29, a109
    v_accvgpr_read_b32 v30, a110
    v_accvgpr_read_b32 v31, a111
    v_accvgpr_read_b32 v32, a112
    v_accvgpr_read_b32 v33, a113
    v_accvgpr_read_b32 v34, a114
    v_accvgpr_read_b32 v35, a115
    v_accvgpr_read_b32 v36, a116
    v_accvgpr_read_b32 v37, a117
    v_accvgpr_read_b32 v38, a118
    v_accvgpr_read_b32 v39, a119
    v_accvgpr_read_b32 v40, a120
    v_accvgpr_read_b32 v41, a121
    v_accvgpr_read_b32 v42, a122
    v_accvgpr_read_b32 v43, a123
    v_accvgpr_read_b32 v44, a124
    v_accvgpr_read_b32 v45, a125
    v_accvgpr_read_b32 v46, a126
    v_accvgpr_read_b32 v47, a127
attn_done:
    v_add_f32 v193, v160, v161
    v_add_f32 v195, v164, v165
    v_add_f32 v197, v168, v169
    v_add_f32 v199, v172, v173
    v_add_f32 v201, v193, v195
    v_add_f32 v202, v197, v199
    v_add_f32 v201, v201, v202
    v_cmp_nlt_f32 vcc, v201, v218
    ds_write_b64 v208, v[192:193] offset:0
    ds_write_b64 v208, v[194:195] offset:512
    ds_write_b64 v208, v[196:197] offset:1024
    ds_write_b64 v208, v[198:199] offset:1536
    s_cmp_lg_u32 s29, 0
    s_cbranch_vccz attn_fin
    s_cbranch_scc1 attn_fin
    s_mov_b32 s29, 1
    s_waitcnt vmcnt(0)
    s_mov_b32 s23, s30
    v_add_u32 v2, s23, v1
    s_mov_b32 s27, s28
    v_mov_b32 v184, 0xff800000
    v_mov_b32 v185, 0xff800000
    v_mov_b32 v186, 0xff800000
    v_mov_b32 v187, 0xff800000
attn_mx:
    global_load_dwordx4 a[192:195], v2, s[12:13] offset:-4096
    global_load_dwordx4 a[196:199], v2, s[12:13] offset:-3072
    global_load_dwordx4 a[200:203], v2, s[12:13] offset:-2048
    global_load_dwordx4 a[204:207], v2, s[12:13] offset:-1024
    s_add_u32 s23, s23, 32768
    s_cmp_ge_u32 s23, s26
    s_cselect_b32 s23, s25, s23
    s_cmp_eq_u32 s27, 0
    s_cselect_b32 s23, 1019904, s23
    v_add_u32 v2, s23, v1
    s_waitcnt vmcnt(0)
    v_mfma_f32_32x32x16_bf16 v[96:111], a[192:195], a[128:131], 0
    v_mfma_f32_32x32x16_bf16 v[96:111], a[196:199], a[132:135], v[96:111]
    v_mfma_f32_32x32x16_bf16 v[96:111], a[200:203], a[136:139], v[96:111]
    v_mfma_f32_32x32x16_bf16 v[96:111], a[204:207], a[140:143], v[96:111]
    v_mfma_f32_32x32x16_bf16 v[112:127], a[192:195], a[144:147], 0
    v_mfma_f32_32x32x16_bf16 v[112:127], a[196:199], a[148:151], v[112:127]
    v_mfma_f32_32x32x16_bf16 v[112:127], a[200:203], a[152:155], v[112:127]
    v_mfma_f32_32x32x16_bf16 v[112:127], a[204:207], a[156:159], v[112:127]
    v_mfma_f32_32x32x16_bf16 v[128:143], a[192:195], a[160:163], 0
    v_mfma_f32_32x32x16_bf16 v[128:143], a[196:199], a[164:167], v[128:143]
    v_mfma_f32_32x32x16_bf16 v[128:143], a[200:203], a[168:171], v[128:143]
    v_mfma_f32_32x32x16_bf16 v[128:143], a[204:207], a[172:175], v[128:143]
    v_mfma_f32_32x32x16_bf16 v[144:159], a[192:195], a[176:179], 0
    v_mfma_f32_32x32x16_bf16 v[144:159], a[196:199], a[180:183], v[144:159]
    v_mfma_f32_32x32x16_bf16 v[144:159], a[200:203], a[184:187], v[144:159]
    v_mfma_f32_32x32x16_bf16 v[144:159], a[204:207], a[188:191], v[144:159]
    s_nop 7
    s_nop 7
    v_max3_f32 v184, v184, v96, v97
    v_max3_f32 v184, v184, v98, v99
    v_max3_f32 v184, v184, v100, v101
    v_max3_f32 v184, v184, v102, v103
    v_max3_f32 v184, v184, v104, v105
    v_max3_f32 v184, v184, v106, v107
    v_max3_f32 v184, v184, v108, v109
    v_max3_f32 v184, v184, v110, v111
    v_max3_f32 v185, v185, v112, v113
    v_max3_f32 v185, v185, v114, v115
    v_max3_f32 v185, v185, v116, v117
    v_max3_f32 v185, v185, v118, v119
    v_max3_f32 v185, v185, v120, v121
    v_max3_f32 v185, v185, v122, v123
    v_max3_f32 v185, v185, v124, v125
    v_max3_f32 v185, v185, v126, v127
    v_max3_f32 v186, v186, v128, v129
    v_max3_f32 v186, v186, v130, v131
    v_max3_f32 v186, v186, v132, v133
    v_max3_f32 v186, v186, v134, v135
    v_max3_f32 v186, v186, v136, v137
    v_max3_f32 v186, v186, v138, v139
    v_max3_f32 v186, v186, v140, v141
    v_max3_f32 v186, v186, v142, v143
    v_max3_f32 v187, v187, v144, v145
    v_max3_f32 v187, v187, v146, v147
    v_max3_f32 v187, v187, v148, v149
    v_max3_f32 v187, v187, v150, v151
    v_max3_f32 v187, v187, v152, v153
    v_max3_f32 v187, v187, v154, v155
    v_max3_f32 v187, v187, v156, v157
    v_max3_f32 v187, v187, v158, v159
    s_sub_u32 s27, s27, 1
    s_cmp_ge_i32 s27, -1
    s_cbranch_scc1 attn_mx
    v_mov_b32 v188, v184
    s_nop 1
    v_permlane32_swap_b32 v184, v188
    v_max_f32 v184, v184, v188
    v_sub_f32 v96, 0, v184
    v_sub_f32 v97, 0, v184
    v_sub_f32 v98, 0, v184
    v_sub_f32 v99, 0, v184
    v_sub_f32 v100, 0, v184
    v_sub_f32 v101, 0, v184
    v_sub_f32 v102, 0, v184
    v_sub_f32 v103, 0, v184
    v_sub_f32 v104, 0, v184
    v_sub_f32 v105, 0, v184
    v_sub_f32 v106, 0, v184
    v_sub_f32 v107, 0, v184
    v_sub_f32 v108, 0, v184
    v_sub_f32 v109, 0, v184
    v_sub_f32 v110, 0, v184
    v_sub_f32 v111, 0, v184
    v_mov_b32 v189, v185
    s_nop 1
    v_permlane32_swap_b32 v185, v189
    v_max_f32 v185, v185, v189
    v_sub_f32 v112, 0, v185
    v_sub_f32 v113, 0, v185
    v_sub_f32 v114, 0, v185
    v_sub_f32 v115, 0, v185
    v_sub_f32 v116, 0, v185
    v_sub_f32 v117, 0, v185
    v_sub_f32 v118, 0, v185
    v_sub_f32 v119, 0, v185
    v_sub_f32 v120, 0, v185
    v_sub_f32 v121, 0, v185
    v_sub_f32 v122, 0, v185
    v_sub_f32 v123, 0, v185
    v_sub_f32 v124, 0, v185
    v_sub_f32 v125, 0, v185
    v_sub_f32 v126, 0, v185
    v_sub_f32 v127, 0, v185
    v_mov_b32 v190, v186
    s_nop 1
    v_permlane32_swap_b32 v186, v190
    v_max_f32 v186, v186, v190
    v_sub_f32 v128, 0, v186
    v_sub_f32 v129, 0, v186
    v_sub_f32 v130, 0, v186
    v_sub_f32 v131, 0, v186
    v_sub_f32 v132, 0, v186
    v_sub_f32 v133, 0, v186
    v_sub_f32 v134, 0, v186
    v_sub_f32 v135, 0, v186
    v_sub_f32 v136, 0, v186
    v_sub_f32 v137, 0, v186
    v_sub_f32 v138, 0, v186
    v_sub_f32 v139, 0, v186
    v_sub_f32 v140, 0, v186
    v_sub_f32 v141, 0, v186
    v_sub_f32 v142, 0, v186
    v_sub_f32 v143, 0, v186
    v_mov_b32 v191, v187
    s_nop 1
    v_permlane32_swap_b32 v187, v191
    v_max_f32 v187, v187, v191
    v_sub_f32 v144, 0, v187
    v_sub_f32 v145, 0, v187
    v_sub_f32 v146, 0, v187
    v_sub_f32 v147, 0, v187
    v_sub_f32 v148, 0, v187
    v_sub_f32 v149, 0, v187
    v_sub_f32 v150, 0, v187
    v_sub_f32 v151, 0, v187
    v_sub_f32 v152, 0, v187
    v_sub_f32 v153, 0, v187
    v_sub_f32 v154, 0, v187
    v_sub_f32 v155, 0, v187
    v_sub_f32 v156, 0, v187
    v_sub_f32 v157, 0, v187
    v_sub_f32 v158, 0, v187
    v_sub_f32 v159, 0, v187
    s_branch attn_pass
attn_fin:
    s_waitcnt lgkmcnt(0)
    s_barrier
    ds_read_b64 v[184:185], v209
    ds_read_b64 v[186:187], v210
    ds_read_b64 v[188:189], v211
    ds_read_b64 v[190:191], v212
    ds_read_b128 v[64:67], v213 offset:0
    ds_read_b128 v[68:71], v213 offset:1024
    ds_read_b128 v[72:75], v213 offset:2048
    ds_read_b128 v[76:79], v213 offset:3072
    ds_read_b128 v[80:83], v213 offset:4096
    ds_read_b128 v[84:87], v213 offset:5120
    ds_read_b128 v[88:91], v213 offset:6144
    ds_read_b128 v[92:95], v213 offset:7168
    ds_read_b128 v[96:99], v214 offset:0
    ds_read_b128 v[100:103], v214 offset:1024
    ds_read_b128 v[104:107], v214 offset:2048
    s_waitcnt lgkmcnt(11)
    v_min3_f32 v192, v184, v186, v188
    v_min_f32 v192, v192, v190
    v_sub_f32 v184, v192, v184
    v_sub_f32 v186, v192, v186
    v_sub_f32 v188, v192, v188
    v_sub_f32 v190, v192, v190
    v_exp_f32 v196, v184
    v_exp_f32 v197, v186
    v_exp_f32 v198, v188
    v_exp_f32 v199, v190
    ds_read_b128 v[108:111], v214 offset:3072
    ds_read_b128 v[112:115], v214 offset:4096
    ds_read_b128 v[116:119], v214 offset:5120
    ds_read_b128 v[120:123], v214 offset:6144
    v_mul_f32 v193, v196, v185
    v_fmac_f32 v193, v197, v187
    v_fmac_f32 v193, v198, v189
    v_fmac_f32 v193, v199, v191
    v_rcp_f32 v193, v193
    s_nop 0
    v_mul_f32 v196, v196, v193
    v_mul_f32 v197, v197, v193
    v_mul_f32 v198, v198, v193
    v_mul_f32 v199, v199, v193
    v_pk_mul_f32 v[16:17], v[16:17], v[196:197] op_sel_hi:[1,0]
    v_pk_mul_f32 v[18:19], v[18:19], v[196:197] op_sel_hi:[1,0]
    v_pk_mul_f32 v[20:21], v[20:21], v[196:197] op_sel_hi:[1,0]
    v_pk_mul_f32 v[22:23], v[22:23], v[196:197] op_sel_hi:[1,0]
    v_pk_mul_f32 v[24:25], v[24:25], v[196:197] op_sel_hi:[1,0]
    v_pk_mul_f32 v[26:27], v[26:27], v[196:197] op_sel_hi:[1,0]
    v_pk_mul_f32 v[28:29], v[28:29], v[196:197] op_sel_hi:[1,0]
    v_pk_mul_f32 v[30:31], v[30:31], v[196:197] op_sel_hi:[1,0]
    v_pk_mul_f32 v[32:33], v[32:33], v[196:197] op_sel_hi:[1,0]
    v_pk_mul_f32 v[34:35], v[34:35], v[196:197] op_sel_hi:[1,0]
    v_pk_mul_f32 v[36:37], v[36:37], v[196:197] op_sel_hi:[1,0]
    v_pk_mul_f32 v[38:39], v[38:39], v[196:197] op_sel_hi:[1,0]
    v_pk_mul_f32 v[40:41], v[40:41], v[196:197] op_sel_hi:[1,0]
    v_pk_mul_f32 v[42:43], v[42:43], v[196:197] op_sel_hi:[1,0]
    v_pk_mul_f32 v[44:45], v[44:45], v[196:197] op_sel_hi:[1,0]
    v_pk_mul_f32 v[46:47], v[46:47], v[196:197] op_sel_hi:[1,0]
    s_waitcnt lgkmcnt(7)
    ds_read_b128 v[124:127], v214 offset:7168
    ds_read_b128 v[128:131], v215 offset:0
    ds_read_b128 v[132:135], v215 offset:1024
    ds_read_b128 v[136:139], v215 offset:2048
    ds_read_b128 v[140:143], v215 offset:3072
    ds_read_b128 v[144:147], v215 offset:4096
    ds_read_b128 v[148:151], v215 offset:5120
    ds_read_b128 v[152:155], v215 offset:6144
    v_pk_fma_f32 v[16:17], v[64:65], v[196:197], v[16:17] op_sel:[0,1,0] op_sel_hi:[1,1,1]
    v_pk_fma_f32 v[18:19], v[66:67], v[196:197], v[18:19] op_sel:[0,1,0] op_sel_hi:[1,1,1]
    v_pk_fma_f32 v[20:21], v[68:69], v[196:197], v[20:21] op_sel:[0,1,0] op_sel_hi:[1,1,1]
    v_pk_fma_f32 v[22:23], v[70:71], v[196:197], v[22:23] op_sel:[0,1,0] op_sel_hi:[1,1,1]
    v_pk_fma_f32 v[24:25], v[72:73], v[196:197], v[24:25] op_sel:[0,1,0] op_sel_hi:[1,1,1]
    v_pk_fma_f32 v[26:27], v[74:75], v[196:197], v[26:27] op_sel:[0,1,0] op_sel_hi:[1,1,1]
    v_pk_fma_f32 v[28:29], v[76:77], v[196:197], v[28:29] op_sel:[0,1,0] op_sel_hi:[1,1,1]
    v_pk_fma_f32 v[30:31], v[78:79], v[196:197], v[30:31] op_sel:[0,1,0] op_sel_hi:[1,1,1]
    v_pk_fma_f32 v[32:33], v[80:81], v[196:197], v[32:33] op_sel:[0,1,0] op_sel_hi:[1,1,1]
    v_pk_fma_f32 v[34:35], v[82:83], v[196:197], v[34:35] op_sel:[0,1,0] op_sel_hi:[1,1,1]
    v_pk_fma_f32 v[36:37], v[84:85], v[196:197], v[36:37] op_sel:[0,1,0] op_sel_hi:[1,1,1]
    v_pk_fma_f32 v[38:39], v[86:87], v[196:197], v[38:39] op_sel:[0,1,0] op_sel_hi:[1,1,1]
    v_pk_fma_f32 v[40:41], v[88:89], v[196:197], v[40:41] op_sel:[0,1,0] op_sel_hi:[1,1,1]
    v_pk_fma_f32 v[42:43], v[90:91], v[196:197], v[42:43] op_sel:[0,1,0] op_sel_hi:[1,1,1]
    v_pk_fma_f32 v[44:45], v[92:93], v[196:197], v[44:45] op_sel:[0,1,0] op_sel_hi:[1,1,1]
    v_pk_fma_f32 v[46:47], v[94:95], v[196:197], v[46:47] op_sel:[0,1,0] op_sel_hi:[1,1,1]
    s_waitcnt lgkmcnt(7)
    ds_read_b128 v[156:159], v215 offset:7168
    v_pk_fma_f32 v[16:17], v[96:97], v[198:199], v[16:17] op_sel_hi:[1,0,1]
    v_pk_fma_f32 v[18:19], v[98:99], v[198:199], v[18:19] op_sel_hi:[1,0,1]
    v_pk_fma_f32 v[20:21], v[100:101], v[198:199], v[20:21] op_sel_hi:[1,0,1]
    v_pk_fma_f32 v[22:23], v[102:103], v[198:199], v[22:23] op_sel_hi:[1,0,1]
    v_pk_fma_f32 v[24:25], v[104:105], v[198:199], v[24:25] op_sel_hi:[1,0,1]
    v_pk_fma_f32 v[26:27], v[106:107], v[198:199], v[26:27] op_sel_hi:[1,0,1]
    v_pk_fma_f32 v[28:29], v[108:109], v[198:199], v[28:29] op_sel_hi:[1,0,1]
    v_pk_fma_f32 v[30:31], v[110:111], v[198:199], v[30:31] op_sel_hi:[1,0,1]
    v_pk_fma_f32 v[32:33], v[112:113], v[198:199], v[32:33] op_sel_hi:[1,0,1]
    v_pk_fma_f32 v[34:35], v[114:115], v[198:199], v[34:35] op_sel_hi:[1,0,1]
    v_pk_fma_f32 v[36:37], v[116:117], v[198:199], v[36:37] op_sel_hi:[1,0,1]
    v_pk_fma_f32 v[38:39], v[118:119], v[198:199], v[38:39] op_sel_hi:[1,0,1]
    v_pk_fma_f32 v[40:41], v[120:121], v[198:199], v[40:41] op_sel_hi:[1,0,1]
    v_pk_fma_f32 v[42:43], v[122:123], v[198:199], v[42:43] op_sel_hi:[1,0,1]
    v_pk_fma_f32 v[44:45], v[124:125], v[198:199], v[44:45] op_sel_hi:[1,0,1]
    v_pk_fma_f32 v[46:47], v[126:127], v[198:199], v[46:47] op_sel_hi:[1,0,1]
    s_waitcnt lgkmcnt(0)
    v_pk_fma_f32 v[16:17], v[128:129], v[198:199], v[16:17] op_sel:[0,1,0] op_sel_hi:[1,1,1]
    v_pk_fma_f32 v[18:19], v[130:131], v[198:199], v[18:19] op_sel:[0,1,0] op_sel_hi:[1,1,1]
    v_pk_fma_f32 v[20:21], v[132:133], v[198:199], v[20:21] op_sel:[0,1,0] op_sel_hi:[1,1,1]
    v_pk_fma_f32 v[22:23], v[134:135], v[198:199], v[22:23] op_sel:[0,1,0] op_sel_hi:[1,1,1]
    v_cvt_pk_bf16_f32 v48, v16, v17
    v_cvt_pk_bf16_f32 v49, v18, v19
    v_cvt_pk_bf16_f32 v50, v20, v21
    v_cvt_pk_bf16_f32 v51, v22, v23
    buffer_store_dwordx4 v[48:51], v1, s[16:19], s56 offen offset:0 sc1
    v_pk_fma_f32 v[24:25], v[136:137], v[198:199], v[24:25] op_sel:[0,1,0] op_sel_hi:[1,1,1]
    v_pk_fma_f32 v[26:27], v[138:139], v[198:199], v[26:27] op_sel:[0,1,0] op_sel_hi:[1,1,1]
    v_pk_fma_f32 v[28:29], v[140:141], v[198:199], v[28:29] op_sel:[0,1,0] op_sel_hi:[1,1,1]
    v_pk_fma_f32 v[30:31], v[142:143], v[198:199], v[30:31] op_sel:[0,1,0] op_sel_hi:[1,1,1]
    v_cvt_pk_bf16_f32 v52, v24, v25
    v_cvt_pk_bf16_f32 v53, v26, v27
    v_cvt_pk_bf16_f32 v54, v28, v29
    v_cvt_pk_bf16_f32 v55, v30, v31
    buffer_store_dwordx4 v[52:55], v1, s[16:19], s56 offen offset:1024 sc1
    v_pk_fma_f32 v[32:33], v[144:145], v[198:199], v[32:33] op_sel:[0,1,0] op_sel_hi:[1,1,1]
    v_pk_fma_f32 v[34:35], v[146:147], v[198:199], v[34:35] op_sel:[0,1,0] op_sel_hi:[1,1,1]
    v_pk_fma_f32 v[36:37], v[148:149], v[198:199], v[36:37] op_sel:[0,1,0] op_sel_hi:[1,1,1]
    v_pk_fma_f32 v[38:39], v[150:151], v[198:199], v[38:39] op_sel:[0,1,0] op_sel_hi:[1,1,1]
    v_cvt_pk_bf16_f32 v56, v32, v33
    v_cvt_pk_bf16_f32 v57, v34, v35
    v_cvt_pk_bf16_f32 v58, v36, v37
    v_cvt_pk_bf16_f32 v59, v38, v39
    buffer_store_dwordx4 v[56:59], v1, s[16:19], s56 offen offset:2048 sc1
    v_pk_fma_f32 v[40:41], v[152:153], v[198:199], v[40:41] op_sel:[0,1,0] op_sel_hi:[1,1,1]
    v_pk_fma_f32 v[42:43], v[154:155], v[198:199], v[42:43] op_sel:[0,1,0] op_sel_hi:[1,1,1]
    v_pk_fma_f32 v[44:45], v[156:157], v[198:199], v[44:45] op_sel:[0,1,0] op_sel_hi:[1,1,1]
    v_pk_fma_f32 v[46:47], v[158:159], v[198:199], v[46:47] op_sel:[0,1,0] op_sel_hi:[1,1,1]
    v_cvt_pk_bf16_f32 v60, v40, v41
    v_cvt_pk_bf16_f32 v61, v42, v43
    v_cvt_pk_bf16_f32 v62, v44, v45
    v_cvt_pk_bf16_f32 v63, v46, v47
    buffer_store_dwordx4 v[60:63], v1, s[16:19], s56 offen offset:3072 sc1
    s_and_b32 s29, s2, 7
    s_lshr_b32 s30, s2, 3
    s_lshl_b32 s21, s29, 5
    s_add_u32 s21, s21, s30
    s_add_u32 s44, s4, 44040192
    s_addc_u32 s45, s5, 0
    s_mov_b32 s46, 256000
    s_mov_b32 s47, 0x20000
    v_mov_b32 v252, s100
    v_mov_b32 v253, s101
    s_cmp_ge_u32 s21, 250
    s_cbranch_scc1 post_kernel_idle
    v_and_b32 v7, 31, v0
    v_xor_b32 v8, 256, v1
    v_and_b32 v9, 16, v7
    v_lshlrev_b32 v9, 10, v9
    v_add_u32 v8, v8, v9
    s_lshl_b32 s24, s21, 14
    s_sub_u32 s24, s24, 16384
    s_lshl_b32 s25, s20, 12
    s_add_u32 s24, s24, s25
    v_add_u32 v8, s24, v8
    v_add_u32 v9, 16384, v8
    s_add_u32 m0, s25, 0
    s_mul_i32 s23, s20, 411648
    s_add_u32 s23, s23, 27267072
    v_add_u32 v2, s23, v1
    s_and_b32 s22, s30, 1
    s_lshl_b32 s22, s22, 17
    s_cmp_ge_u32 s21, 125
    s_cselect_b32 s26, 125, 0
    s_sub_u32 s28, s21, s26
    s_cmp_eq_u32 s28, 0
    s_cselect_b32 s30, 0, -1
    s_cmp_eq_u32 s28, 124
    s_cselect_b32 s31, 0, -1
    s_mov_b32 s32, 0xffff0000
    s_mov_b32 s33, 0xffff0000
    s_andn2_b32 s34, 0x40000000, s30
    s_andn2_b32 s35, 0x40000000, s31
    v_and_b32 v10, 0x3fffffff, v8
    v_or_b32 v10, s34, v10
    v_cndmask_b32 v8, v10, v8, s[32:33]
    v_or_b32 v10, s35, v9
    v_cndmask_b32 v9, v9, v10, s[32:33]
    s_add_u32 s8, s4, 12582912
    s_addc_u32 s9, s5, 0
    s_mov_b32 s10, 4096000
    s_mov_b32 s11, 0x20000
    s_add_u32 s12, s4, 16777216
    s_addc_u32 s13, s5, 0
    s_mov_b32 s14, 4096000
    s_mov_b32 s15, 0x20000
    buffer_load_dwordx4 v[144:147], v8, s[12:15], 0 offen offset:0
    buffer_load_dwordx4 v[148:151], v8, s[12:15], 0 offen offset:1024
    buffer_load_dwordx4 v[152:155], v8, s[12:15], 0 offen offset:2048
    buffer_load_dwordx4 v[156:159], v8, s[12:15], 0 offen offset:3072
    buffer_load_dwordx4 v[160:163], v9, s[12:15], 0 offen offset:0
    buffer_load_dwordx4 v[164:167], v9, s[12:15], 0 offen offset:1024
    buffer_load_dwordx4 v[168:171], v9, s[12:15], 0 offen offset:2048
    buffer_load_dwordx4 v[172:175], v9, s[12:15], 0 offen offset:3072
    s_movk_i32 s43, 1000
    v_and_b32 v11, 3, v0
    v_add_u32 v11, s28, v11
    v_max_u32 v11, 1, v11
    v_min_u32 v11, 125, v11
    s_sub_u32 s26, s26, 1
    v_add_u32 v11, s26, v11
    v_lshl_add_u32 v11, v11, 2, s20
    v_lshlrev_b32 v11, 7, v11
    s_barrier
    s_mov_b32 s16, s6
    s_mov_b32 s17, s7
    s_mov_b32 s18, 4096000
    s_mov_b32 s19, 0x20000
    v_lshlrev_b32 v10, 3, v7
    v_add_u32 v6, 126976, v10
    s_lshl_b32 s23, s20, 8
    v_add_u32 v5, s23, v6
    s_lshl_b32 s27, s20, 12
    v_add_u32 v10, s27, v1
    s_xor_b32 s34, s2, 8
    s_lshl_b32 s34, s34, 2
    s_add_u32 s34, s34, s20
    s_lshl_b32 s35, s2, 2
    s_add_u32 s35, s35, s20
    s_lshl_b32 s36, s34, 9
    s_add_u32 s36, s36, 34603008
    v_mov_b32 v13, s36
    s_lshl_b32 s36, s35, 9
    s_add_u32 s36, s36, 34603008
    v_mov_b32 v14, s36
    s_lshl_b32 s36, s21, 14
    s_add_u32 s38, s36, s25
    v_add_u32 v4, s38, v1
    v_xor_b32 v15, 16384, v4
    s_getreg_b32 s37, hwreg(HW_REG_XCC_ID, 0, 4)
    s_add_u32 s36, s37, s100
    s_add_u32 s36, s36, 1
    s_mov_b32 s37, s101
    s_lshl_b32 s35, s20, 13
    v_add_u32 v3, s35, v1
    s_waitcnt vmcnt(8)
    buffer_store_dwordx2 v[252:253], off, s[44:47], s39 sc1
    s_mov_b32 s34, 400000
    s_mov_b64 exec, 7
post_kernel_pa:
    buffer_load_dwordx2 v[254:255], v11, s[44:47], 0 offen sc1
    s_waitcnt vmcnt(0)
    v_cmp_ne_u64 vcc, s[100:101], v[254:255]
    s_sub_u32 s34, s34, 1
    s_cbranch_scc1 post_kernel_pb
    s_nop 2
    s_cbranch_vccnz post_kernel_pa
post_kernel_pb:
    s_mov_b64 exec, -1
    buffer_load_dwordx4 v8, s[8:11], 0 offen offset:0 sc1 lds
    buffer_load_dwordx4 v8, s[8:11], 0 offen offset:1024 sc1 lds
    buffer_load_dwordx4 v8, s[8:11], 0 offen offset:2048 sc1 lds
    buffer_load_dwordx4 v8, s[8:11], 0 offen offset:3072 sc1 lds
    s_add_u32 m0, s25, 16384
    s_nop 0
    buffer_load_dwordx4 v9, s[8:11], 0 offen offset:0 sc1 lds
    buffer_load_dwordx4 v9, s[8:11], 0 offen offset:1024 sc1 lds
    buffer_load_dwordx4 v9, s[8:11], 0 offen offset:2048 sc1 lds
    buffer_load_dwordx4 v9, s[8:11], 0 offen offset:3072 sc1 lds
    global_load_dwordx4 a[128:131], v2, s[4:5] offset:-4096
    global_load_dwordx4 a[132:135], v2, s[4:5] offset:-3072
    global_load_dwordx4 a[136:139], v2, s[4:5] offset:-2048
    v_lshlrev_b32 v80, 16, v144
    v_and_b32 v81, 0xffff0000, v144
    v_lshlrev_b32 v82, 16, v145
    v_and_b32 v83, 0xffff0000, v145
    v_lshlrev_b32 v84, 16, v146
    v_and_b32 v85, 0xffff0000, v146
    v_lshlrev_b32 v86, 16, v147
    v_and_b32 v87, 0xffff0000, v147
    v_lshlrev_b32 v88, 16, v148
    v_and_b32 v89, 0xffff0000, v148
    v_lshlrev_b32 v90, 16, v149
    v_and_b32 v91, 0xffff0000, v149
    v_lshlrev_b32 v92, 16, v150
    v_and_b32 v93, 0xffff0000, v150
    v_lshlrev_b32 v94, 16, v151
    v_and_b32 v95, 0xffff0000, v151
    v_lshlrev_b32 v96, 16, v152
    v_and_b32 v97, 0xffff0000, v152
    v_lshlrev_b32 v98, 16, v153
    v_and_b32 v99, 0xffff0000, v153
    v_lshlrev_b32 v100, 16, v154
    v_and_b32 v101, 0xffff0000, v154
    v_lshlrev_b32 v102, 16, v155
    v_and_b32 v103, 0xffff0000, v155
    v_lshlrev_b32 v104, 16, v156
    v_and_b32 v105, 0xffff0000, v156
    v_lshlrev_b32 v106, 16, v157
    v_and_b32 v107, 0xffff0000, v157
    v_lshlrev_b32 v108, 16, v158
    v_and_b32 v109, 0xffff0000, v158
    v_lshlrev_b32 v110, 16, v159
    v_and_b32 v111, 0xffff0000, v159
    v_lshlrev_b32 v112, 16, v160
    v_and_b32 v113, 0xffff0000, v160
    v_lshlrev_b32 v114, 16, v161
    v_and_b32 v115, 0xffff0000, v161
    v_lshlrev_b32 v116, 16, v162
    v_and_b32 v117, 0xffff0000, v162
    v_lshlrev_b32 v118, 16, v163
    v_and_b32 v119, 0xffff0000, v163
    v_lshlrev_b32 v120, 16, v164
    v_and_b32 v121, 0xffff0000, v164
    v_lshlrev_b32 v122, 16, v165
    v_and_b32 v123, 0xffff0000, v165
    v_lshlrev_b32 v124, 16, v166
    v_and_b32 v125, 0xffff0000, v166
    v_lshlrev_b32 v126, 16, v167
    v_and_b32 v127, 0xffff0000, v167
    v_lshlrev_b32 v128, 16, v168
    v_and_b32 v129, 0xffff0000, v168
    v_lshlrev_b32 v130, 16, v169
    v_and_b32 v131, 0xffff0000, v169
    v_lshlrev_b32 v132, 16, v170
    v_and_b32 v133, 0xffff0000, v170
    v_lshlrev_b32 v134, 16, v171
    v_and_b32 v135, 0xffff0000, v171
    v_lshlrev_b32 v136, 16, v172
    v_and_b32 v137, 0xffff0000, v172
    v_lshlrev_b32 v138, 16, v173
    v_and_b32 v139, 0xffff0000, v173
    v_lshlrev_b32 v140, 16, v174
    v_and_b32 v141, 0xffff0000, v174
    v_lshlrev_b32 v142, 16, v175
    v_and_b32 v143, 0xffff0000, v175
    global_load_dwordx4 a[140:143], v2, s[4:5] offset:-1024
    global_load_dwordx4 a[144:147], v2, s[4:5] offset:0
    global_load_dwordx4 a[148:151], v2, s[4:5] offset:1024
    global_load_dwordx4 a[152:155], v2, s[4:5] offset:2048
    global_load_dwordx4 a[156:159], v2, s[4:5] offset:3072
    v_add_u32 v2, 8192, v2
    global_load_dwordx4 a[160:163], v2, s[4:5] offset:-4096
    global_load_dwordx4 a[164:167], v2, s[4:5] offset:-3072
    global_load_dwordx4 a[168:171], v2, s[4:5] offset:-2048
    global_load_dwordx4 a[172:175], v2, s[4:5] offset:-1024
    global_load_dwordx4 a[176:179], v2, s[4:5] offset:0
    global_load_dwordx4 a[180:183], v2, s[4:5] offset:1024
    global_load_dwordx4 a[184:187], v2, s[4:5] offset:2048
    global_load_dwordx4 a[188:191], v2, s[4:5] offset:3072
    v_add_u32 v2, 8192, v2
    v_mov_b32 v254, s36
    v_mov_b32 v255, s37
    global_store_dwordx2 v14, v[254:255], s[4:5] offset:320 sc1
    s_waitcnt vmcnt(17)
    s_barrier
    ds_read_b128 a[0:3], v1 offset:0
    ds_read_b128 a[64:67], v1 offset:16384
    ds_read_b128 a[4:7], v1 offset:1024
    ds_read_b128 a[68:71], v1 offset:17408
    ds_read_b128 a[8:11], v1 offset:2048
    ds_read_b128 a[72:75], v1 offset:18432
    ds_read_b128 a[12:15], v1 offset:3072
    ds_read_b128 a[76:79], v1 offset:19456
    ds_read_b128 a[16:19], v1 offset:4096
    ds_read_b128 a[80:83], v1 offset:20480
    ds_read_b128 a[20:23], v1 offset:5120
    ds_read_b128 a[84:87], v1 offset:21504
    s_waitcnt lgkmcnt(10)
    s_waitcnt vmcnt(13)
    v_mfma_f32_32x32x16_bf16 v[80:95], a[128:131], a[0:3], v[80:95]
    ds_read_b128 a[24:27], v1 offset:6144
    v_mfma_f32_32x32x16_bf16 v[112:127], a[128:131], a[64:67], v[112:127]
    ds_read_b128 a[88:91], v1 offset:22528
    v_mfma_f32_32x32x16_bf16 v[96:111], a[132:135], a[0:3], v[96:111]
    v_mfma_f32_32x32x16_bf16 v[128:143], a[132:135], a[64:67], v[128:143]
    s_waitcnt lgkmcnt(10)
    v_mfma_f32_32x32x16_bf16 v[80:95], a[136:139], a[4:7], v[80:95]
    ds_read_b128 a[28:31], v1 offset:7168
    v_mfma_f32_32x32x16_bf16 v[112:127], a[136:139], a[68:71], v[112:127]
    ds_read_b128 a[92:95], v1 offset:23552
    v_mfma_f32_32x32x16_bf16 v[96:111], a[140:143], a[4:7], v[96:111]
    global_load_dwordx4 a[192:195], v2, s[4:5] offset:-4096
    v_mfma_f32_32x32x16_bf16 v[128:143], a[140:143], a[68:71], v[128:143]
    global_load_dwordx4 a[196:199], v2, s[4:5] offset:-3072
    s_waitcnt lgkmcnt(10)
    s_waitcnt vmcnt(11)
    v_mfma_f32_32x32x16_bf16 v[80:95], a[144:147], a[8:11], v[80:95]
    ds_read_b128 a[32:35], v1 offset:8192
    v_mfma_f32_32x32x16_bf16 v[112:127], a[144:147], a[72:75], v[112:127]
    ds_read_b128 a[96:99], v1 offset:24576
    v_mfma_f32_32x32x16_bf16 v[96:111], a[148:151], a[8:11], v[96:111]
    global_load_dwordx4 a[200:203], v2, s[4:5] offset:-2048
    v_mfma_f32_32x32x16_bf16 v[128:143], a[148:151], a[72:75], v[128:143]
    global_load_dwordx4 a[204:207], v2, s[4:5] offset:-1024
    s_waitcnt lgkmcnt(10)
    v_mfma_f32_32x32x16_bf16 v[80:95], a[152:155], a[12:15], v[80:95]
    ds_read_b128 a[36:39], v1 offset:9216
    v_mfma_f32_32x32x16_bf16 v[112:127], a[152:155], a[76:79], v[112:127]
    ds_read_b128 a[100:103], v1 offset:25600
    v_mfma_f32_32x32x16_bf16 v[96:111], a[156:159], a[12:15], v[96:111]
    global_load_dwordx4 a[208:211], v2, s[4:5] offset:0
    v_mfma_f32_32x32x16_bf16 v[128:143], a[156:159], a[76:79], v[128:143]
    global_load_dwordx4 a[212:215], v2, s[4:5] offset:1024
    s_waitcnt lgkmcnt(10)
    s_waitcnt vmcnt(11)
    v_mfma_f32_32x32x16_bf16 v[80:95], a[160:163], a[16:19], v[80:95]
    ds_read_b128 a[40:43], v1 offset:10240
    v_mfma_f32_32x32x16_bf16 v[112:127], a[160:163], a[80:83], v[112:127]
    ds_read_b128 a[104:107], v1 offset:26624
    v_mfma_f32_32x32x16_bf16 v[96:111], a[164:167], a[16:19], v[96:111]
    global_load_dwordx4 a[216:219], v2, s[4:5] offset:2048
    v_mfma_f32_32x32x16_bf16 v[128:143], a[164:167], a[80:83], v[128:143]
    global_load_dwordx4 a[220:223], v2, s[4:5] offset:3072
    v_add_u32 v2, 8192, v2
    s_waitcnt lgkmcnt(10)
    v_mfma_f32_32x32x16_bf16 v[80:95], a[168:171], a[20:23], v[80:95]
    ds_read_b128 a[44:47], v1 offset:11264
    v_mfma_f32_32x32x16_bf16 v[112:127], a[168:171], a[84:87], v[112:127]
    ds_read_b128 a[108:111], v1 offset:27648
    v_mfma_f32_32x32x16_bf16 v[96:111], a[172:175], a[20:23], v[96:111]
    global_load_dwordx4 a[224:227], v2, s[4:5] offset:-4096
    v_mfma_f32_32x32x16_bf16 v[128:143], a[172:175], a[84:87], v[128:143]
    global_load_dwordx4 a[228:231], v2, s[4:5] offset:-3072
    s_waitcnt lgkmcnt(10)
    s_waitcnt vmcnt(11)
    v_mfma_f32_32x32x16_bf16 v[80:95], a[176:179], a[24:27], v[80:95]
    ds_read_b128 a[48:51], v1 offset:12288
    v_mfma_f32_32x32x16_bf16 v[112:127], a[176:179], a[88:91], v[112:127]
    ds_read_b128 a[112:115], v1 offset:28672
    v_mfma_f32_32x32x16_bf16 v[96:111], a[180:183], a[24:27], v[96:111]
    global_load_dwordx4 a[232:235], v2, s[4:5] offset:-2048
    v_mfma_f32_32x32x16_bf16 v[128:143], a[180:183], a[88:91], v[128:143]
    global_load_dwordx4 a[236:239], v2, s[4:5] offset:-1024
    s_waitcnt lgkmcnt(10)
    v_mfma_f32_32x32x16_bf16 v[80:95], a[184:187], a[28:31], v[80:95]
    ds_read_b128 a[52:55], v1 offset:13312
    v_mfma_f32_32x32x16_bf16 v[112:127], a[184:187], a[92:95], v[112:127]
    ds_read_b128 a[116:119], v1 offset:29696
    v_mfma_f32_32x32x16_bf16 v[96:111], a[188:191], a[28:31], v[96:111]
    global_load_dwordx4 a[240:243], v2, s[4:5] offset:0
    v_mfma_f32_32x32x16_bf16 v[128:143], a[188:191], a[92:95], v[128:143]
    global_load_dwordx4 a[244:247], v2, s[4:5] offset:1024
    s_waitcnt lgkmcnt(10)
    s_waitcnt vmcnt(10)
    v_mfma_f32_32x32x16_bf16 v[80:95], a[192:195], a[32:35], v[80:95]
    ds_read_b128 a[56:59], v1 offset:14336
    v_mfma_f32_32x32x16_bf16 v[112:127], a[192:195], a[96:99], v[112:127]
    ds_read_b128 a[120:123], v1 offset:30720
    v_mfma_f32_32x32x16_bf16 v[96:111], a[196:199], a[32:35], v[96:111]
    global_load_dwordx4 a[248:251], v2, s[4:5] offset:2048
    v_mfma_f32_32x32x16_bf16 v[128:143], a[196:199], a[96:99], v[128:143]
    global_load_dwordx4 a[252:255], v2, s[4:5] offset:3072
    v_add_u32 v2, 8192, v2
    s_waitcnt lgkmcnt(10)
    v_mfma_f32_32x32x16_bf16 v[80:95], a[200:203], a[36:39], v[80:95]
    ds_read_b128 a[60:63], v1 offset:15360
    v_mfma_f32_32x32x16_bf16 v[112:127], a[200:203], a[100:103], v[112:127]
    ds_read_b128 a[124:127], v1 offset:31744
    v_mfma_f32_32x32x16_bf16 v[96:111], a[204:207], a[36:39], v[96:111]
    global_load_dwordx4 a[128:131], v2, s[4:5] offset:-4096
    v_mfma_f32_32x32x16_bf16 v[128:143], a[204:207], a[100:103], v[128:143]
    global_load_dwordx4 a[132:135], v2, s[4:5] offset:-3072
    s_waitcnt lgkmcnt(10)
    s_waitcnt vmcnt(10)
    v_mfma_f32_32x32x16_bf16 v[80:95], a[208:211], a[40:43], v[80:95]
    global_load_dwordx4 a[136:139], v2, s[4:5] offset:-2048
    v_mfma_f32_32x32x16_bf16 v[112:127], a[208:211], a[104:107], v[112:127]
    v_mfma_f32_32x32x16_bf16 v[96:111], a[212:215], a[40:43], v[96:111]
    global_load_dwordx4 a[140:143], v2, s[4:5] offset:-1024
    v_mfma_f32_32x32x16_bf16 v[128:143], a[212:215], a[104:107], v[128:143]
    s_waitcnt lgkmcnt(8)
    v_mfma_f32_32x32x16_bf16 v[80:95], a[216:219], a[44:47], v[80:95]
    global_load_dwordx4 a[144:147], v2, s[4:5] offset:0
    v_mfma_f32_32x32x16_bf16 v[112:127], a[216:219], a[108:111], v[112:127]
    v_mfma_f32_32x32x16_bf16 v[96:111], a[220:223], a[44:47], v[96:111]
    global_load_dwordx4 a[148:151], v2, s[4:5] offset:1024
    v_mfma_f32_32x32x16_bf16 v[128:143], a[220:223], a[108:111], v[128:143]
    s_waitcnt lgkmcnt(6)
    s_waitcnt vmcnt(10)
    v_mfma_f32_32x32x16_bf16 v[80:95], a[224:227], a[48:51], v[80:95]
    global_load_dwordx4 a[152:155], v2, s[4:5] offset:2048
    v_mfma_f32_32x32x16_bf16 v[112:127], a[224:227], a[112:115], v[112:127]
    v_mfma_f32_32x32x16_bf16 v[96:111], a[228:231], a[48:51], v[96:111]
    global_load_dwordx4 a[156:159], v2, s[4:5] offset:3072
    v_add_u32 v2, 8192, v2
    v_mfma_f32_32x32x16_bf16 v[128:143], a[228:231], a[112:115], v[128:143]
    s_waitcnt lgkmcnt(4)
    v_mfma_f32_32x32x16_bf16 v[80:95], a[232:235], a[52:55], v[80:95]
    global_load_dwordx4 a[160:163], v2, s[4:5] offset:-4096
    v_mfma_f32_32x32x16_bf16 v[112:127], a[232:235], a[116:119], v[112:127]
    v_mfma_f32_32x32x16_bf16 v[96:111], a[236:239], a[52:55], v[96:111]
    global_load_dwordx4 a[164:167], v2, s[4:5] offset:-3072
    v_mfma_f32_32x32x16_bf16 v[128:143], a[236:239], a[116:119], v[128:143]
    s_waitcnt lgkmcnt(2)
    s_waitcnt vmcnt(10)
    v_mfma_f32_32x32x16_bf16 v[80:95], a[240:243], a[56:59], v[80:95]
    global_load_dwordx4 a[168:171], v2, s[4:5] offset:-2048
    v_mfma_f32_32x32x16_bf16 v[112:127], a[240:243], a[120:123], v[112:127]
    v_mfma_f32_32x32x16_bf16 v[96:111], a[244:247], a[56:59], v[96:111]
    global_load_dwordx4 a[172:175], v2, s[4:5] offset:-1024
    v_mfma_f32_32x32x16_bf16 v[128:143], a[244:247], a[120:123], v[128:143]
    s_waitcnt lgkmcnt(0)
    v_mfma_f32_32x32x16_bf16 v[80:95], a[248:251], a[60:63], v[80:95]
    global_load_dwordx4 a[176:179], v2, s[4:5] offset:0
    v_mfma_f32_32x32x16_bf16 v[112:127], a[248:251], a[124:127], v[112:127]
    v_mfma_f32_32x32x16_bf16 v[96:111], a[252:255], a[60:63], v[96:111]
    global_load_dwordx4 a[180:183], v2, s[4:5] offset:1024
    v_mfma_f32_32x32x16_bf16 v[128:143], a[252:255], a[124:127], v[128:143]
    s_nop 7
    s_nop 3
    v_pk_add_f32 v[180:181], v[80:81], v[82:83]
    v_pk_add_f32 v[188:189], v[112:113], v[114:115]
    v_pk_mul_f32 v[182:183], v[80:81], v[80:81]
    v_pk_mul_f32 v[190:191], v[112:113], v[112:113]
    v_pk_fma_f32 v[182:183], v[82:83], v[82:83], v[182:183]
    v_pk_fma_f32 v[190:191], v[114:115], v[114:115], v[190:191]
    v_pk_add_f32 v[180:181], v[180:181], v[84:85]
    v_pk_add_f32 v[188:189], v[188:189], v[116:117]
    v_pk_fma_f32 v[182:183], v[84:85], v[84:85], v[182:183]
    v_pk_fma_f32 v[190:191], v[116:117], v[116:117], v[190:191]
    v_pk_add_f32 v[180:181], v[180:181], v[86:87]
    v_pk_add_f32 v[188:189], v[188:189], v[118:119]
    v_pk_fma_f32 v[182:183], v[86:87], v[86:87], v[182:183]
    v_pk_fma_f32 v[190:191], v[118:119], v[118:119], v[190:191]
    v_pk_add_f32 v[180:181], v[180:181], v[88:89]
    v_pk_add_f32 v[188:189], v[188:189], v[120:121]
    v_pk_fma_f32 v[182:183], v[88:89], v[88:89], v[182:183]
    v_pk_fma_f32 v[190:191], v[120:121], v[120:121], v[190:191]
    v_pk_add_f32 v[180:181], v[180:181], v[90:91]
    v_pk_add_f32 v[188:189], v[188:189], v[122:123]
    v_pk_fma_f32 v[182:183], v[90:91], v[90:91], v[182:183]
    v_pk_fma_f32 v[190:191], v[122:123], v[122:123], v[190:191]
    v_pk_add_f32 v[180:181], v[180:181], v[92:93]
    v_pk_add_f32 v[188:189], v[188:189], v[124:125]
    v_pk_fma_f32 v[182:183], v[92:93], v[92:93], v[182:183]
    v_pk_fma_f32 v[190:191], v[124:125], v[124:125], v[190:191]
    v_pk_add_f32 v[180:181], v[180:181], v[94:95]
    v_pk_add_f32 v[188:189], v[188:189], v[126:127]
    v_pk_fma_f32 v[182:183], v[94:95], v[94:95], v[182:183]
    v_pk_fma_f32 v[190:191], v[126:127], v[126:127], v[190:191]
    v_pk_add_f32 v[180:181], v[180:181], v[96:97]
    v_pk_add_f32 v[188:189], v[188:189], v[128:129]
    v_pk_fma_f32 v[182:183], v[96:97], v[96:97], v[182:183]
    v_pk_fma_f32 v[190:191], v[128:129], v[128:129], v[190:191]
    v_pk_add_f32 v[180:181], v[180:181], v[98:99]
    v_pk_add_f32 v[188:189], v[188:189], v[130:131]
    v_pk_fma_f32 v[182:183], v[98:99], v[98:99], v[182:183]
    v_pk_fma_f32 v[190:191], v[130:131], v[130:131], v[190:191]
    v_pk_add_f32 v[180:181], v[180:181], v[100:101]
    v_pk_add_f32 v[188:189], v[188:189], v[132:133]
    v_pk_fma_f32 v[182:183], v[100:101], v[100:101], v[182:183]
    v_pk_fma_f32 v[190:191], v[132:133], v[132:133], v[190:191]
    v_pk_add_f32 v[180:181], v[180:181], v[102:103]
    v_pk_add_f32 v[188:189], v[188:189], v[134:135]
    v_pk_fma_f32 v[182:183], v[102:103], v[102:103], v[182:183]
    v_pk_fma_f32 v[190:191], v[134:135], v[134:135], v[190:191]
    v_pk_add_f32 v[180:181], v[180:181], v[104:105]
    v_pk_add_f32 v[188:189], v[188:189], v[136:137]
    v_pk_fma_f32 v[182:183], v[104:105], v[104:105], v[182:183]
    v_pk_fma_f32 v[190:191], v[136:137], v[136:137], v[190:191]
    v_pk_add_f32 v[180:181], v[180:181], v[106:107]
    v_pk_add_f32 v[188:189], v[188:189], v[138:139]
    v_pk_fma_f32 v[182:183], v[106:107], v[106:107], v[182:183]
    v_pk_fma_f32 v[190:191], v[138:139], v[138:139], v[190:191]
    v_pk_add_f32 v[180:181], v[180:181], v[108:109]
    v_pk_add_f32 v[188:189], v[188:189], v[140:141]
    v_pk_fma_f32 v[182:183], v[108:109], v[108:109], v[182:183]
    v_pk_fma_f32 v[190:191], v[140:141], v[140:141], v[190:191]
    v_pk_add_f32 v[180:181], v[180:181], v[110:111]
    v_pk_add_f32 v[188:189], v[188:189], v[142:143]
    v_pk_fma_f32 v[182:183], v[110:111], v[110:111], v[182:183]
    v_pk_fma_f32 v[190:191], v[142:143], v[142:143], v[190:191]
    v_add_f32 v180, v180, v181
    v_add_f32 v181, v182, v183
    v_add_f32 v188, v188, v189
    v_add_f32 v189, v190, v191
    v_mov_b32 v182, v180
    v_mov_b32 v183, v181
    v_mov_b32 v190, v188
    v_mov_b32 v191, v189
    v_permlane32_swap_b32 v180, v182
    v_permlane32_swap_b32 v181, v183
    s_nop 0
    v_permlane32_swap_b32 v188, v190
    v_permlane32_swap_b32 v189, v191
    v_pk_add_f32 v[180:181], v[180:181], v[182:183]
    ds_write_b64 v5, v[180:181] offset:0
    v_pk_add_f32 v[188:189], v[188:189], v[190:191]
    ds_write_b64 v5, v[188:189] offset:1024
    s_waitcnt lgkmcnt(0)
    s_barrier
    ds_read_b64 v[180:181], v6 offset:0
    ds_read_b64 v[182:183], v6 offset:256
    ds_read_b64 v[184:185], v6 offset:512
    ds_read_b64 v[186:187], v6 offset:768
    ds_read_b64 v[188:189], v6 offset:1024
    ds_read_b64 v[190:191], v6 offset:1280
    ds_read_b64 v[192:193], v6 offset:1536
    ds_read_b64 v[194:195], v6 offset:1792
    s_waitcnt lgkmcnt(4)
    v_pk_add_f32 v[180:181], v[180:181], v[182:183]
    global_load_dwordx4 a[184:187], v2, s[4:5] offset:2048
    v_pk_add_f32 v[184:185], v[184:185], v[186:187]
    v_pk_add_f32 v[180:181], v[180:181], v[184:185]
    v_mul_f32 v182, 0x3b800000, v180
    v_mul_f32 v181, 0x3b800000, v181
    v_fma_f32 v181, -v182, v182, v181
    v_max_f32 v181, 0, v181
    v_add_f32 v181, 0x3727c5ac, v181
    v_rsq_f32 v180, v181
    s_nop 0
    v_mul_f32 v180, 0x3fb8aa3b, v180
    v_mul_f32_e64 v182, -v182, v180
    v_pk_fma_f32 v[16:17], v[80:81], v[180:181], v[182:183] op_sel_hi:[1,0,0]
    v_pk_fma_f32 v[18:19], v[82:83], v[180:181], v[182:183] op_sel_hi:[1,0,0]
    v_pk_fma_f32 v[20:21], v[84:85], v[180:181], v[182:183] op_sel_hi:[1,0,0]
    v_pk_fma_f32 v[22:23], v[86:87], v[180:181], v[182:183] op_sel_hi:[1,0,0]
    global_load_dwordx4 a[188:191], v2, s[4:5] offset:3072
    v_add_u32 v2, 8192, v2
    v_pk_fma_f32 v[24:25], v[88:89], v[180:181], v[182:183] op_sel_hi:[1,0,0]
    v_pk_fma_f32 v[26:27], v[90:91], v[180:181], v[182:183] op_sel_hi:[1,0,0]
    v_pk_fma_f32 v[28:29], v[92:93], v[180:181], v[182:183] op_sel_hi:[1,0,0]
    v_pk_fma_f32 v[30:31], v[94:95], v[180:181], v[182:183] op_sel_hi:[1,0,0]
    v_pk_fma_f32 v[32:33], v[96:97], v[180:181], v[182:183] op_sel_hi:[1,0,0]
    v_pk_fma_f32 v[34:35], v[98:99], v[180:181], v[182:183] op_sel_hi:[1,0,0]
    v_pk_fma_f32 v[36:37], v[100:101], v[180:181], v[182:183] op_sel_hi:[1,0,0]
    v_pk_fma_f32 v[38:39], v[102:103], v[180:181], v[182:183] op_sel_hi:[1,0,0]
    v_pk_fma_f32 v[40:41], v[104:105], v[180:181], v[182:183] op_sel_hi:[1,0,0]
    v_pk_fma_f32 v[42:43], v[106:107], v[180:181], v[182:183] op_sel_hi:[1,0,0]
    v_pk_fma_f32 v[44:45], v[108:109], v[180:181], v[182:183] op_sel_hi:[1,0,0]
    v_pk_fma_f32 v[46:47], v[110:111], v[180:181], v[182:183] op_sel_hi:[1,0,0]
    v_cvt_pk_bf16_f32 v144, v16, v17
    v_cvt_pk_bf16_f32 v145, v18, v19
    v_cvt_pk_bf16_f32 v146, v20, v21
    global_load_dwordx4 a[192:195], v2, s[4:5] offset:-4096
    v_cvt_pk_bf16_f32 v147, v22, v23
    ds_write_b128 v10, v[144:147] offset:0
    v_cvt_pk_bf16_f32 v148, v24, v25
    v_cvt_pk_bf16_f32 v149, v26, v27
    v_cvt_pk_bf16_f32 v150, v28, v29
    v_cvt_pk_bf16_f32 v151, v30, v31
    ds_write_b128 v10, v[148:151] offset:1024
    v_cvt_pk_bf16_f32 v152, v32, v33
    v_cvt_pk_bf16_f32 v153, v34, v35
    v_cvt_pk_bf16_f32 v154, v36, v37
    v_cvt_pk_bf16_f32 v155, v38, v39
    ds_write_b128 v10, v[152:155] offset:2048
    global_load_dwordx4 a[196:199], v2, s[4:5] offset:-3072
    v_cvt_pk_bf16_f32 v156, v40, v41
    v_cvt_pk_bf16_f32 v157, v42, v43
    v_cvt_pk_bf16_f32 v158, v44, v45
    v_cvt_pk_bf16_f32 v159, v46, v47
    ds_write_b128 v10, v[156:159] offset:3072
    s_waitcnt lgkmcnt(4)
    v_pk_add_f32 v[188:189], v[188:189], v[190:191]
    v_pk_add_f32 v[192:193], v[192:193], v[194:195]
    v_pk_add_f32 v[188:189], v[188:189], v[192:193]
    v_mul_f32 v190, 0x3b800000, v188
    v_mul_f32 v189, 0x3b800000, v189
    v_fma_f32 v189, -v190, v190, v189
    global_load_dwordx4 a[200:203], v2, s[4:5] offset:-2048
    v_max_f32 v189, 0, v189
    v_add_f32 v189, 0x3727c5ac, v189
    v_rsq_f32 v188, v189
    s_nop 0
    v_mul_f32 v188, 0x3fb8aa3b, v188
    v_mul_f32_e64 v190, -v190, v188
    v_pk_fma_f32 v[48:49], v[112:113], v[188:189], v[190:191] op_sel_hi:[1,0,0]
    v_pk_fma_f32 v[50:51], v[114:115], v[188:189], v[190:191] op_sel_hi:[1,0,0]
    v_pk_fma_f32 v[52:53], v[116:117], v[188:189], v[190:191] op_sel_hi:[1,0,0]
    v_pk_fma_f32 v[54:55], v[118:119], v[188:189], v[190:191] op_sel_hi:[1,0,0]
    v_pk_fma_f32 v[56:57], v[120:121], v[188:189], v[190:191] op_sel_hi:[1,0,0]
    v_pk_fma_f32 v[58:59], v[122:123], v[188:189], v[190:191] op_sel_hi:[1,0,0]
    v_pk_fma_f32 v[60:61], v[124:125], v[188:189], v[190:191] op_sel_hi:[1,0,0]
    v_pk_fma_f32 v[62:63], v[126:127], v[188:189], v[190:191] op_sel_hi:[1,0,0]
    v_pk_fma_f32 v[64:65], v[128:129], v[188:189], v[190:191] op_sel_hi:[1,0,0]
    global_load_dwordx4 a[204:207], v2, s[4:5] offset:-1024
    v_pk_fma_f32 v[66:67], v[130:131], v[188:189], v[190:191] op_sel_hi:[1,0,0]
    v_pk_fma_f32 v[68:69], v[132:133], v[188:189], v[190:191] op_sel_hi:[1,0,0]
    v_pk_fma_f32 v[70:71], v[134:135], v[188:189], v[190:191] op_sel_hi:[1,0,0]
    v_pk_fma_f32 v[72:73], v[136:137], v[188:189], v[190:191] op_sel_hi:[1,0,0]
    v_pk_fma_f32 v[74:75], v[138:139], v[188:189], v[190:191] op_sel_hi:[1,0,0]
    v_pk_fma_f32 v[76:77], v[140:141], v[188:189], v[190:191] op_sel_hi:[1,0,0]
    v_pk_fma_f32 v[78:79], v[142:143], v[188:189], v[190:191] op_sel_hi:[1,0,0]
    v_cvt_pk_bf16_f32 v160, v48, v49
    v_cvt_pk_bf16_f32 v161, v50, v51
    v_cvt_pk_bf16_f32 v162, v52, v53
    v_cvt_pk_bf16_f32 v163, v54, v55
    ds_write_b128 v10, v[160:163] offset:16384
    v_cvt_pk_bf16_f32 v164, v56, v57
    v_cvt_pk_bf16_f32 v165, v58, v59
    global_load_dwordx4 a[208:211], v2, s[4:5] offset:0
    v_cvt_pk_bf16_f32 v166, v60, v61
    v_cvt_pk_bf16_f32 v167, v62, v63
    ds_write_b128 v10, v[164:167] offset:17408
    v_cvt_pk_bf16_f32 v168, v64, v65
    v_cvt_pk_bf16_f32 v169, v66, v67
    v_cvt_pk_bf16_f32 v170, v68, v69
    v_cvt_pk_bf16_f32 v171, v70, v71
    ds_write_b128 v10, v[168:171] offset:18432
    v_cvt_pk_bf16_f32 v172, v72, v73
    v_cvt_pk_bf16_f32 v173, v74, v75
    v_cvt_pk_bf16_f32 v174, v76, v77
    v_cvt_pk_bf16_f32 v175, v78, v79
    global_load_dwordx4 a[212:215], v2, s[4:5] offset:1024
    ds_write_b128 v10, v[172:175] offset:19456
    s_lshl_b32 s27, s20, 6
    v_add_u32 v7, s27, v7
    v_mul_u32_u24 v7, 160, v7
    v_bfe_u32 v8, v0, 5, 1
    v_lshl_add_u32 v7, v8, 3, v7
    v_add_u32 v7, 32768, v7
    global_load_dwordx2 v[254:255], v13, s[4:5] offset:320 sc1
    s_waitcnt lgkmcnt(0)
    s_barrier
    global_load_dwordx4 a[216:219], v2, s[4:5] offset:2048
    s_mov_b32 s28, 0x3fb8aa3b
    ds_read_b128 a[0:3], v1 offset:0
    ds_read_b128 a[64:67], v1 offset:16384
    ds_read_b128 a[4:7], v1 offset:1024
    ds_read_b128 a[68:71], v1 offset:17408
    ds_read_b128 a[8:11], v1 offset:2048
    ds_read_b128 a[72:75], v1 offset:18432
    ds_read_b128 a[12:15], v1 offset:3072
    ds_read_b128 a[76:79], v1 offset:19456
    ds_read_b128 a[16:19], v1 offset:4096
    ds_read_b128 a[80:83], v1 offset:20480
    ds_read_b128 a[20:23], v1 offset:5120
    ds_read_b128 a[84:87], v1 offset:21504
    s_waitcnt lgkmcnt(10)
    s_waitcnt vmcnt(20)
    v_mfma_f32_32x32x16_bf16 v[16:31], a[0:3], a[128:131], 0
    ds_read_b128 a[24:27], v1 offset:6144
    v_mfma_f32_32x32x16_bf16 v[32:47], a[64:67], a[128:131], 0
    ds_read_b128 a[88:91], v1 offset:22528
    v_mfma_f32_32x32x16_bf16 v[48:63], a[0:3], a[132:135], 0
    global_load_dwordx4 a[220:223], v2, s[4:5] offset:3072
    v_add_u32 v2, 8192, v2
    v_mfma_f32_32x32x16_bf16 v[64:79], a[64:67], a[132:135], 0
    global_load_dwordx4 a[224:227], v2, s[4:5] offset:-4096
    s_waitcnt lgkmcnt(10)
    v_mfma_f32_32x32x16_bf16 v[16:31], a[4:7], a[136:139], v[16:31]
    ds_read_b128 a[28:31], v1 offset:7168
    v_mfma_f32_32x32x16_bf16 v[32:47], a[68:71], a[136:139], v[32:47]
    ds_read_b128 a[92:95], v1 offset:23552
    v_mfma_f32_32x32x16_bf16 v[48:63], a[4:7], a[140:143], v[48:63]
    global_load_dwordx4 a[228:231], v2, s[4:5] offset:-3072
    v_mfma_f32_32x32x16_bf16 v[64:79], a[68:71], a[140:143], v[64:79]
    global_load_dwordx4 a[232:235], v2, s[4:5] offset:-2048
    s_waitcnt lgkmcnt(10)
    s_waitcnt vmcnt(20)
    v_mfma_f32_32x32x16_bf16 v[16:31], a[8:11], a[144:147], v[16:31]
    ds_read_b128 a[32:35], v1 offset:8192
    v_cndmask_b32 v196, v112, v80, s[32:33]
    v_mul_f32 v196, s28, v196
    v_mfma_f32_32x32x16_bf16 v[32:47], a[72:75], a[144:147], v[32:47]
    ds_read_b128 a[96:99], v1 offset:24576
    v_cndmask_b32 v197, v113, v81, s[32:33]
    v_mfma_f32_32x32x16_bf16 v[48:63], a[8:11], a[148:151], v[48:63]
    global_load_dwordx4 a[236:239], v2, s[4:5] offset:-1024
    v_mul_f32 v197, s28, v197
    v_cndmask_b32 v198, v114, v82, s[32:33]
    v_mfma_f32_32x32x16_bf16 v[64:79], a[72:75], a[148:151], v[64:79]
    global_load_dwordx4 a[240:243], v2, s[4:5] offset:0
    v_mul_f32 v198, s28, v198
    s_waitcnt lgkmcnt(10)
    v_mfma_f32_32x32x16_bf16 v[16:31], a[12:15], a[152:155], v[16:31]
    ds_read_b128 a[36:39], v1 offset:9216
    v_cndmask_b32 v199, v115, v83, s[32:33]
    v_mul_f32 v199, s28, v199
    v_mfma_f32_32x32x16_bf16 v[32:47], a[76:79], a[152:155], v[32:47]
    ds_read_b128 a[100:103], v1 offset:25600
    v_cndmask_b32 v200, v116, v84, s[32:33]
    v_mfma_f32_32x32x16_bf16 v[48:63], a[12:15], a[156:159], v[48:63]
    global_load_dwordx4 a[244:247], v2, s[4:5] offset:1024
    v_mul_f32 v200, s28, v200
    v_cndmask_b32 v201, v117, v85, s[32:33]
    v_mfma_f32_32x32x16_bf16 v[64:79], a[76:79], a[156:159], v[64:79]
    v_mul_f32 v201, s28, v201
    s_waitcnt lgkmcnt(10)
    s_waitcnt vmcnt(19)
    v_mfma_f32_32x32x16_bf16 v[16:31], a[16:19], a[160:163], v[16:31]
    ds_read_b128 a[40:43], v1 offset:10240
    v_cndmask_b32 v202, v118, v86, s[32:33]
    v_mul_f32 v202, s28, v202
    v_mfma_f32_32x32x16_bf16 v[32:47], a[80:83], a[160:163], v[32:47]
    ds_read_b128 a[104:107], v1 offset:26624
    v_cndmask_b32 v203, v119, v87, s[32:33]
    v_mfma_f32_32x32x16_bf16 v[48:63], a[16:19], a[164:167], v[48:63]
    global_load_dwordx4 a[248:251], v2, s[4:5] offset:2048
    v_mul_f32 v203, s28, v203
    v_cndmask_b32 v204, v120, v88, s[32:33]
    v_mfma_f32_32x32x16_bf16 v[64:79], a[80:83], a[164:167], v[64:79]
    global_load_dwordx4 a[252:255], v2, s[4:5] offset:3072
    v_add_u32 v2, 8192, v2
    v_mul_f32 v204, s28, v204
    s_waitcnt lgkmcnt(10)
    v_mfma_f32_32x32x16_bf16 v[16:31], a[20:23], a[168:171], v[16:31]
    ds_read_b128 a[44:47], v1 offset:11264
    v_cndmask_b32 v205, v121, v89, s[32:33]
    v_mul_f32 v205, s28, v205
    v_mfma_f32_32x32x16_bf16 v[32:47], a[84:87], a[168:171], v[32:47]
    ds_read_b128 a[108:111], v1 offset:27648
    v_cndmask_b32 v206, v122, v90, s[32:33]
    v_mfma_f32_32x32x16_bf16 v[48:63], a[20:23], a[172:175], v[48:63]
    global_load_dwordx4 a[128:131], v2, s[4:5] offset:-4096
    v_mul_f32 v206, s28, v206
    v_cndmask_b32 v207, v123, v91, s[32:33]
    v_mfma_f32_32x32x16_bf16 v[64:79], a[84:87], a[172:175], v[64:79]
    global_load_dwordx4 a[132:135], v2, s[4:5] offset:-3072
    v_mul_f32 v207, s28, v207
    s_waitcnt lgkmcnt(10)
    s_waitcnt vmcnt(19)
    v_mfma_f32_32x32x16_bf16 v[16:31], a[24:27], a[176:179], v[16:31]
    ds_read_b128 a[48:51], v1 offset:12288
    v_cndmask_b32 v208, v124, v92, s[32:33]
    v_mul_f32 v208, s28, v208
    v_mfma_f32_32x32x16_bf16 v[32:47], a[88:91], a[176:179], v[32:47]
    ds_read_b128 a[112:115], v1 offset:28672
    v_cndmask_b32 v209, v125, v93, s[32:33]
    v_mfma_f32_32x32x16_bf16 v[48:63], a[24:27], a[180:183], v[48:63]
    global_load_dwordx4 a[136:139], v2, s[4:5] offset:-2048
    v_mul_f32 v209, s28, v209
    v_cndmask_b32 v210, v126, v94, s[32:33]
    v_mfma_f32_32x32x16_bf16 v[64:79], a[88:91], a[180:183], v[64:79]
    global_load_dwordx4 a[140:143], v2, s[4:5] offset:-1024
    v_mul_f32 v210, s28, v210
    s_waitcnt lgkmcnt(10)
    v_mfma_f32_32x32x16_bf16 v[16:31], a[28:31], a[184:187], v[16:31]
    ds_read_b128 a[52:55], v1 offset:13312
    v_cndmask_b32 v211, v127, v95, s[32:33]
    v_mul_f32 v211, s28, v211
    v_mfma_f32_32x32x16_bf16 v[32:47], a[92:95], a[184:187], v[32:47]
    ds_read_b128 a[116:119], v1 offset:29696
    v_cndmask_b32 v212, v128, v96, s[32:33]
    v_mfma_f32_32x32x16_bf16 v[48:63], a[28:31], a[188:191], v[48:63]
    global_load_dwordx4 a[144:147], v2, s[4:5] offset:0
    v_mul_f32 v212, s28, v212
    v_cndmask_b32 v213, v129, v97, s[32:33]
    v_mfma_f32_32x32x16_bf16 v[64:79], a[92:95], a[188:191], v[64:79]
    v_mul_f32 v213, s28, v213
    s_waitcnt lgkmcnt(10)
    s_waitcnt vmcnt(18)
    v_mfma_f32_32x32x16_bf16 v[16:31], a[32:35], a[192:195], v[16:31]
    ds_read_b128 a[56:59], v1 offset:14336
    v_cndmask_b32 v214, v130, v98, s[32:33]
    v_mul_f32 v214, s28, v214
    v_mfma_f32_32x32x16_bf16 v[32:47], a[96:99], a[192:195], v[32:47]
    ds_read_b128 a[120:123], v1 offset:30720
    v_cndmask_b32 v215, v131, v99, s[32:33]
    v_mfma_f32_32x32x16_bf16 v[48:63], a[32:35], a[196:199], v[48:63]
    global_load_dwordx4 a[148:151], v2, s[4:5] offset:1024
    v_mul_f32 v215, s28, v215
    v_cndmask_b32 v216, v132, v100, s[32:33]
    v_mfma_f32_32x32x16_bf16 v[64:79], a[96:99], a[196:199], v[64:79]
    global_load_dwordx4 a[152:155], v2, s[4:5] offset:2048
    v_mul_f32 v216, s28, v216
    s_waitcnt lgkmcnt(10)
    v_mfma_f32_32x32x16_bf16 v[16:31], a[36:39], a[200:203], v[16:31]
    ds_read_b128 a[60:63], v1 offset:15360
    v_cndmask_b32 v217, v133, v101, s[32:33]
    v_mul_f32 v217, s28, v217
    v_mfma_f32_32x32x16_bf16 v[32:47], a[100:103], a[200:203], v[32:47]
    ds_read_b128 a[124:127], v1 offset:31744
    v_cndmask_b32 v218, v134, v102, s[32:33]
    v_mfma_f32_32x32x16_bf16 v[48:63], a[36:39], a[204:207], v[48:63]
    global_load_dwordx4 a[156:159], v2, s[4:5] offset:3072
    v_add_u32 v2, 8192, v2
    v_mul_f32 v218, s28, v218
    v_cndmask_b32 v219, v135, v103, s[32:33]
    v_mfma_f32_32x32x16_bf16 v[64:79], a[100:103], a[204:207], v[64:79]
    global_load_dwordx4 a[160:163], v2, s[4:5] offset:-4096
    v_mul_f32 v219, s28, v219
    s_waitcnt lgkmcnt(10)
    s_waitcnt vmcnt(17)
    v_mfma_f32_32x32x16_bf16 v[16:31], a[40:43], a[208:211], v[16:31]
    v_cndmask_b32 v220, v136, v104, s[32:33]
    v_mul_f32 v220, s28, v220
    v_mfma_f32_32x32x16_bf16 v[32:47], a[104:107], a[208:211], v[32:47]
    global_load_dwordx4 a[164:167], v2, s[4:5] offset:-3072
    v_cndmask_b32 v221, v137, v105, s[32:33]
    v_mfma_f32_32x32x16_bf16 v[48:63], a[40:43], a[212:215], v[48:63]
    v_mul_f32 v221, s28, v221
    v_cndmask_b32 v222, v138, v106, s[32:33]
    v_mfma_f32_32x32x16_bf16 v[64:79], a[104:107], a[212:215], v[64:79]
    global_load_dwordx4 a[168:171], v2, s[4:5] offset:-2048
    v_mul_f32 v222, s28, v222
    s_waitcnt lgkmcnt(8)
    v_mfma_f32_32x32x16_bf16 v[16:31], a[44:47], a[216:219], v[16:31]
    v_cndmask_b32 v223, v139, v107, s[32:33]
    v_mul_f32 v223, s28, v223
    v_mfma_f32_32x32x16_bf16 v[32:47], a[108:111], a[216:219], v[32:47]
    global_load_dwordx4 a[172:175], v2, s[4:5] offset:-1024
    v_cndmask_b32 v224, v140, v108, s[32:33]
    v_mfma_f32_32x32x16_bf16 v[48:63], a[44:47], a[220:223], v[48:63]
    v_mul_f32 v224, s28, v224
    v_cndmask_b32 v225, v141, v109, s[32:33]
    v_mfma_f32_32x32x16_bf16 v[64:79], a[108:111], a[220:223], v[64:79]
    v_mul_f32 v225, s28, v225
    s_waitcnt lgkmcnt(6)
    s_waitcnt vmcnt(16)
    v_mfma_f32_32x32x16_bf16 v[16:31], a[48:51], a[224:227], v[16:31]
    global_load_dwordx4 a[176:179], v2, s[4:5] offset:0
    v_cndmask_b32 v226, v142, v110, s[32:33]
    v_mul_f32 v226, s28, v226
    v_mfma_f32_32x32x16_bf16 v[32:47], a[112:115], a[224:227], v[32:47]
    v_cndmask_b32 v227, v143, v111, s[32:33]
    v_mfma_f32_32x32x16_bf16 v[48:63], a[48:51], a[228:231], v[48:63]
    global_load_dwordx4 a[180:183], v2, s[4:5] offset:1024
    v_mul_f32 v227, s28, v227
    v_bfe_u32 v8, v0, 2, 4
    v_mfma_f32_32x32x16_bf16 v[64:79], a[112:115], a[228:231], v[64:79]
    v_add_u32 v8, s27, v8
    s_waitcnt lgkmcnt(4)
    v_mfma_f32_32x32x16_bf16 v[16:31], a[52:55], a[232:235], v[16:31]
    global_load_dwordx4 a[184:187], v2, s[4:5] offset:2048
    v_and_b32 v11, 3, v0
    v_lshlrev_b32 v11, 3, v11
    v_mfma_f32_32x32x16_bf16 v[32:47], a[116:119], a[232:235], v[32:47]
    v_mul_u32_u24 v12, 80, v8
    v_mfma_f32_32x32x16_bf16 v[48:63], a[52:55], a[236:239], v[48:63]
    global_load_dwordx4 a[188:191], v2, s[4:5] offset:3072
    v_add_u32 v2, 8192, v2
    v_add_u32 v12, v12, v11
    v_add_u32 v12, 73728, v12
    v_mfma_f32_32x32x16_bf16 v[64:79], a[116:119], a[236:239], v[64:79]
    v_mul_u32_u24 v8, 160, v8
    s_waitcnt lgkmcnt(2)
    s_waitcnt vmcnt(16)
    v_mfma_f32_32x32x16_bf16 v[16:31], a[56:59], a[240:243], v[16:31]
    global_load_dwordx4 a[192:195], v2, s[4:5] offset:-4096
    v_add_u32 v8, v8, v11
    v_add_u32 v8, 32768, v8
    v_mfma_f32_32x32x16_bf16 v[32:47], a[120:123], a[240:243], v[32:47]
    v_bfe_u32 v9, v0, 2, 2
    v_mfma_f32_32x32x16_bf16 v[48:63], a[56:59], a[244:247], v[48:63]
    global_load_dwordx4 a[196:199], v2, s[4:5] offset:-3072
    v_bfe_u32 v11, v0, 5, 1
    v_lshl_add_u32 v9, v11, 2, v9
    v_mfma_f32_32x32x16_bf16 v[64:79], a[120:123], a[244:247], v[64:79]
    v_mul_u32_u24 v9, 80, v9
    s_waitcnt lgkmcnt(0)
    v_mfma_f32_32x32x16_bf16 v[16:31], a[60:63], a[248:251], v[16:31]
    global_load_dwordx4 a[200:203], v2, s[4:5] offset:-2048
    v_bfe_u32 v11, v0, 4, 1
    v_xor_b32 v11, 1, v11
    v_mfma_f32_32x32x16_bf16 v[32:47], a[124:127], a[248:251], v[32:47]
    v_lshl_add_u32 v9, v11, 5, v9
    v_mfma_f32_32x32x16_bf16 v[48:63], a[60:63], a[252:255], v[48:63]
    global_load_dwordx4 a[204:207], v2, s[4:5] offset:-1024
    v_and_b32 v11, 3, v0
    v_lshl_add_u32 v9, v11, 3, v9
    v_mfma_f32_32x32x16_bf16 v[64:79], a[124:127], a[252:255], v[64:79]
    v_add_u32 v9, 73728, v9
    s_waitcnt vmcnt(16)
    v_mfma_f32_32x32x16_bf16 v[80:95], a[0:3], a[128:131], 0
    v_mfma_f32_32x32x16_bf16 v[112:127], a[0:3], a[132:135], 0
    global_load_dwordx4 a[208:211], v2, s[4:5] offset:0
    v_mfma_f32_32x32x16_bf16 v[80:95], a[4:7], a[136:139], v[80:95]
    v_mfma_f32_32x32x16_bf16 v[112:127], a[4:7], a[140:143], v[112:127]
    global_load_dwordx4 a[212:215], v2, s[4:5] offset:1024
    v_exp_f32 v180, -v48
    v_exp_f32 v181, -v49
    v_add_f32 v180, 1.0, v180
    v_add_f32 v181, 1.0, v181
    v_rcp_f32 v180, v180
    s_waitcnt vmcnt(14)
    v_mfma_f32_32x32x16_bf16 v[80:95], a[8:11], a[144:147], v[80:95]
    global_load_dwordx4 a[216:219], v2, s[4:5] offset:2048
    v_rcp_f32 v181, v181
    v_mul_f32 v180, v16, v180
    v_mul_f32 v181, v17, v181
    v_cvt_pk_bf16_f32 v228, v180, v181
    v_mfma_f32_32x32x16_bf16 v[112:127], a[8:11], a[148:151], v[112:127]
    v_and_b32 v228, s30, v228
    v_exp_f32 v182, -v50
    v_exp_f32 v183, -v51
    v_add_f32 v182, 1.0, v182
    v_mfma_f32_32x32x16_bf16 v[80:95], a[12:15], a[152:155], v[80:95]
    global_load_dwordx4 a[220:223], v2, s[4:5] offset:3072
    v_add_u32 v2, 8192, v2
    v_add_f32 v183, 1.0, v183
    v_rcp_f32 v182, v182
    v_rcp_f32 v183, v183
    v_mul_f32 v182, v18, v182
    v_mfma_f32_32x32x16_bf16 v[112:127], a[12:15], a[156:159], v[112:127]
    v_mul_f32 v183, v19, v183
    v_cvt_pk_bf16_f32 v229, v182, v183
    v_and_b32 v229, s30, v229
    ds_write_b64 v7, v[228:229] offset:0
    s_waitcnt vmcnt(12)
    v_mfma_f32_32x32x16_bf16 v[80:95], a[16:19], a[160:163], v[80:95]
    global_load_dwordx4 a[224:227], v2, s[4:5] offset:-4096
    v_exp_f32 v180, -v52
    v_exp_f32 v181, -v53
    v_add_f32 v180, 1.0, v180
    v_add_f32 v181, 1.0, v181
    v_mfma_f32_32x32x16_bf16 v[112:127], a[16:19], a[164:167], v[112:127]
    v_rcp_f32 v180, v180
    v_rcp_f32 v181, v181
    v_mul_f32 v180, v20, v180
    v_mul_f32 v181, v21, v181
    v_mfma_f32_32x32x16_bf16 v[80:95], a[20:23], a[168:171], v[80:95]
    global_load_dwordx4 a[228:231], v2, s[4:5] offset:-3072
    v_cvt_pk_bf16_f32 v230, v180, v181
    v_and_b32 v230, s30, v230
    v_exp_f32 v182, -v54
    v_exp_f32 v183, -v55
    v_add_f32 v182, 1.0, v182
    v_mfma_f32_32x32x16_bf16 v[112:127], a[20:23], a[172:175], v[112:127]
    v_add_f32 v183, 1.0, v183
    v_rcp_f32 v182, v182
    v_rcp_f32 v183, v183
    v_mul_f32 v182, v22, v182
    s_waitcnt vmcnt(10)
    v_mfma_f32_32x32x16_bf16 v[80:95], a[24:27], a[176:179], v[80:95]
    global_load_dwordx4 a[232:235], v2, s[4:5] offset:-2048
    v_mul_f32 v183, v23, v183
    v_cvt_pk_bf16_f32 v231, v182, v183
    v_and_b32 v231, s30, v231
    ds_write_b64 v7, v[230:231] offset:16
    v_mfma_f32_32x32x16_bf16 v[112:127], a[24:27], a[180:183], v[112:127]
    global_load_dwordx4 a[236:239], v2, s[4:5] offset:-1024
    v_exp_f32 v180, -v56
    v_exp_f32 v181, -v57
    v_add_f32 v180, 1.0, v180
    v_add_f32 v181, 1.0, v181
    v_mfma_f32_32x32x16_bf16 v[80:95], a[28:31], a[184:187], v[80:95]
    global_load_dwordx4 a[240:243], v2, s[4:5] offset:0
    v_rcp_f32 v180, v180
    v_rcp_f32 v181, v181
    v_mul_f32 v180, v24, v180
    v_mul_f32 v181, v25, v181
    v_mfma_f32_32x32x16_bf16 v[112:127], a[28:31], a[188:191], v[112:127]
    global_load_dwordx4 a[244:247], v2, s[4:5] offset:1024
    v_cvt_pk_bf16_f32 v232, v180, v181
    v_exp_f32 v182, -v58
    v_exp_f32 v183, -v59
    v_add_f32 v182, 1.0, v182
    s_waitcnt vmcnt(10)
    v_mfma_f32_32x32x16_bf16 v[80:95], a[32:35], a[192:195], v[80:95]
    global_load_dwordx4 a[248:251], v2, s[4:5] offset:2048
    v_add_f32 v183, 1.0, v183
    v_rcp_f32 v182, v182
    v_rcp_f32 v183, v183
    v_mul_f32 v182, v26, v182
    v_mfma_f32_32x32x16_bf16 v[112:127], a[32:35], a[196:199], v[112:127]
    global_load_dwordx4 a[252:255], v2, s[4:5] offset:3072
    v_add_u32 v2, 8192, v2
    v_mul_f32 v183, v27, v183
    v_cvt_pk_bf16_f32 v233, v182, v183
    ds_write_b64 v7, v[232:233] offset:32
    v_exp_f32 v180, -v60
    v_exp_f32 v181, -v61
    v_mfma_f32_32x32x16_bf16 v[80:95], a[36:39], a[200:203], v[80:95]
    v_add_f32 v180, 1.0, v180
    v_add_f32 v181, 1.0, v181
    v_rcp_f32 v180, v180
    v_rcp_f32 v181, v181
    v_mfma_f32_32x32x16_bf16 v[112:127], a[36:39], a[204:207], v[112:127]
    v_mul_f32 v180, v28, v180
    v_mul_f32 v181, v29, v181
    v_cvt_pk_bf16_f32 v234, v180, v181
    v_exp_f32 v182, -v62
    s_waitcnt vmcnt(8)
    v_mfma_f32_32x32x16_bf16 v[80:95], a[40:43], a[208:211], v[80:95]
    v_exp_f32 v183, -v63
    v_add_f32 v182, 1.0, v182
    v_add_f32 v183, 1.0, v183
    v_rcp_f32 v182, v182
    v_mfma_f32_32x32x16_bf16 v[112:127], a[40:43], a[212:215], v[112:127]
    v_rcp_f32 v183, v183
    v_mul_f32 v182, v30, v182
    v_mul_f32 v183, v31, v183
    v_cvt_pk_bf16_f32 v235, v182, v183
    v_mfma_f32_32x32x16_bf16 v[80:95], a[44:47], a[216:219], v[80:95]
    ds_write_b64 v7, v[234:235] offset:48
    v_exp_f32 v180, -v64
    v_exp_f32 v181, -v65
    v_add_f32 v180, 1.0, v180
    v_mfma_f32_32x32x16_bf16 v[112:127], a[44:47], a[220:223], v[112:127]
    v_add_f32 v181, 1.0, v181
    v_rcp_f32 v180, v180
    v_rcp_f32 v181, v181
    v_mul_f32 v180, v32, v180
    s_waitcnt vmcnt(4)
    v_mfma_f32_32x32x16_bf16 v[80:95], a[48:51], a[224:227], v[80:95]
    v_mul_f32 v181, v33, v181
    v_cvt_pk_bf16_f32 v236, v180, v181
    v_exp_f32 v182, -v66
    v_exp_f32 v183, -v67
    v_add_f32 v182, 1.0, v182
    v_mfma_f32_32x32x16_bf16 v[112:127], a[48:51], a[228:231], v[112:127]
    v_add_f32 v183, 1.0, v183
    v_rcp_f32 v182, v182
    v_rcp_f32 v183, v183
    v_mul_f32 v182, v34, v182
    v_mfma_f32_32x32x16_bf16 v[80:95], a[52:55], a[232:235], v[80:95]
    v_mul_f32 v183, v35, v183
    v_cvt_pk_bf16_f32 v237, v182, v183
    ds_write_b64 v7, v[236:237] offset:64
    v_exp_f32 v180, -v68
    v_mfma_f32_32x32x16_bf16 v[112:127], a[52:55], a[236:239], v[112:127]
    v_exp_f32 v181, -v69
    v_add_f32 v180, 1.0, v180
    v_add_f32 v181, 1.0, v181
    v_rcp_f32 v180, v180
    s_waitcnt vmcnt(0)
    v_mfma_f32_32x32x16_bf16 v[80:95], a[56:59], a[240:243], v[80:95]
    v_rcp_f32 v181, v181
    v_mul_f32 v180, v36, v180
    v_mul_f32 v181, v37, v181
    v_cvt_pk_bf16_f32 v238, v180, v181
    v_mfma_f32_32x32x16_bf16 v[112:127], a[56:59], a[244:247], v[112:127]
    v_exp_f32 v182, -v70
    v_exp_f32 v183, -v71
    v_add_f32 v182, 1.0, v182
    v_add_f32 v183, 1.0, v183
    v_mfma_f32_32x32x16_bf16 v[80:95], a[60:63], a[248:251], v[80:95]
    v_rcp_f32 v182, v182
    v_rcp_f32 v183, v183
    v_mul_f32 v182, v38, v182
    v_mul_f32 v183, v39, v183
    v_mfma_f32_32x32x16_bf16 v[112:127], a[60:63], a[252:255], v[112:127]
    v_cvt_pk_bf16_f32 v239, v182, v183
    ds_write_b64 v7, v[238:239] offset:80
    v_exp_f32 v180, -v72
    v_exp_f32 v181, -v73
    v_mfma_f32_32x32x16_bf16 v[96:111], a[64:67], a[128:131], 0
    global_load_dwordx4 a[128:131], v2, s[4:5] offset:-4096
    v_add_f32 v180, 1.0, v180
    v_add_f32 v181, 1.0, v181
    v_rcp_f32 v180, v180
    v_rcp_f32 v181, v181
    v_mfma_f32_32x32x16_bf16 v[128:143], a[64:67], a[132:135], 0
    global_load_dwordx4 a[132:135], v2, s[4:5] offset:-3072
    v_mul_f32 v180, v40, v180
    v_mul_f32 v181, v41, v181
    v_cvt_pk_bf16_f32 v240, v180, v181
    v_and_b32 v240, s31, v240
    v_mfma_f32_32x32x16_bf16 v[96:111], a[68:71], a[136:139], v[96:111]
    v_exp_f32 v182, -v74
    v_exp_f32 v183, -v75
    v_add_f32 v182, 1.0, v182
    v_add_f32 v183, 1.0, v183
    v_mfma_f32_32x32x16_bf16 v[128:143], a[68:71], a[140:143], v[128:143]
    global_load_dwordx4 a[136:139], v2, s[4:5] offset:-2048
    v_rcp_f32 v182, v182
    v_rcp_f32 v183, v183
    v_mul_f32 v182, v42, v182
    v_mfma_f32_32x32x16_bf16 v[96:111], a[72:75], a[144:147], v[96:111]
    v_mul_f32 v183, v43, v183
    v_cvt_pk_bf16_f32 v241, v182, v183
    v_and_b32 v241, s31, v241
    ds_write_b64 v7, v[240:241] offset:96
    v_mfma_f32_32x32x16_bf16 v[128:143], a[72:75], a[148:151], v[128:143]
    global_load_dwordx4 a[140:143], v2, s[4:5] offset:-1024
    v_exp_f32 v180, -v76
    v_exp_f32 v181, -v77
    v_add_f32 v180, 1.0, v180
    v_add_f32 v181, 1.0, v181
    v_mfma_f32_32x32x16_bf16 v[96:111], a[76:79], a[152:155], v[96:111]
    v_rcp_f32 v180, v180
    v_rcp_f32 v181, v181
    v_mul_f32 v180, v44, v180
    v_mul_f32 v181, v45, v181
    v_mfma_f32_32x32x16_bf16 v[128:143], a[76:79], a[156:159], v[128:143]
    global_load_dwordx4 a[144:147], v2, s[4:5] offset:0
    v_cvt_pk_bf16_f32 v242, v180, v181
    v_and_b32 v242, s31, v242
    v_exp_f32 v182, -v78
    v_mfma_f32_32x32x16_bf16 v[96:111], a[80:83], a[160:163], v[96:111]
    v_exp_f32 v183, -v79
    v_add_f32 v182, 1.0, v182
    v_add_f32 v183, 1.0, v183
    v_rcp_f32 v182, v182
    v_mfma_f32_32x32x16_bf16 v[128:143], a[80:83], a[164:167], v[128:143]
    global_load_dwordx4 a[148:151], v2, s[4:5] offset:1024
    v_rcp_f32 v183, v183
    v_mul_f32 v182, v46, v182
    v_mul_f32 v183, v47, v183
    v_cvt_pk_bf16_f32 v243, v182, v183
    v_mfma_f32_32x32x16_bf16 v[96:111], a[84:87], a[168:171], v[96:111]
    v_and_b32 v243, s31, v243
    ds_write_b64 v7, v[242:243] offset:112
    v_exp_f32 v180, -v112
    v_exp_f32 v181, -v113
    v_mfma_f32_32x32x16_bf16 v[128:143], a[84:87], a[172:175], v[128:143]
    global_load_dwordx4 a[152:155], v2, s[4:5] offset:2048
    v_add_f32 v180, 1.0, v180
    v_add_f32 v181, 1.0, v181
    v_rcp_f32 v180, v180
    v_mfma_f32_32x32x16_bf16 v[96:111], a[88:91], a[176:179], v[96:111]
    v_rcp_f32 v181, v181
    v_mul_f32 v180, v80, v180
    v_mul_f32 v181, v81, v181
    v_cvt_pk_bf16_f32 v228, v180, v181
    v_mfma_f32_32x32x16_bf16 v[128:143], a[88:91], a[180:183], v[128:143]
    global_load_dwordx4 a[156:159], v2, s[4:5] offset:3072
    v_add_u32 v2, 8192, v2
    v_and_b32 v228, s30, v228
    v_exp_f32 v182, -v114
    v_exp_f32 v183, -v115
    v_add_f32 v182, 1.0, v182
    v_mfma_f32_32x32x16_bf16 v[96:111], a[92:95], a[184:187], v[96:111]
    v_add_f32 v183, 1.0, v183
    v_rcp_f32 v182, v182
    v_rcp_f32 v183, v183
    v_mul_f32 v182, v82, v182
    v_mfma_f32_32x32x16_bf16 v[128:143], a[92:95], a[188:191], v[128:143]
    global_load_dwordx4 a[160:163], v2, s[4:5] offset:-4096
    v_mul_f32 v183, v83, v183
    v_cvt_pk_bf16_f32 v229, v182, v183
    v_and_b32 v229, s30, v229
    v_mfma_f32_32x32x16_bf16 v[96:111], a[96:99], a[192:195], v[96:111]
    ds_write_b64 v7, v[228:229] offset:5120
    v_exp_f32 v180, -v116
    v_exp_f32 v181, -v117
    v_add_f32 v180, 1.0, v180
    v_mfma_f32_32x32x16_bf16 v[128:143], a[96:99], a[196:199], v[128:143]
    global_load_dwordx4 a[164:167], v2, s[4:5] offset:-3072
    v_add_f32 v181, 1.0, v181
    v_rcp_f32 v180, v180
    v_rcp_f32 v181, v181
    v_mul_f32 v180, v84, v180
    v_mfma_f32_32x32x16_bf16 v[96:111], a[100:103], a[200:203], v[96:111]
    v_mul_f32 v181, v85, v181
    v_cvt_pk_bf16_f32 v230, v180, v181
    v_and_b32 v230, s30, v230
    v_exp_f32 v182, -v118
    v_mfma_f32_32x32x16_bf16 v[128:143], a[100:103], a[204:207], v[128:143]
    global_load_dwordx4 a[168:171], v2, s[4:5] offset:-2048
    v_exp_f32 v183, -v119
    v_add_f32 v182, 1.0, v182
    v_add_f32 v183, 1.0, v183
    v_mfma_f32_32x32x16_bf16 v[96:111], a[104:107], a[208:211], v[96:111]
    v_rcp_f32 v182, v182
    v_rcp_f32 v183, v183
    v_mul_f32 v182, v86, v182
    v_mul_f32 v183, v87, v183
    v_mfma_f32_32x32x16_bf16 v[128:143], a[104:107], a[212:215], v[128:143]
    global_load_dwordx4 a[172:175], v2, s[4:5] offset:-1024
    v_cvt_pk_bf16_f32 v231, v182, v183
    v_and_b32 v231, s30, v231
    ds_write_b64 v7, v[230:231] offset:5136
    v_exp_f32 v180, -v120
    v_mfma_f32_32x32x16_bf16 v[96:111], a[108:111], a[216:219], v[96:111]
    v_exp_f32 v181, -v121
    v_add_f32 v180, 1.0, v180
    v_add_f32 v181, 1.0, v181
    v_rcp_f32 v180, v180
    v_mfma_f32_32x32x16_bf16 v[128:143], a[108:111], a[220:223], v[128:143]
    v_rcp_f32 v181, v181
    v_mul_f32 v180, v88, v180
    v_mul_f32 v181, v89, v181
    v_mfma_f32_32x32x16_bf16 v[96:111], a[112:115], a[224:227], v[96:111]
    global_load_dwordx4 a[176:179], v2, s[4:5] offset:0
    v_cvt_pk_bf16_f32 v232, v180, v181
    v_exp_f32 v182, -v122
    v_exp_f32 v183, -v123
    v_add_f32 v182, 1.0, v182
    v_mfma_f32_32x32x16_bf16 v[128:143], a[112:115], a[228:231], v[128:143]
    v_add_f32 v183, 1.0, v183
    v_rcp_f32 v182, v182
    v_rcp_f32 v183, v183
    v_mul_f32 v182, v90, v182
    v_mfma_f32_32x32x16_bf16 v[96:111], a[116:119], a[232:235], v[96:111]
    global_load_dwordx4 a[180:183], v2, s[4:5] offset:1024
    v_mul_f32 v183, v91, v183
    v_cvt_pk_bf16_f32 v233, v182, v183
    ds_write_b64 v7, v[232:233] offset:5152
    v_exp_f32 v180, -v124
    v_mfma_f32_32x32x16_bf16 v[128:143], a[116:119], a[236:239], v[128:143]
    v_exp_f32 v181, -v125
    v_add_f32 v180, 1.0, v180
    v_add_f32 v181, 1.0, v181
    v_mfma_f32_32x32x16_bf16 v[96:111], a[120:123], a[240:243], v[96:111]
    global_load_dwordx4 a[184:187], v2, s[4:5] offset:2048
    v_rcp_f32 v180, v180
    v_rcp_f32 v181, v181
    v_mul_f32 v180, v92, v180
    v_mul_f32 v181, v93, v181
    v_mfma_f32_32x32x16_bf16 v[128:143], a[120:123], a[244:247], v[128:143]
    v_cvt_pk_bf16_f32 v234, v180, v181
    v_exp_f32 v182, -v126
    v_exp_f32 v183, -v127
    v_add_f32 v182, 1.0, v182
    v_mfma_f32_32x32x16_bf16 v[96:111], a[124:127], a[248:251], v[96:111]
    global_load_dwordx4 a[188:191], v2, s[4:5] offset:3072
    v_add_u32 v2, 8192, v2
    v_add_f32 v183, 1.0, v183
    v_rcp_f32 v182, v182
    v_rcp_f32 v183, v183
    v_mul_f32 v182, v94, v182
    v_mfma_f32_32x32x16_bf16 v[128:143], a[124:127], a[252:255], v[128:143]
    v_mul_f32 v183, v95, v183
    v_cvt_pk_bf16_f32 v235, v182, v183
    ds_write_b64 v7, v[234:235] offset:5168
    ds_read_b64 a[0:1], v8 offset:0
    global_load_dwordx4 a[192:195], v2, s[4:5] offset:-4096
    ds_read_b64 a[2:3], v8 offset:8
    ds_read_b64 a[4:5], v8 offset:16
    ds_read_b64 a[6:7], v8 offset:24
    ds_read_b64 a[8:9], v8 offset:32
    ds_read_b64 a[10:11], v8 offset:40
    ds_read_b64 a[12:13], v8 offset:48
    ds_read_b64 a[14:15], v8 offset:56
    ds_read_b64 a[16:17], v8 offset:64
    ds_read_b64 a[18:19], v8 offset:72
    ds_read_b64 a[20:21], v8 offset:80
    ds_read_b64 a[22:23], v8 offset:88
    ds_read_b64 a[24:25], v8 offset:96
    v_exp_f32 v180, -v128
    global_load_dwordx4 a[196:199], v2, s[4:5] offset:-3072
    v_exp_f32 v181, -v129
    ds_read_b64 a[26:27], v8 offset:2560
    v_add_f32 v180, 1.0, v180
    v_add_f32 v181, 1.0, v181
    v_rcp_f32 v180, v180
    ds_read_b64 a[28:29], v8 offset:2568
    v_rcp_f32 v181, v181
    v_mul_f32 v180, v96, v180
    ds_read_b64 a[30:31], v8 offset:2576
    v_mul_f32 v181, v97, v181
    v_cvt_pk_bf16_f32 v236, v180, v181
    v_exp_f32 v182, -v130
    global_load_dwordx4 a[200:203], v2, s[4:5] offset:-2048
    ds_read_b64 a[32:33], v8 offset:2584
    v_exp_f32 v183, -v131
    v_add_f32 v182, 1.0, v182
    ds_read_b64 a[34:35], v8 offset:2592
    v_add_f32 v183, 1.0, v183
    v_rcp_f32 v182, v182
    v_rcp_f32 v183, v183
    ds_read_b64 a[36:37], v8 offset:2600
    v_mul_f32 v182, v98, v182
    v_mul_f32 v183, v99, v183
    v_cvt_pk_bf16_f32 v237, v182, v183
    ds_read_b64 a[38:39], v8 offset:2608
    global_load_dwordx4 a[204:207], v2, s[4:5] offset:-1024
    ds_write_b64 v7, v[236:237] offset:5184
    v_exp_f32 v180, -v132
    ds_read_b64 a[40:41], v8 offset:2616
    v_exp_f32 v181, -v133
    v_add_f32 v180, 1.0, v180
    v_add_f32 v181, 1.0, v181
    ds_read_b64 a[42:43], v8 offset:2624
    v_rcp_f32 v180, v180
    v_rcp_f32 v181, v181
    ds_read_b64 a[44:45], v8 offset:2632
    v_mul_f32 v180, v100, v180
    v_mul_f32 v181, v101, v181
    global_load_dwordx4 a[208:211], v2, s[4:5] offset:0
    v_cvt_pk_bf16_f32 v238, v180, v181
    ds_read_b64 a[46:47], v8 offset:2640
    v_exp_f32 v182, -v134
    v_exp_f32 v183, -v135
    ds_read_b64 a[48:49], v8 offset:2648
    v_add_f32 v182, 1.0, v182
    v_add_f32 v183, 1.0, v183
    v_rcp_f32 v182, v182
    ds_read_b64 a[50:51], v8 offset:2656
    v_rcp_f32 v183, v183
    v_mul_f32 v182, v102, v182
    v_mul_f32 v183, v103, v183
    global_load_dwordx4 a[212:215], v2, s[4:5] offset:1024
    s_waitcnt lgkmcnt(0)
    s_waitcnt vmcnt(19)
    v_mfma_f32_4x4x4_16b_bf16 v[16:19], a[128:129], a[0:1], 0
    v_cvt_pk_bf16_f32 v239, v182, v183
    ds_write_b64 v7, v[238:239] offset:5200
    v_mfma_f32_4x4x4_16b_bf16 v[20:23], a[128:129], a[8:9], 0
    v_exp_f32 v180, -v136
    v_mfma_f32_4x4x4_16b_bf16 v[24:27], a[130:131], a[26:27], 0
    v_exp_f32 v181, -v137
    v_mfma_f32_4x4x4_16b_bf16 v[28:31], a[130:131], a[34:35], 0
    global_load_dwordx4 a[216:219], v2, s[4:5] offset:2048
    v_add_f32 v180, 1.0, v180
    v_mfma_f32_4x4x4_16b_bf16 v[16:19], a[132:133], a[2:3], v[16:19]
    v_add_f32 v181, 1.0, v181
    v_rcp_f32 v180, v180
    v_mfma_f32_4x4x4_16b_bf16 v[20:23], a[132:133], a[10:11], v[20:23]
    v_rcp_f32 v181, v181
    v_mfma_f32_4x4x4_16b_bf16 v[24:27], a[134:135], a[28:29], v[24:27]
    v_mul_f32 v180, v104, v180
    v_mfma_f32_4x4x4_16b_bf16 v[28:31], a[134:135], a[36:37], v[28:31]
    v_mul_f32 v181, v105, v181
    global_load_dwordx4 a[220:223], v2, s[4:5] offset:3072
    v_add_u32 v2, 8192, v2
    v_mfma_f32_4x4x4_16b_bf16 v[16:19], a[136:137], a[4:5], v[16:19]
    v_cvt_pk_bf16_f32 v240, v180, v181
    v_mfma_f32_4x4x4_16b_bf16 v[20:23], a[136:137], a[12:13], v[20:23]
    v_and_b32 v240, s31, v240
    v_exp_f32 v182, -v138
    v_mfma_f32_4x4x4_16b_bf16 v[24:27], a[138:139], a[30:31], v[24:27]
    v_exp_f32 v183, -v139
    v_mfma_f32_4x4x4_16b_bf16 v[28:31], a[138:139], a[38:39], v[28:31]
    v_add_f32 v182, 1.0, v182
    global_load_dwordx4 a[224:227], v2, s[4:5] offset:-4096
    s_waitcnt vmcnt(19)
    v_mfma_f32_4x4x4_16b_bf16 v[16:19], a[140:141], a[6:7], v[16:19]
    v_add_f32 v183, 1.0, v183
    v_mfma_f32_4x4x4_16b_bf16 v[20:23], a[140:141], a[14:15], v[20:23]
    v_rcp_f32 v182, v182
    v_rcp_f32 v183, v183
    v_mfma_f32_4x4x4_16b_bf16 v[24:27], a[142:143], a[32:33], v[24:27]
    v_mul_f32 v182, v106, v182
    v_mfma_f32_4x4x4_16b_bf16 v[28:31], a[142:143], a[40:41], v[28:31]
    v_mul_f32 v183, v107, v183
    global_load_dwordx4 a[228:231], v2, s[4:5] offset:-3072
    v_mfma_f32_4x4x4_16b_bf16 v[16:19], a[144:145], a[8:9], v[16:19]
    v_cvt_pk_bf16_f32 v241, v182, v183
    v_mfma_f32_4x4x4_16b_bf16 v[20:23], a[144:145], a[16:17], v[20:23]
    v_and_b32 v241, s31, v241
    v_mfma_f32_4x4x4_16b_bf16 v[24:27], a[146:147], a[34:35], v[24:27]
    ds_write_b64 v7, v[240:241] offset:5216
    v_exp_f32 v180, -v140
    v_mfma_f32_4x4x4_16b_bf16 v[28:31], a[146:147], a[42:43], v[28:31]
    v_exp_f32 v181, -v141
    v_mfma_f32_4x4x4_16b_bf16 v[16:19], a[148:149], a[10:11], v[16:19]
    global_load_dwordx4 a[232:235], v2, s[4:5] offset:-2048
    v_add_f32 v180, 1.0, v180
    v_mfma_f32_4x4x4_16b_bf16 v[20:23], a[148:149], a[18:19], v[20:23]
    v_add_f32 v181, 1.0, v181
    v_mfma_f32_4x4x4_16b_bf16 v[24:27], a[150:151], a[36:37], v[24:27]
    v_rcp_f32 v180, v180
    v_rcp_f32 v181, v181
    v_mfma_f32_4x4x4_16b_bf16 v[28:31], a[150:151], a[44:45], v[28:31]
    v_mul_f32 v180, v108, v180
    s_waitcnt vmcnt(18)
    v_mfma_f32_4x4x4_16b_bf16 v[16:19], a[152:153], a[12:13], v[16:19]
    global_load_dwordx4 a[236:239], v2, s[4:5] offset:-1024
    v_mul_f32 v181, v109, v181
    v_mfma_f32_4x4x4_16b_bf16 v[20:23], a[152:153], a[20:21], v[20:23]
    v_cvt_pk_bf16_f32 v242, v180, v181
    v_mfma_f32_4x4x4_16b_bf16 v[24:27], a[154:155], a[38:39], v[24:27]
    v_and_b32 v242, s31, v242
    v_mfma_f32_4x4x4_16b_bf16 v[28:31], a[154:155], a[46:47], v[28:31]
    v_exp_f32 v182, -v142
    v_exp_f32 v183, -v143
    v_mfma_f32_4x4x4_16b_bf16 v[16:19], a[156:157], a[14:15], v[16:19]
    global_load_dwordx4 a[240:243], v2, s[4:5] offset:0
    v_add_f32 v182, 1.0, v182
    v_mfma_f32_4x4x4_16b_bf16 v[20:23], a[156:157], a[22:23], v[20:23]
    v_add_f32 v183, 1.0, v183
    v_mfma_f32_4x4x4_16b_bf16 v[24:27], a[158:159], a[40:41], v[24:27]
    v_rcp_f32 v182, v182
    v_mfma_f32_4x4x4_16b_bf16 v[28:31], a[158:159], a[48:49], v[28:31]
    v_rcp_f32 v183, v183
    v_mul_f32 v182, v110, v182
    v_mfma_f32_4x4x4_16b_bf16 v[16:19], a[160:161], a[16:17], v[16:19]
    v_mul_f32 v183, v111, v183
    global_load_dwordx4 a[244:247], v2, s[4:5] offset:1024
    v_mfma_f32_4x4x4_16b_bf16 v[20:23], a[160:161], a[24:25], v[20:23]
    v_cvt_pk_bf16_f32 v243, v182, v183
    v_mfma_f32_4x4x4_16b_bf16 v[24:27], a[162:163], a[42:43], v[24:27]
    v_and_b32 v243, s31, v243
    v_mfma_f32_4x4x4_16b_bf16 v[28:31], a[162:163], a[50:51], v[28:31]
    ds_write_b64 v7, v[242:243] offset:5232
    ds_read_b64 a[64:65], v8 offset:5120
    ds_read_b64 a[66:67], v8 offset:5128
    ds_read_b64 a[68:69], v8 offset:5136
    ds_read_b64 a[70:71], v8 offset:5144
    ds_read_b64 a[72:73], v8 offset:5152
    ds_read_b64 a[74:75], v8 offset:5160
    ds_read_b64 a[76:77], v8 offset:5168
    global_load_dwordx4 a[248:251], v2, s[4:5] offset:2048
    ds_read_b64 a[78:79], v8 offset:5176
    ds_read_b64 a[80:81], v8 offset:5184
    v_exp_f32 v180, -v16
    v_exp_f32 v181, -v17
    ds_read_b64 a[82:83], v8 offset:5192
    v_add_f32 v180, 1.0, v180
    v_add_f32 v181, 1.0, v181
    ds_read_b64 a[84:85], v8 offset:5200
    v_rcp_f32 v180, v180
    v_rcp_f32 v181, v181
    v_mul_f32 v180, v16, v180
    ds_read_b64 a[86:87], v8 offset:5208
    global_load_dwordx4 a[252:255], v2, s[4:5] offset:3072
    v_add_u32 v2, 8192, v2
    v_mul_f32 v181, v17, v181
    v_cvt_pk_bf16_f32 v244, v180, v181
    ds_read_b64 a[88:89], v8 offset:5216
    v_exp_f32 v182, -v18
    v_exp_f32 v183, -v19
    v_add_f32 v182, 1.0, v182
    ds_read_b64 a[90:91], v8 offset:7680
    v_add_f32 v183, 1.0, v183
    v_rcp_f32 v182, v182
    ds_read_b64 a[92:93], v8 offset:7688
    v_rcp_f32 v183, v183
    global_load_dwordx4 a[128:131], v2, s[4:5] offset:-4096
    v_mul_f32 v182, v18, v182
    v_mul_f32 v183, v19, v183
    ds_read_b64 a[94:95], v8 offset:7696
    v_cvt_pk_bf16_f32 v245, v182, v183
    ds_write_b64 v12, v[244:245] offset:0
    ds_read_b64 a[96:97], v8 offset:7704
    v_exp_f32 v180, -v20
    v_exp_f32 v181, -v21
    v_add_f32 v180, 1.0, v180
    ds_read_b64 a[98:99], v8 offset:7712
    v_add_f32 v181, 1.0, v181
    v_rcp_f32 v180, v180
    ds_read_b64 a[100:101], v8 offset:7720
    global_load_dwordx4 a[132:135], v2, s[4:5] offset:-3072
    v_rcp_f32 v181, v181
    v_mul_f32 v180, v20, v180
    ds_read_b64 a[102:103], v8 offset:7728
    v_mul_f32 v181, v21, v181
    v_cvt_pk_bf16_f32 v246, v180, v181
    v_exp_f32 v182, -v22
    ds_read_b64 a[104:105], v8 offset:7736
    v_exp_f32 v183, -v23
    v_add_f32 v182, 1.0, v182
    ds_read_b64 a[106:107], v8 offset:7744
    v_add_f32 v183, 1.0, v183
    v_rcp_f32 v182, v182
    global_load_dwordx4 a[136:139], v2, s[4:5] offset:-2048
    v_rcp_f32 v183, v183
    ds_read_b64 a[108:109], v8 offset:7752
    v_mul_f32 v182, v22, v182
    v_mul_f32 v183, v23, v183
    ds_read_b64 a[110:111], v8 offset:7760
    v_cvt_pk_bf16_f32 v247, v182, v183
    ds_write_b64 v12, v[246:247] offset:32
    v_exp_f32 v180, -v24
    ds_read_b64 a[112:113], v8 offset:7768
    v_exp_f32 v181, -v25
    v_add_f32 v180, 1.0, v180
    ds_read_b64 a[114:115], v8 offset:7776
    v_add_f32 v181, 1.0, v181
    global_load_dwordx4 a[140:143], v2, s[4:5] offset:-1024
    v_rcp_f32 v180, v180
    v_rcp_f32 v181, v181
    s_waitcnt lgkmcnt(0)
    s_waitcnt vmcnt(24)
    v_mfma_f32_4x4x4_16b_bf16 v[32:35], a[164:165], a[64:65], 0
    v_mul_f32 v180, v24, v180
    v_mfma_f32_4x4x4_16b_bf16 v[36:39], a[164:165], a[72:73], 0
    v_mul_f32 v181, v25, v181
    v_mfma_f32_4x4x4_16b_bf16 v[40:43], a[166:167], a[90:91], 0
    v_cvt_pk_bf16_f32 v248, v180, v181
    v_mfma_f32_4x4x4_16b_bf16 v[44:47], a[166:167], a[98:99], 0
    global_load_dwordx4 a[144:147], v2, s[4:5] offset:0
    v_exp_f32 v182, -v26
    v_mfma_f32_4x4x4_16b_bf16 v[32:35], a[168:169], a[66:67], v[32:35]
    v_exp_f32 v183, -v27
    v_mfma_f32_4x4x4_16b_bf16 v[36:39], a[168:169], a[74:75], v[36:39]
    v_add_f32 v182, 1.0, v182
    v_mfma_f32_4x4x4_16b_bf16 v[40:43], a[170:171], a[92:93], v[40:43]
    v_add_f32 v183, 1.0, v183
    v_mfma_f32_4x4x4_16b_bf16 v[44:47], a[170:171], a[100:101], v[44:47]
    v_rcp_f32 v182, v182
    global_load_dwordx4 a[148:151], v2, s[4:5] offset:1024
    v_mfma_f32_4x4x4_16b_bf16 v[32:35], a[172:173], a[68:69], v[32:35]
    v_mfma_f32_4x4x4_16b_bf16 v[36:39], a[172:173], a[76:77], v[36:39]
    v_rcp_f32 v183, v183
    v_mfma_f32_4x4x4_16b_bf16 v[40:43], a[174:175], a[94:95], v[40:43]
    v_mul_f32 v182, v26, v182
    v_mfma_f32_4x4x4_16b_bf16 v[44:47], a[174:175], a[102:103], v[44:47]
    v_mul_f32 v183, v27, v183
    s_waitcnt vmcnt(23)
    v_mfma_f32_4x4x4_16b_bf16 v[32:35], a[176:177], a[70:71], v[32:35]
    global_load_dwordx4 a[152:155], v2, s[4:5] offset:2048
    v_cvt_pk_bf16_f32 v249, v182, v183
    v_mfma_f32_4x4x4_16b_bf16 v[36:39], a[176:177], a[78:79], v[36:39]
    ds_write_b64 v12, v[248:249] offset:1280
    v_mfma_f32_4x4x4_16b_bf16 v[40:43], a[178:179], a[96:97], v[40:43]
    v_exp_f32 v180, -v28
    v_mfma_f32_4x4x4_16b_bf16 v[44:47], a[178:179], a[104:105], v[44:47]
    v_exp_f32 v181, -v29
    v_mfma_f32_4x4x4_16b_bf16 v[32:35], a[180:181], a[72:73], v[32:35]
    v_add_f32 v180, 1.0, v180
    v_mfma_f32_4x4x4_16b_bf16 v[36:39], a[180:181], a[80:81], v[36:39]
    global_load_dwordx4 a[156:159], v2, s[4:5] offset:3072
    v_add_u32 v2, 8192, v2
    v_mfma_f32_4x4x4_16b_bf16 v[40:43], a[182:183], a[98:99], v[40:43]
    v_add_f32 v181, 1.0, v181
    v_mfma_f32_4x4x4_16b_bf16 v[44:47], a[182:183], a[106:107], v[44:47]
    v_rcp_f32 v180, v180
    v_mfma_f32_4x4x4_16b_bf16 v[32:35], a[184:185], a[74:75], v[32:35]
    v_rcp_f32 v181, v181
    v_mfma_f32_4x4x4_16b_bf16 v[36:39], a[184:185], a[82:83], v[36:39]
    v_mul_f32 v180, v28, v180
    global_load_dwordx4 a[160:163], v2, s[4:5] offset:-4096
    v_mfma_f32_4x4x4_16b_bf16 v[40:43], a[186:187], a[100:101], v[40:43]
    v_mul_f32 v181, v29, v181
    v_mfma_f32_4x4x4_16b_bf16 v[44:47], a[186:187], a[108:109], v[44:47]
    v_cvt_pk_bf16_f32 v250, v180, v181
    s_waitcnt vmcnt(23)
    v_mfma_f32_4x4x4_16b_bf16 v[32:35], a[188:189], a[76:77], v[32:35]
    v_exp_f32 v182, -v30
    v_mfma_f32_4x4x4_16b_bf16 v[36:39], a[188:189], a[84:85], v[36:39]
    v_exp_f32 v183, -v31
    v_mfma_f32_4x4x4_16b_bf16 v[40:43], a[190:191], a[102:103], v[40:43]
    global_load_dwordx4 a[164:167], v2, s[4:5] offset:-3072
    v_mfma_f32_4x4x4_16b_bf16 v[44:47], a[190:191], a[110:111], v[44:47]
    v_add_f32 v182, 1.0, v182
    v_mfma_f32_4x4x4_16b_bf16 v[32:35], a[192:193], a[78:79], v[32:35]
    v_add_f32 v183, 1.0, v183
    v_mfma_f32_4x4x4_16b_bf16 v[36:39], a[192:193], a[86:87], v[36:39]
    v_rcp_f32 v182, v182
    v_mfma_f32_4x4x4_16b_bf16 v[40:43], a[194:195], a[104:105], v[40:43]
    v_rcp_f32 v183, v183
    v_mfma_f32_4x4x4_16b_bf16 v[44:47], a[194:195], a[112:113], v[44:47]
    global_load_dwordx4 a[168:171], v2, s[4:5] offset:-2048
    v_mul_f32 v182, v30, v182
    v_mfma_f32_4x4x4_16b_bf16 v[32:35], a[196:197], a[80:81], v[32:35]
    v_mul_f32 v183, v31, v183
    v_mfma_f32_4x4x4_16b_bf16 v[36:39], a[196:197], a[88:89], v[36:39]
    v_cvt_pk_bf16_f32 v251, v182, v183
    v_mfma_f32_4x4x4_16b_bf16 v[40:43], a[198:199], a[106:107], v[40:43]
    ds_write_b64 v12, v[250:251] offset:1312
    v_mfma_f32_4x4x4_16b_bf16 v[44:47], a[198:199], a[114:115], v[44:47]
    s_nop 3
    global_load_dwordx4 a[172:175], v2, s[4:5] offset:-1024
    v_exp_f32 v180, -v32
    v_exp_f32 v181, -v33
    v_add_f32 v180, 1.0, v180
    v_add_f32 v181, 1.0, v181
    v_rcp_f32 v180, v180
    v_rcp_f32 v181, v181
    v_mul_f32 v180, v32, v180
    v_mul_f32 v181, v33, v181
    v_cvt_pk_bf16_f32 v244, v180, v181
    v_exp_f32 v182, -v34
    global_load_dwordx4 a[176:179], v2, s[4:5] offset:0
    v_exp_f32 v183, -v35
    v_add_f32 v182, 1.0, v182
    v_add_f32 v183, 1.0, v183
    v_rcp_f32 v182, v182
    v_rcp_f32 v183, v183
    v_mul_f32 v182, v34, v182
    v_mul_f32 v183, v35, v183
    v_cvt_pk_bf16_f32 v245, v182, v183
    ds_write_b64 v12, v[244:245] offset:2560
    v_exp_f32 v180, -v36
    v_exp_f32 v181, -v37
    global_load_dwordx4 a[180:183], v2, s[4:5] offset:1024
    v_add_f32 v180, 1.0, v180
    v_add_f32 v181, 1.0, v181
    v_rcp_f32 v180, v180
    v_rcp_f32 v181, v181
    v_mul_f32 v180, v36, v180
    v_mul_f32 v181, v37, v181
    v_cvt_pk_bf16_f32 v246, v180, v181
    v_exp_f32 v182, -v38
    v_exp_f32 v183, -v39
    v_add_f32 v182, 1.0, v182
    v_add_f32 v183, 1.0, v183
    v_rcp_f32 v182, v182
    global_load_dwordx4 a[184:187], v2, s[4:5] offset:2048
    v_rcp_f32 v183, v183
    v_mul_f32 v182, v38, v182
    v_mul_f32 v183, v39, v183
    v_cvt_pk_bf16_f32 v247, v182, v183
    ds_write_b64 v12, v[246:247] offset:2592
    v_exp_f32 v180, -v40
    v_exp_f32 v181, -v41
    v_add_f32 v180, 1.0, v180
    v_add_f32 v181, 1.0, v181
    v_rcp_f32 v180, v180
    v_rcp_f32 v181, v181
    global_load_dwordx4 a[188:191], v2, s[4:5] offset:3072
    v_add_u32 v2, 8192, v2
    v_mul_f32 v180, v40, v180
    v_mul_f32 v181, v41, v181
    v_cvt_pk_bf16_f32 v248, v180, v181
    v_exp_f32 v182, -v42
    v_exp_f32 v183, -v43
    v_add_f32 v182, 1.0, v182
    v_add_f32 v183, 1.0, v183
    v_rcp_f32 v182, v182
    v_rcp_f32 v183, v183
    v_mul_f32 v182, v42, v182
    global_load_dwordx4 a[192:195], v2, s[4:5] offset:-4096
    v_mul_f32 v183, v43, v183
    v_cvt_pk_bf16_f32 v249, v182, v183
    ds_write_b64 v12, v[248:249] offset:3840
    v_exp_f32 v180, -v44
    v_exp_f32 v181, -v45
    v_add_f32 v180, 1.0, v180
    v_add_f32 v181, 1.0, v181
    v_rcp_f32 v180, v180
    v_rcp_f32 v181, v181
    v_mul_f32 v180, v44, v180
    v_mul_f32 v181, v45, v181
    v_cvt_pk_bf16_f32 v250, v180, v181
    global_load_dwordx4 a[196:199], v2, s[4:5] offset:-3072
    v_add_u32 v2, s22, v2
    v_exp_f32 v182, -v46
    v_exp_f32 v183, -v47
    v_add_f32 v182, 1.0, v182
    v_add_f32 v183, 1.0, v183
    v_rcp_f32 v182, v182
    v_rcp_f32 v183, v183
    v_mul_f32 v182, v46, v182
    v_mul_f32 v183, v47, v183
    v_cvt_pk_bf16_f32 v251, v182, v183
    ds_write_b64 v12, v[250:251] offset:3872
    s_waitcnt lgkmcnt(0)
    s_barrier
    ds_read_b64_tr_b16 a[0:1], v9 offset:0
    ds_read_b64_tr_b16 a[2:3], v9 offset:640
    ds_read_b64_tr_b16 a[4:5], v9 offset:1280
    ds_read_b64_tr_b16 a[6:7], v9 offset:1920
    ds_read_b64_tr_b16 a[8:9], v9 offset:2560
    ds_read_b64_tr_b16 a[10:11], v9 offset:3200
    ds_read_b64_tr_b16 a[12:13], v9 offset:3840
    ds_read_b64_tr_b16 a[14:15], v9 offset:4480
    ds_read_b64_tr_b16 a[16:17], v9 offset:5120
    ds_read_b64_tr_b16 a[18:19], v9 offset:5760
    ds_read_b64_tr_b16 a[20:21], v9 offset:6400
    ds_read_b64_tr_b16 a[22:23], v9 offset:7040
    ds_read_b64_tr_b16 a[24:25], v9 offset:7680
    ds_read_b64_tr_b16 a[26:27], v9 offset:8320
    s_waitcnt lgkmcnt(12)
    s_waitcnt vmcnt(30)
    v_mfma_f32_32x32x16_bf16 v[80:95], a[200:203], a[0:3], v[196:211]
    ds_read_b64_tr_b16 a[28:29], v9 offset:8960
    global_load_dwordx4 a[200:203], v2, s[4:5] offset:-2048
    v_mfma_f32_32x32x16_bf16 v[96:111], a[204:207], a[0:3], v[212:227]
    ds_read_b64_tr_b16 a[30:31], v9 offset:9600
    global_load_dwordx4 a[204:207], v2, s[4:5] offset:-1024
    s_waitcnt lgkmcnt(12)
    s_waitcnt vmcnt(28)
    v_mfma_f32_32x32x16_bf16 v[80:95], a[208:211], a[4:7], v[80:95]
    ds_read_b64_tr_b16 a[32:33], v9 offset:10240
    v_mfma_f32_32x32x16_bf16 v[96:111], a[212:215], a[4:7], v[96:111]
    ds_read_b64_tr_b16 a[34:35], v9 offset:10880
    global_load_dwordx4 a[208:211], v2, s[4:5] offset:0
    s_waitcnt lgkmcnt(12)
    v_mfma_f32_32x32x16_bf16 v[80:95], a[216:219], a[8:11], v[80:95]
    ds_read_b64_tr_b16 a[36:37], v9 offset:11520
    v_mfma_f32_32x32x16_bf16 v[96:111], a[220:223], a[8:11], v[96:111]
    ds_read_b64_tr_b16 a[38:39], v9 offset:12160
    global_load_dwordx4 a[212:215], v2, s[4:5] offset:1024
    s_waitcnt lgkmcnt(12)
    s_waitcnt vmcnt(26)
    v_mfma_f32_32x32x16_bf16 v[80:95], a[224:227], a[12:15], v[80:95]
    ds_read_b64_tr_b16 a[40:41], v9 offset:12800
    v_mfma_f32_32x32x16_bf16 v[96:111], a[228:231], a[12:15], v[96:111]
    ds_read_b64_tr_b16 a[42:43], v9 offset:13440
    global_load_dwordx4 a[216:219], v2, s[4:5] offset:2048
    s_waitcnt lgkmcnt(12)
    v_mfma_f32_32x32x16_bf16 v[80:95], a[232:235], a[16:19], v[80:95]
    ds_read_b64_tr_b16 a[44:45], v9 offset:14080
    v_mfma_f32_32x32x16_bf16 v[96:111], a[236:239], a[16:19], v[96:111]
    ds_read_b64_tr_b16 a[46:47], v9 offset:14720
    global_load_dwordx4 a[220:223], v2, s[4:5] offset:3072
    v_add_u32 v2, 8192, v2
    s_waitcnt lgkmcnt(12)
    s_waitcnt vmcnt(24)
    v_mfma_f32_32x32x16_bf16 v[80:95], a[240:243], a[20:23], v[80:95]
    ds_read_b64_tr_b16 a[48:49], v9 offset:15360
    v_mfma_f32_32x32x16_bf16 v[96:111], a[244:247], a[20:23], v[96:111]
    ds_read_b64_tr_b16 a[50:51], v9 offset:16000
    global_load_dwordx4 a[224:227], v2, s[4:5] offset:-4096
    s_waitcnt lgkmcnt(12)
    v_mfma_f32_32x32x16_bf16 v[80:95], a[248:251], a[24:27], v[80:95]
    ds_read_b64_tr_b16 a[52:53], v9 offset:16640
    v_mfma_f32_32x32x16_bf16 v[96:111], a[252:255], a[24:27], v[96:111]
    ds_read_b64_tr_b16 a[54:55], v9 offset:17280
    s_waitcnt lgkmcnt(12)
    s_waitcnt vmcnt(21)
    v_mfma_f32_32x32x16_bf16 v[80:95], a[128:131], a[28:31], v[80:95]
    ds_read_b64_tr_b16 a[56:57], v9 offset:17920
    global_load_dwordx4 a[228:231], v2, s[4:5] offset:-3072
    v_mfma_f32_32x32x16_bf16 v[96:111], a[132:135], a[28:31], v[96:111]
    ds_read_b64_tr_b16 a[58:59], v9 offset:18560
    s_waitcnt lgkmcnt(12)
    v_mfma_f32_32x32x16_bf16 v[80:95], a[136:139], a[32:35], v[80:95]
    ds_read_b64_tr_b16 a[60:61], v9 offset:19200
    global_load_dwordx4 a[232:235], v2, s[4:5] offset:-2048
    v_mfma_f32_32x32x16_bf16 v[96:111], a[140:143], a[32:35], v[96:111]
    ds_read_b64_tr_b16 a[62:63], v9 offset:19840
    s_waitcnt lgkmcnt(12)
    s_waitcnt vmcnt(19)
    v_mfma_f32_32x32x16_bf16 v[80:95], a[144:147], a[36:39], v[80:95]
    global_load_dwordx4 a[236:239], v2, s[4:5] offset:-1024
    v_mfma_f32_32x32x16_bf16 v[96:111], a[148:151], a[36:39], v[96:111]
    s_waitcnt lgkmcnt(10)
    v_mfma_f32_32x32x16_bf16 v[80:95], a[152:155], a[40:43], v[80:95]
    global_load_dwordx4 a[240:243], v2, s[4:5] offset:0
    v_mfma_f32_32x32x16_bf16 v[96:111], a[156:159], a[40:43], v[96:111]
    s_waitcnt lgkmcnt(8)
    s_waitcnt vmcnt(17)
    v_mfma_f32_32x32x16_bf16 v[80:95], a[160:163], a[44:47], v[80:95]
    global_load_dwordx4 a[244:247], v2, s[4:5] offset:1024
    v_mfma_f32_32x32x16_bf16 v[96:111], a[164:167], a[44:47], v[96:111]
    s_waitcnt lgkmcnt(6)
    v_mfma_f32_32x32x16_bf16 v[80:95], a[168:171], a[48:51], v[80:95]
    global_load_dwordx4 a[248:251], v2, s[4:5] offset:2048
    v_mfma_f32_32x32x16_bf16 v[96:111], a[172:175], a[48:51], v[96:111]
    s_waitcnt lgkmcnt(4)
    s_waitcnt vmcnt(15)
    v_mfma_f32_32x32x16_bf16 v[80:95], a[176:179], a[52:55], v[80:95]
    global_load_dwordx4 a[252:255], v2, s[4:5] offset:3072
    v_add_u32 v2, 8192, v2
    v_mfma_f32_32x32x16_bf16 v[96:111], a[180:183], a[52:55], v[96:111]
    s_waitcnt lgkmcnt(2)
    v_mfma_f32_32x32x16_bf16 v[80:95], a[184:187], a[56:59], v[80:95]
    v_mfma_f32_32x32x16_bf16 v[96:111], a[188:191], a[56:59], v[96:111]
    global_load_dwordx4 a[128:131], v2, s[4:5] offset:-4096
    s_waitcnt lgkmcnt(0)
    s_waitcnt vmcnt(13)
    v_mfma_f32_32x32x16_bf16 v[80:95], a[192:195], a[60:63], v[80:95]
    v_mfma_f32_32x32x16_bf16 v[96:111], a[196:199], a[60:63], v[96:111]
    global_load_dwordx4 a[132:135], v2, s[4:5] offset:-3072
    v_add_u32 v9, 94208, v1
    v_add_u32 v10, 94208, v10
    s_lshl_b32 s57, s20, 12
    v_cmp_eq_u64 vcc, s[36:37], v[254:255]
    s_nop 0
    s_nop 7
    global_load_dwordx4 a[136:139], v2, s[4:5] offset:-2048
    v_pk_add_f32 v[180:181], v[80:81], v[82:83]
    v_pk_mul_f32 v[182:183], v[80:81], v[80:81]
    v_pk_fma_f32 v[182:183], v[82:83], v[82:83], v[182:183]
    v_pk_add_f32 v[180:181], v[180:181], v[84:85]
    v_pk_fma_f32 v[182:183], v[84:85], v[84:85], v[182:183]
    v_pk_add_f32 v[180:181], v[180:181], v[86:87]
    v_pk_fma_f32 v[182:183], v[86:87], v[86:87], v[182:183]
    v_pk_add_f32 v[180:181], v[180:181], v[88:89]
    v_pk_fma_f32 v[182:183], v[88:89], v[88:89], v[182:183]
    v_pk_add_f32 v[180:181], v[180:181], v[90:91]
    v_pk_fma_f32 v[182:183], v[90:91], v[90:91], v[182:183]
    v_pk_add_f32 v[180:181], v[180:181], v[92:93]
    v_pk_fma_f32 v[182:183], v[92:93], v[92:93], v[182:183]
    global_load_dwordx4 a[140:143], v2, s[4:5] offset:-1024
    v_pk_add_f32 v[180:181], v[180:181], v[94:95]
    v_pk_fma_f32 v[182:183], v[94:95], v[94:95], v[182:183]
    v_pk_add_f32 v[180:181], v[180:181], v[96:97]
    v_pk_fma_f32 v[182:183], v[96:97], v[96:97], v[182:183]
    v_pk_add_f32 v[180:181], v[180:181], v[98:99]
    v_pk_fma_f32 v[182:183], v[98:99], v[98:99], v[182:183]
    v_pk_add_f32 v[180:181], v[180:181], v[100:101]
    v_pk_fma_f32 v[182:183], v[100:101], v[100:101], v[182:183]
    v_pk_add_f32 v[180:181], v[180:181], v[102:103]
    v_pk_fma_f32 v[182:183], v[102:103], v[102:103], v[182:183]
    v_pk_add_f32 v[180:181], v[180:181], v[104:105]
    v_pk_fma_f32 v[182:183], v[104:105], v[104:105], v[182:183]
    v_pk_add_f32 v[180:181], v[180:181], v[106:107]
    v_pk_fma_f32 v[182:183], v[106:107], v[106:107], v[182:183]
    v_pk_add_f32 v[180:181], v[180:181], v[108:109]
    v_pk_fma_f32 v[182:183], v[108:109], v[108:109], v[182:183]
    global_load_dwordx4 a[144:147], v2, s[4:5] offset:0
    v_pk_add_f32 v[180:181], v[180:181], v[110:111]
    v_pk_fma_f32 v[182:183], v[110:111], v[110:111], v[182:183]
    v_add_f32 v180, v180, v181
    v_add_f32 v181, v182, v183
    v_mov_b32 v182, v180
    v_mov_b32 v183, v181
    s_nop 1
    v_permlane32_swap_b32 v180, v182
    v_permlane32_swap_b32 v181, v183
    v_pk_add_f32 v[180:181], v[180:181], v[182:183]
    ds_write_b64 v5, v[180:181] offset:2048
    s_waitcnt lgkmcnt(0)
    s_barrier
    global_load_dwordx4 a[148:151], v2, s[4:5] offset:1024
    ds_read_b64 v[180:181], v6 offset:2048
    ds_read_b64 v[182:183], v6 offset:2304
    global_load_dwordx4 a[152:155], v2, s[4:5] offset:2048
    ds_read_b64 v[184:185], v6 offset:2560
    ds_read_b64 v[186:187], v6 offset:2816
    s_waitcnt lgkmcnt(0)
    v_pk_add_f32 v[180:181], v[180:181], v[182:183]
    global_load_dwordx4 a[156:159], v2, s[4:5] offset:3072
    v_add_u32 v2, 8192, v2
    v_pk_add_f32 v[184:185], v[184:185], v[186:187]
    v_pk_add_f32 v[180:181], v[180:181], v[184:185]
    v_mul_f32 v182, 0x3b800000, v180
    v_mul_f32 v181, 0x3b800000, v181
    v_fma_f32 v181, -v182, v182, v181
    v_max_f32 v181, 0, v181
    v_add_f32 v181, 0x37ae990f, v181
    v_rsq_f32 v180, v181
    s_nop 0
    v_mul_f32 v180, 0x3fb8aa3b, v180
    global_load_dwordx4 a[160:163], v2, s[4:5] offset:-4096
    v_mul_f32_e64 v182, -v182, v180
    v_pk_fma_f32 v[16:17], v[80:81], v[180:181], v[182:183] op_sel_hi:[1,0,0]
    v_pk_fma_f32 v[18:19], v[82:83], v[180:181], v[182:183] op_sel_hi:[1,0,0]
    v_pk_fma_f32 v[20:21], v[84:85], v[180:181], v[182:183] op_sel_hi:[1,0,0]
    v_pk_fma_f32 v[22:23], v[86:87], v[180:181], v[182:183] op_sel_hi:[1,0,0]
    v_pk_fma_f32 v[24:25], v[88:89], v[180:181], v[182:183] op_sel_hi:[1,0,0]
    v_pk_fma_f32 v[26:27], v[90:91], v[180:181], v[182:183] op_sel_hi:[1,0,0]
    v_pk_fma_f32 v[28:29], v[92:93], v[180:181], v[182:183] op_sel_hi:[1,0,0]
    v_pk_fma_f32 v[30:31], v[94:95], v[180:181], v[182:183] op_sel_hi:[1,0,0]
    v_pk_fma_f32 v[32:33], v[96:97], v[180:181], v[182:183] op_sel_hi:[1,0,0]
    v_pk_fma_f32 v[34:35], v[98:99], v[180:181], v[182:183] op_sel_hi:[1,0,0]
    v_pk_fma_f32 v[36:37], v[100:101], v[180:181], v[182:183] op_sel_hi:[1,0,0]
    v_pk_fma_f32 v[38:39], v[102:103], v[180:181], v[182:183] op_sel_hi:[1,0,0]
    v_pk_fma_f32 v[40:41], v[104:105], v[180:181], v[182:183] op_sel_hi:[1,0,0]
    v_pk_fma_f32 v[42:43], v[106:107], v[180:181], v[182:183] op_sel_hi:[1,0,0]
    v_pk_fma_f32 v[44:45], v[108:109], v[180:181], v[182:183] op_sel_hi:[1,0,0]
    global_load_dwordx4 a[164:167], v2, s[4:5] offset:-3072
    v_pk_fma_f32 v[46:47], v[110:111], v[180:181], v[182:183] op_sel_hi:[1,0,0]
    v_cvt_pk_bf16_f32 v144, v16, v17
    v_cvt_pk_bf16_f32 v145, v18, v19
    v_cvt_pk_bf16_f32 v146, v20, v21
    v_cvt_pk_bf16_f32 v147, v22, v23
    s_cbranch_vccz post_kernel_xs1
    global_store_dwordx4 v4, v[144:147], s[6:7] offset:0
post_kernel_xj1:
    ds_write_b128 v10, v[144:147] offset:0
    v_cvt_pk_bf16_f32 v148, v24, v25
    v_cvt_pk_bf16_f32 v149, v26, v27
    v_cvt_pk_bf16_f32 v150, v28, v29
    v_cvt_pk_bf16_f32 v151, v30, v31
    s_cbranch_vccz post_kernel_xs2
    global_store_dwordx4 v4, v[148:151], s[6:7] offset:1024
post_kernel_xj2:
    ds_write_b128 v10, v[148:151] offset:1024
    v_cvt_pk_bf16_f32 v152, v32, v33
    v_cvt_pk_bf16_f32 v153, v34, v35
    v_cvt_pk_bf16_f32 v154, v36, v37
    v_cvt_pk_bf16_f32 v155, v38, v39
    s_cbranch_vccz post_kernel_xs3
    global_store_dwordx4 v4, v[152:155], s[6:7] offset:2048
post_kernel_xj3:
    ds_write_b128 v10, v[152:155] offset:2048
    v_cvt_pk_bf16_f32 v156, v40, v41
    v_cvt_pk_bf16_f32 v157, v42, v43
    v_cvt_pk_bf16_f32 v158, v44, v45
    v_cvt_pk_bf16_f32 v159, v46, v47
    s_cbranch_vccz post_kernel_xs4
    global_store_dwordx4 v4, v[156:159], s[6:7] offset:3072
post_kernel_xj4:
    ds_write_b128 v10, v[156:159] offset:3072
    s_waitcnt lgkmcnt(0)
    s_barrier
    ds_read_b128 a[0:3], v9 offset:0
    ds_read_b128 a[4:7], v9 offset:1024
    ds_read_b128 a[8:11], v9 offset:2048
    ds_read_b128 a[12:15], v9 offset:3072
    s_waitcnt lgkmcnt(3)
    v_mfma_f32_32x32x16_bf16 v[16:31], a[200:203], a[0:3], 0
    ds_read_b128 a[16:19], v9 offset:4096
    global_load_dwordx4 a[168:171], v2, s[4:5] offset:-2048
    v_mfma_f32_32x32x16_bf16 v[32:47], a[204:207], a[0:3], 0
    ds_read_b128 a[20:23], v9 offset:5120
    global_load_dwordx4 a[172:175], v2, s[4:5] offset:-1024
    s_waitcnt lgkmcnt(4)
    s_waitcnt vmcnt(24)
    v_mfma_f32_32x32x16_bf16 v[16:31], a[208:211], a[4:7], v[16:31]
    ds_read_b128 a[24:27], v9 offset:6144
    s_waitcnt vmcnt(2)
    s_cbranch_vccz post_kernel_xs5
    global_store_dwordx2 v14, v[252:253], s[4:5] offset:256
post_kernel_xj5:
    v_mfma_f32_32x32x16_bf16 v[32:47], a[212:215], a[4:7], v[32:47]
    ds_read_b128 a[28:31], v9 offset:7168
    global_load_dwordx4 a[176:179], v2, s[4:5] offset:0
    v_add_f32 v196, v80, v80
    v_add_f32 v197, v81, v81
    v_add_f32 v198, v82, v82
    s_waitcnt lgkmcnt(5)
    v_mfma_f32_32x32x16_bf16 v[16:31], a[216:219], a[8:11], v[16:31]
    ds_read_b128 a[32:35], v9 offset:8192
    v_add_f32 v199, v83, v83
    v_add_f32 v200, v84, v84
    v_add_f32 v201, v85, v85
    v_mfma_f32_32x32x16_bf16 v[32:47], a[220:223], a[8:11], v[32:47]
    ds_read_b128 a[36:39], v9 offset:9216
    global_load_dwordx4 a[180:183], v2, s[4:5] offset:1024
    v_add_f32 v202, v86, v86
    v_add_f32 v203, v87, v87
    v_add_f32 v204, v88, v88
    s_waitcnt lgkmcnt(6)
    v_mfma_f32_32x32x16_bf16 v[16:31], a[224:227], a[12:15], v[16:31]
    ds_read_b128 a[40:43], v9 offset:10240
    v_add_f32 v205, v89, v89
    v_add_f32 v206, v90, v90
    v_add_f32 v207, v91, v91
    v_mfma_f32_32x32x16_bf16 v[32:47], a[228:231], a[12:15], v[32:47]
    ds_read_b128 a[44:47], v9 offset:11264
    global_load_dwordx4 a[184:187], v2, s[4:5] offset:2048
    v_add_f32 v208, v92, v92
    v_add_f32 v209, v93, v93
    v_add_f32 v210, v94, v94
    s_waitcnt lgkmcnt(7)
    v_mfma_f32_32x32x16_bf16 v[16:31], a[232:235], a[16:19], v[16:31]
    ds_read_b128 a[48:51], v9 offset:12288
    v_add_f32 v211, v95, v95
    v_add_f32 v212, v96, v96
    v_add_f32 v213, v97, v97
    v_mfma_f32_32x32x16_bf16 v[32:47], a[236:239], a[16:19], v[32:47]
    ds_read_b128 a[52:55], v9 offset:13312
    global_load_dwordx4 a[188:191], v2, s[4:5] offset:3072
    v_add_u32 v2, 8192, v2
    v_add_f32 v214, v98, v98
    v_add_f32 v215, v99, v99
    v_add_f32 v216, v100, v100
    s_waitcnt lgkmcnt(8)
    v_mfma_f32_32x32x16_bf16 v[16:31], a[240:243], a[20:23], v[16:31]
    ds_read_b128 a[56:59], v9 offset:14336
    v_add_f32 v217, v101, v101
    v_add_f32 v218, v102, v102
    v_add_f32 v219, v103, v103
    v_mfma_f32_32x32x16_bf16 v[32:47], a[244:247], a[20:23], v[32:47]
    ds_read_b128 a[60:63], v9 offset:15360
    global_load_dwordx4 a[192:195], v2, s[4:5] offset:-4096
    v_add_f32 v220, v104, v104
    v_add_f32 v221, v105, v105
    v_add_f32 v222, v106, v106
    global_load_dwordx2 v[254:255], v13, s[4:5] offset:256 sc1
    s_waitcnt lgkmcnt(9)
    v_mfma_f32_32x32x16_bf16 v[16:31], a[248:251], a[24:27], v[16:31]
    v_add_f32 v223, v107, v107
    v_add_f32 v224, v108, v108
    v_add_f32 v225, v109, v109
    v_mfma_f32_32x32x16_bf16 v[32:47], a[252:255], a[24:27], v[32:47]
    global_load_dwordx4 a[196:199], v2, s[4:5] offset:-3072
    v_add_f32 v226, v110, v110
    v_add_f32 v227, v111, v111
    v_and_b32 v7, 31, v0
    s_waitcnt lgkmcnt(8)
    v_mfma_f32_32x32x16_bf16 v[16:31], a[128:131], a[28:31], v[16:31]
    v_xor_b32 v7, 16, v7
    v_mul_u32_u24 v7, 528, v7
    v_bfe_u32 v8, v0, 5, 1
    v_mfma_f32_32x32x16_bf16 v[32:47], a[132:135], a[28:31], v[32:47]
    v_lshl_add_u32 v11, v8, 4, v7
    s_lshl_b32 s27, s20, 7
    s_add_u32 s27, s27, 94208
    s_waitcnt lgkmcnt(7)
    v_mfma_f32_32x32x16_bf16 v[16:31], a[136:139], a[32:35], v[16:31]
    v_add_u32 v11, s27, v11
    v_mul_u32_u24 v8, 528, v8
    v_and_b32 v7, 31, v0
    v_mfma_f32_32x32x16_bf16 v[32:47], a[140:143], a[32:35], v[32:47]
    v_lshl_add_u32 v8, v7, 4, v8
    s_mul_i32 s27, s20, 4224
    s_add_u32 s27, s27, 94208
    s_waitcnt lgkmcnt(6)
    v_mfma_f32_32x32x16_bf16 v[16:31], a[144:147], a[36:39], v[16:31]
    v_add_u32 v8, s27, v8
    s_lshl_b32 s24, s21, 14
    s_lshl_b32 s25, s20, 12
    v_mfma_f32_32x32x16_bf16 v[32:47], a[148:151], a[36:39], v[32:47]
    s_add_u32 s24, s24, s25
    v_mov_b32 v188, 0x3f80
    v_mov_b32 v189, 0x3f800000
    s_waitcnt lgkmcnt(5)
    v_mfma_f32_32x32x16_bf16 v[16:31], a[152:155], a[40:43], v[16:31]
    v_mfma_f32_32x32x16_bf16 v[32:47], a[156:159], a[40:43], v[32:47]
    s_waitcnt lgkmcnt(4)
    v_mfma_f32_32x32x16_bf16 v[16:31], a[160:163], a[44:47], v[16:31]
    s_waitcnt vmcnt(1)
    s_mov_b32 s34, 400000
post_kernel_p1:
    v_readfirstlane_b32 s42, v254
    v_readfirstlane_b32 s43, v255
    s_sub_u32 s34, s34, 1
    s_cselect_b64 s[42:43], s[100:101], s[42:43]
    s_cmp_lg_u64 s[42:43], s[100:101]
    s_cbranch_scc1 post_kernel_p1c
    s_add_u32 m0, s57, 110592
    s_nop 0
    global_load_lds_dwordx4 v15, s[6:7] offset:0 sc1
    global_load_lds_dwordx4 v15, s[6:7] offset:1024 sc1
    global_load_lds_dwordx4 v15, s[6:7] offset:2048 sc1
    global_load_lds_dwordx4 v15, s[6:7] offset:3072 sc1
    v_mfma_f32_32x32x16_bf16 v[32:47], a[164:167], a[44:47], v[32:47]
    s_waitcnt lgkmcnt(3)
    v_mfma_f32_32x32x16_bf16 v[16:31], a[168:171], a[48:51], v[16:31]
    v_mfma_f32_32x32x16_bf16 v[32:47], a[172:175], a[48:51], v[32:47]
    s_waitcnt lgkmcnt(2)
    v_mfma_f32_32x32x16_bf16 v[16:31], a[176:179], a[52:55], v[16:31]
    v_mfma_f32_32x32x16_bf16 v[32:47], a[180:183], a[52:55], v[32:47]
    s_waitcnt lgkmcnt(1)
    v_mfma_f32_32x32x16_bf16 v[16:31], a[184:187], a[56:59], v[16:31]
    v_mfma_f32_32x32x16_bf16 v[32:47], a[188:191], a[56:59], v[32:47]
    s_waitcnt lgkmcnt(0)
    v_mfma_f32_32x32x16_bf16 v[16:31], a[192:195], a[60:63], v[16:31]
    s_waitcnt vmcnt(4)
    v_mfma_f32_32x32x16_bf16 v[32:47], a[196:199], a[60:63], v[32:47]
    s_waitcnt vmcnt(0)
    s_waitcnt lgkmcnt(0)
    s_barrier
    ds_read_b128 a[64:67], v9 offset:16384
    ds_read_b128 a[68:71], v9 offset:17408
    ds_read_b128 a[72:75], v9 offset:18432
    ds_read_b128 a[76:79], v9 offset:19456
    s_waitcnt lgkmcnt(3)
    v_mfma_f32_32x32x16_bf16 v[48:63], a[200:203], a[64:67], 0
    ds_read_b128 a[80:83], v9 offset:20480
    global_load_dwordx4 a[200:203], v2, s[4:5] offset:-2048
    v_mfma_f32_32x32x16_bf16 v[64:79], a[204:207], a[64:67], 0
    ds_read_b128 a[84:87], v9 offset:21504
    global_load_dwordx4 a[204:207], v2, s[4:5] offset:-1024
    s_waitcnt lgkmcnt(4)
    v_mfma_f32_32x32x16_bf16 v[48:63], a[208:211], a[68:71], v[48:63]
    ds_read_b128 a[88:91], v9 offset:22528
    v_exp_f32 v144, -v16
    v_exp_f32 v145, -v17
    v_add_f32 v144, 1.0, v144
    v_add_f32 v145, 1.0, v145
    v_rcp_f32 v144, v144
    v_rcp_f32 v145, v145
    v_mul_f32 v144, v16, v144
    v_mul_f32 v145, v17, v145
    v_cvt_pk_bf16_f32 v148, v144, v145
    v_exp_f32 v146, -v18
    v_mfma_f32_32x32x16_bf16 v[64:79], a[212:215], a[68:71], v[64:79]
    ds_read_b128 a[92:95], v9 offset:23552
    global_load_dwordx4 a[208:211], v2, s[4:5] offset:0
    v_exp_f32 v147, -v19
    v_add_f32 v146, 1.0, v146
    v_add_f32 v147, 1.0, v147
    v_rcp_f32 v146, v146
    s_waitcnt lgkmcnt(5)
    v_mfma_f32_32x32x16_bf16 v[48:63], a[216:219], a[72:75], v[48:63]
    ds_read_b128 a[96:99], v9 offset:24576
    global_load_dwordx4 a[212:215], v2, s[4:5] offset:1024
    v_rcp_f32 v147, v147
    v_mul_f32 v146, v18, v146
    v_mul_f32 v147, v19, v147
    v_mfma_f32_32x32x16_bf16 v[64:79], a[220:223], a[72:75], v[64:79]
    ds_read_b128 a[100:103], v9 offset:25600
    v_cvt_pk_bf16_f32 v149, v146, v147
    v_exp_f32 v144, -v20
    v_exp_f32 v145, -v21
    s_waitcnt lgkmcnt(6)
    v_mfma_f32_32x32x16_bf16 v[48:63], a[224:227], a[76:79], v[48:63]
    ds_read_b128 a[104:107], v9 offset:26624
    global_load_dwordx4 a[216:219], v2, s[4:5] offset:2048
    v_add_f32 v144, 1.0, v144
    v_add_f32 v145, 1.0, v145
    v_rcp_f32 v144, v144
    v_rcp_f32 v145, v145
    v_mfma_f32_32x32x16_bf16 v[64:79], a[228:231], a[76:79], v[64:79]
    ds_read_b128 a[108:111], v9 offset:27648
    global_load_dwordx4 a[220:223], v2, s[4:5] offset:3072
    v_add_u32 v2, 8192, v2
    v_mul_f32 v144, v20, v144
    v_mul_f32 v145, v21, v145
    v_cvt_pk_bf16_f32 v150, v144, v145
    s_waitcnt lgkmcnt(7)
    v_mfma_f32_32x32x16_bf16 v[48:63], a[232:235], a[80:83], v[48:63]
    ds_read_b128 a[112:115], v9 offset:28672
    v_exp_f32 v146, -v22
    v_exp_f32 v147, -v23
    v_add_f32 v146, 1.0, v146
    v_mfma_f32_32x32x16_bf16 v[64:79], a[236:239], a[80:83], v[64:79]
    ds_read_b128 a[116:119], v9 offset:29696
    global_load_dwordx4 a[224:227], v2, s[4:5] offset:-4096
    v_add_f32 v147, 1.0, v147
    v_rcp_f32 v146, v146
    v_rcp_f32 v147, v147
    s_waitcnt lgkmcnt(8)
    v_mfma_f32_32x32x16_bf16 v[48:63], a[240:243], a[84:87], v[48:63]
    ds_read_b128 a[120:123], v9 offset:30720
    v_mul_f32 v146, v22, v146
    v_mul_f32 v147, v23, v147
    v_cvt_pk_bf16_f32 v151, v146, v147
    ds_write_b128 v3, v[148:151] offset:0
    v_mfma_f32_32x32x16_bf16 v[64:79], a[244:247], a[84:87], v[64:79]
    ds_read_b128 a[124:127], v9 offset:31744
    global_load_dwordx4 a[228:231], v2, s[4:5] offset:-3072
    v_exp_f32 v144, -v24
    v_exp_f32 v145, -v25
    v_add_f32 v144, 1.0, v144
    s_waitcnt lgkmcnt(10)
    v_mfma_f32_32x32x16_bf16 v[48:63], a[248:251], a[88:91], v[48:63]
    v_add_f32 v145, 1.0, v145
    v_rcp_f32 v144, v144
    v_rcp_f32 v145, v145
    v_mfma_f32_32x32x16_bf16 v[64:79], a[252:255], a[88:91], v[64:79]
    global_load_dwordx4 a[232:235], v2, s[4:5] offset:-2048
    v_mul_f32 v144, v24, v144
    v_mul_f32 v145, v25, v145
    v_cvt_pk_bf16_f32 v152, v144, v145
    v_exp_f32 v146, -v26
    s_waitcnt lgkmcnt(9)
    v_mfma_f32_32x32x16_bf16 v[48:63], a[128:131], a[92:95], v[48:63]
    v_exp_f32 v147, -v27
    v_add_f32 v146, 1.0, v146
    v_add_f32 v147, 1.0, v147
    v_mfma_f32_32x32x16_bf16 v[64:79], a[132:135], a[92:95], v[64:79]
    global_load_dwordx4 a[236:239], v2, s[4:5] offset:-1024
    v_rcp_f32 v146, v146
    v_rcp_f32 v147, v147
    v_mul_f32 v146, v26, v146
    s_waitcnt lgkmcnt(8)
    v_mfma_f32_32x32x16_bf16 v[48:63], a[136:139], a[96:99], v[48:63]
    v_mul_f32 v147, v27, v147
    v_cvt_pk_bf16_f32 v153, v146, v147
    v_exp_f32 v144, -v28
    v_mfma_f32_32x32x16_bf16 v[64:79], a[140:143], a[96:99], v[64:79]
    global_load_dwordx4 a[240:243], v2, s[4:5] offset:0
    v_exp_f32 v145, -v29
    v_add_f32 v144, 1.0, v144
    v_add_f32 v145, 1.0, v145
    v_rcp_f32 v144, v144
    s_waitcnt lgkmcnt(7)
    v_mfma_f32_32x32x16_bf16 v[48:63], a[144:147], a[100:103], v[48:63]
    v_rcp_f32 v145, v145
    v_mul_f32 v144, v28, v144
    v_mul_f32 v145, v29, v145
    v_mfma_f32_32x32x16_bf16 v[64:79], a[148:151], a[100:103], v[64:79]
    global_load_dwordx4 a[244:247], v2, s[4:5] offset:1024
    v_cvt_pk_bf16_f32 v154, v144, v145
    v_exp_f32 v146, -v30
    v_exp_f32 v147, -v31
    s_waitcnt lgkmcnt(6)
    v_mfma_f32_32x32x16_bf16 v[48:63], a[152:155], a[104:107], v[48:63]
    v_add_f32 v146, 1.0, v146
    v_add_f32 v147, 1.0, v147
    v_rcp_f32 v146, v146
    v_rcp_f32 v147, v147
    v_mfma_f32_32x32x16_bf16 v[64:79], a[156:159], a[104:107], v[64:79]
    global_load_dwordx4 a[248:251], v2, s[4:5] offset:2048
    v_mul_f32 v146, v30, v146
    v_mul_f32 v147, v31, v147
    v_cvt_pk_bf16_f32 v155, v146, v147
    s_waitcnt lgkmcnt(5)
    v_mfma_f32_32x32x16_bf16 v[48:63], a[160:163], a[108:111], v[48:63]
    ds_write_b128 v3, v[152:155] offset:2048
    v_exp_f32 v144, -v32
    v_exp_f32 v145, -v33
    v_mfma_f32_32x32x16_bf16 v[64:79], a[164:167], a[108:111], v[64:79]
    global_load_dwordx4 a[252:255], v2, s[4:5] offset:3072
    v_add_u32 v2, 8192, v2
    v_add_f32 v144, 1.0, v144
    v_add_f32 v145, 1.0, v145
    v_rcp_f32 v144, v144
    s_waitcnt lgkmcnt(5)
    v_mfma_f32_32x32x16_bf16 v[48:63], a[168:171], a[112:115], v[48:63]
    v_rcp_f32 v145, v145
    v_mul_f32 v144, v32, v144
    v_mul_f32 v145, v33, v145
    v_cvt_pk_bf16_f32 v148, v144, v145
    v_mfma_f32_32x32x16_bf16 v[64:79], a[172:175], a[112:115], v[64:79]
    global_load_dwordx4 a[128:131], v2, s[4:5] offset:-4096
    v_exp_f32 v146, -v34
    v_exp_f32 v147, -v35
    v_add_f32 v146, 1.0, v146
    s_waitcnt lgkmcnt(4)
    v_mfma_f32_32x32x16_bf16 v[48:63], a[176:179], a[116:119], v[48:63]
    v_add_f32 v147, 1.0, v147
    v_rcp_f32 v146, v146
    v_rcp_f32 v147, v147
    v_mfma_f32_32x32x16_bf16 v[64:79], a[180:183], a[116:119], v[64:79]
    global_load_dwordx4 a[132:135], v2, s[4:5] offset:-3072
    v_mul_f32 v146, v34, v146
    v_mul_f32 v147, v35, v147
    v_cvt_pk_bf16_f32 v149, v146, v147
    v_exp_f32 v144, -v36
    s_waitcnt lgkmcnt(3)
    v_mfma_f32_32x32x16_bf16 v[48:63], a[184:187], a[120:123], v[48:63]
    v_exp_f32 v145, -v37
    v_add_f32 v144, 1.0, v144
    v_add_f32 v145, 1.0, v145
    v_mfma_f32_32x32x16_bf16 v[64:79], a[188:191], a[120:123], v[64:79]
    global_load_dwordx4 a[136:139], v2, s[4:5] offset:-2048
    v_rcp_f32 v144, v144
    v_rcp_f32 v145, v145
    v_mul_f32 v144, v36, v144
    s_waitcnt lgkmcnt(1)
    v_mfma_f32_32x32x16_bf16 v[48:63], a[192:195], a[124:127], v[48:63]
    v_mul_f32 v145, v37, v145
    v_cvt_pk_bf16_f32 v150, v144, v145
    v_exp_f32 v146, -v38
    v_mfma_f32_32x32x16_bf16 v[64:79], a[196:199], a[124:127], v[64:79]
    global_load_dwordx4 a[140:143], v2, s[4:5] offset:-1024
    v_exp_f32 v147, -v39
    v_add_f32 v146, 1.0, v146
    v_add_f32 v147, 1.0, v147
    v_rcp_f32 v146, v146
    s_waitcnt vmcnt(16)
    v_mfma_f32_32x32x16_bf16 v[80:95], a[200:203], a[0:3], 0
    v_rcp_f32 v147, v147
    v_mul_f32 v146, v38, v146
    v_mul_f32 v147, v39, v147
    v_mfma_f32_32x32x16_bf16 v[112:127], a[200:203], a[64:67], 0
    global_load_dwordx4 a[144:147], v2, s[4:5] offset:0
    v_cvt_pk_bf16_f32 v151, v146, v147
    ds_write_b128 v3, v[148:151] offset:4096
    v_exp_f32 v144, -v40
    v_mfma_f32_32x32x16_bf16 v[96:111], a[204:207], a[0:3], 0
    v_exp_f32 v145, -v41
    v_add_f32 v144, 1.0, v144
    v_add_f32 v145, 1.0, v145
    v_rcp_f32 v144, v144
    v_mfma_f32_32x32x16_bf16 v[128:143], a[204:207], a[64:67], 0
    global_load_dwordx4 a[148:151], v2, s[4:5] offset:1024
    v_rcp_f32 v145, v145
    v_mul_f32 v144, v40, v144
    v_mul_f32 v145, v41, v145
    s_waitcnt vmcnt(14)
    v_mfma_f32_32x32x16_bf16 v[80:95], a[208:211], a[4:7], v[80:95]
    v_cvt_pk_bf16_f32 v152, v144, v145
    v_exp_f32 v146, -v42
    v_exp_f32 v147, -v43
    v_mfma_f32_32x32x16_bf16 v[112:127], a[208:211], a[68:71], v[112:127]
    global_load_dwordx4 a[152:155], v2, s[4:5] offset:2048
    v_add_f32 v146, 1.0, v146
    v_add_f32 v147, 1.0, v147
    v_rcp_f32 v146, v146
    v_mfma_f32_32x32x16_bf16 v[96:111], a[212:215], a[4:7], v[96:111]
    v_rcp_f32 v147, v147
    v_mul_f32 v146, v42, v146
    v_mul_f32 v147, v43, v147
    v_cvt_pk_bf16_f32 v153, v146, v147
    v_mfma_f32_32x32x16_bf16 v[128:143], a[212:215], a[68:71], v[128:143]
    global_load_dwordx4 a[156:159], v2, s[4:5] offset:3072
    v_add_u32 v2, 8192, v2
    v_exp_f32 v144, -v44
    v_exp_f32 v145, -v45
    v_add_f32 v144, 1.0, v144
    v_mfma_f32_32x32x16_bf16 v[80:95], a[216:219], a[8:11], v[80:95]
    v_add_f32 v145, 1.0, v145
    v_rcp_f32 v144, v144
    v_rcp_f32 v145, v145
    v_mfma_f32_32x32x16_bf16 v[112:127], a[216:219], a[72:75], v[112:127]
    global_load_dwordx4 a[160:163], v2, s[4:5] offset:-4096
    v_mul_f32 v144, v44, v144
    v_mul_f32 v145, v45, v145
    v_cvt_pk_bf16_f32 v154, v144, v145
    v_exp_f32 v146, -v46
    v_mfma_f32_32x32x16_bf16 v[96:111], a[220:223], a[8:11], v[96:111]
    v_exp_f32 v147, -v47
    v_add_f32 v146, 1.0, v146
    v_add_f32 v147, 1.0, v147
    v_mfma_f32_32x32x16_bf16 v[128:143], a[220:223], a[72:75], v[128:143]
    global_load_dwordx4 a[164:167], v2, s[4:5] offset:-3072
    v_rcp_f32 v146, v146
    v_rcp_f32 v147, v147
    v_mul_f32 v146, v46, v146
    s_waitcnt vmcnt(14)
    v_mfma_f32_32x32x16_bf16 v[80:95], a[224:227], a[12:15], v[80:95]
    v_mul_f32 v147, v47, v147
    v_cvt_pk_bf16_f32 v155, v146, v147
    ds_write_b128 v3, v[152:155] offset:6144
    v_mfma_f32_32x32x16_bf16 v[112:127], a[224:227], a[76:79], v[112:127]
    global_load_dwordx4 a[168:171], v2, s[4:5] offset:-2048
    v_exp_f32 v144, -v48
    v_exp_f32 v145, -v49
    v_add_f32 v144, 1.0, v144
    v_add_f32 v145, 1.0, v145
    v_mfma_f32_32x32x16_bf16 v[96:111], a[228:231], a[12:15], v[96:111]
    v_rcp_f32 v144, v144
    v_rcp_f32 v145, v145
    v_mul_f32 v144, v48, v144
    v_mfma_f32_32x32x16_bf16 v[128:143], a[228:231], a[76:79], v[128:143]
    global_load_dwordx4 a[172:175], v2, s[4:5] offset:-1024
    v_mul_f32 v145, v49, v145
    v_cvt_pk_bf16_f32 v148, v144, v145
    v_exp_f32 v146, -v50
    v_mfma_f32_32x32x16_bf16 v[80:95], a[232:235], a[16:19], v[80:95]
    v_exp_f32 v147, -v51
    v_add_f32 v146, 1.0, v146
    v_add_f32 v147, 1.0, v147
    v_rcp_f32 v146, v146
    v_mfma_f32_32x32x16_bf16 v[112:127], a[232:235], a[80:83], v[112:127]
    global_load_dwordx4 a[176:179], v2, s[4:5] offset:0
    v_rcp_f32 v147, v147
    v_mul_f32 v146, v50, v146
    v_mul_f32 v147, v51, v147
    v_mfma_f32_32x32x16_bf16 v[96:111], a[236:239], a[16:19], v[96:111]
    v_cvt_pk_bf16_f32 v149, v146, v147
    v_exp_f32 v144, -v52
    v_exp_f32 v145, -v53
    v_mfma_f32_32x32x16_bf16 v[128:143], a[236:239], a[80:83], v[128:143]
    global_load_dwordx4 a[180:183], v2, s[4:5] offset:1024
    v_add_f32 v144, 1.0, v144
    v_add_f32 v145, 1.0, v145
    v_rcp_f32 v144, v144
    v_rcp_f32 v145, v145
    s_waitcnt vmcnt(14)
    v_mfma_f32_32x32x16_bf16 v[80:95], a[240:243], a[20:23], v[80:95]
    v_mul_f32 v144, v52, v144
    v_mul_f32 v145, v53, v145
    v_cvt_pk_bf16_f32 v150, v144, v145
    v_mfma_f32_32x32x16_bf16 v[112:127], a[240:243], a[84:87], v[112:127]
    global_load_dwordx4 a[184:187], v2, s[4:5] offset:2048
    v_exp_f32 v146, -v54
    v_exp_f32 v147, -v55
    v_add_f32 v146, 1.0, v146
    v_mfma_f32_32x32x16_bf16 v[96:111], a[244:247], a[20:23], v[96:111]
    v_add_f32 v147, 1.0, v147
    v_rcp_f32 v146, v146
    v_rcp_f32 v147, v147
    v_mfma_f32_32x32x16_bf16 v[128:143], a[244:247], a[84:87], v[128:143]
    global_load_dwordx4 a[188:191], v2, s[4:5] offset:3072
    v_add_u32 v2, 8192, v2
    v_mul_f32 v146, v54, v146
    v_mul_f32 v147, v55, v147
    v_cvt_pk_bf16_f32 v151, v146, v147
    ds_write_b128 v3, v[148:151] offset:1024
    v_mfma_f32_32x32x16_bf16 v[80:95], a[248:251], a[24:27], v[80:95]
    v_exp_f32 v144, -v56
    v_exp_f32 v145, -v57
    v_add_f32 v144, 1.0, v144
    v_mfma_f32_32x32x16_bf16 v[112:127], a[248:251], a[88:91], v[112:127]
    global_load_dwordx4 a[192:195], v2, s[4:5] offset:-4096
    v_add_f32 v145, 1.0, v145
    v_rcp_f32 v144, v144
    v_rcp_f32 v145, v145
    v_mfma_f32_32x32x16_bf16 v[96:111], a[252:255], a[24:27], v[96:111]
    v_mul_f32 v144, v56, v144
    v_mul_f32 v145, v57, v145
    v_cvt_pk_bf16_f32 v152, v144, v145
    v_exp_f32 v146, -v58
    v_mfma_f32_32x32x16_bf16 v[128:143], a[252:255], a[88:91], v[128:143]
    global_load_dwordx4 a[196:199], v2, s[4:5] offset:-3072
    v_exp_f32 v147, -v59
    v_add_f32 v146, 1.0, v146
    v_add_f32 v147, 1.0, v147
    s_waitcnt vmcnt(14)
    v_mfma_f32_32x32x16_bf16 v[80:95], a[128:131], a[28:31], v[80:95]
    v_rcp_f32 v146, v146
    v_rcp_f32 v147, v147
    v_mul_f32 v146, v58, v146
    v_mfma_f32_32x32x16_bf16 v[112:127], a[128:131], a[92:95], v[112:127]
    v_mul_f32 v147, v59, v147
    v_cvt_pk_bf16_f32 v153, v146, v147
    v_exp_f32 v144, -v60
    v_mfma_f32_32x32x16_bf16 v[96:111], a[132:135], a[28:31], v[96:111]
    global_load_dwordx4 a[200:203], v2, s[4:5] offset:-2048
    v_exp_f32 v145, -v61
    v_add_f32 v144, 1.0, v144
    v_add_f32 v145, 1.0, v145
    v_rcp_f32 v144, v144
    v_mfma_f32_32x32x16_bf16 v[128:143], a[132:135], a[92:95], v[128:143]
    v_rcp_f32 v145, v145
    v_mul_f32 v144, v60, v144
    v_mul_f32 v145, v61, v145
    v_mfma_f32_32x32x16_bf16 v[80:95], a[136:139], a[32:35], v[80:95]
    global_load_dwordx4 a[204:207], v2, s[4:5] offset:-1024
    v_cvt_pk_bf16_f32 v154, v144, v145
    v_exp_f32 v146, -v62
    v_exp_f32 v147, -v63
    v_mfma_f32_32x32x16_bf16 v[112:127], a[136:139], a[96:99], v[112:127]
    v_add_f32 v146, 1.0, v146
    v_add_f32 v147, 1.0, v147
    v_rcp_f32 v146, v146
    v_rcp_f32 v147, v147
    v_mfma_f32_32x32x16_bf16 v[96:111], a[140:143], a[32:35], v[96:111]
    global_load_dwordx4 a[208:211], v2, s[4:5] offset:0
    v_mul_f32 v146, v62, v146
    v_mul_f32 v147, v63, v147
    v_cvt_pk_bf16_f32 v155, v146, v147
    v_mfma_f32_32x32x16_bf16 v[128:143], a[140:143], a[96:99], v[128:143]
    ds_write_b128 v3, v[152:155] offset:3072
    v_exp_f32 v144, -v64
    v_exp_f32 v145, -v65
    s_waitcnt vmcnt(13)
    v_mfma_f32_32x32x16_bf16 v[80:95], a[144:147], a[36:39], v[80:95]
    global_load_dwordx4 a[212:215], v2, s[4:5] offset:1024
    v_add_f32 v144, 1.0, v144
    v_add_f32 v145, 1.0, v145
    v_rcp_f32 v144, v144
    v_mfma_f32_32x32x16_bf16 v[112:127], a[144:147], a[100:103], v[112:127]
    v_rcp_f32 v145, v145
    v_mul_f32 v144, v64, v144
    v_mul_f32 v145, v65, v145
    v_cvt_pk_bf16_f32 v148, v144, v145
    v_mfma_f32_32x32x16_bf16 v[96:111], a[148:151], a[36:39], v[96:111]
    global_load_dwordx4 a[216:219], v2, s[4:5] offset:2048
    v_exp_f32 v146, -v66
    v_exp_f32 v147, -v67
    v_add_f32 v146, 1.0, v146
    v_mfma_f32_32x32x16_bf16 v[128:143], a[148:151], a[100:103], v[128:143]
    v_add_f32 v147, 1.0, v147
    v_rcp_f32 v146, v146
    v_rcp_f32 v147, v147
    v_mfma_f32_32x32x16_bf16 v[80:95], a[152:155], a[40:43], v[80:95]
    global_load_dwordx4 a[220:223], v2, s[4:5] offset:3072
    v_add_u32 v2, 8192, v2
    v_mul_f32 v146, v66, v146
    v_mul_f32 v147, v67, v147
    v_cvt_pk_bf16_f32 v149, v146, v147
    v_exp_f32 v144, -v68
    v_mfma_f32_32x32x16_bf16 v[112:127], a[152:155], a[104:107], v[112:127]
    v_exp_f32 v145, -v69
    v_add_f32 v144, 1.0, v144
    v_add_f32 v145, 1.0, v145
    v_mfma_f32_32x32x16_bf16 v[96:111], a[156:159], a[40:43], v[96:111]
    global_load_dwordx4 a[224:227], v2, s[4:5] offset:-4096
    v_rcp_f32 v144, v144
    v_rcp_f32 v145, v145
    v_mul_f32 v144, v68, v144
    v_mfma_f32_32x32x16_bf16 v[128:143], a[156:159], a[104:107], v[128:143]
    v_mul_f32 v145, v69, v145
    v_cvt_pk_bf16_f32 v150, v144, v145
    v_exp_f32 v146, -v70
    s_waitcnt vmcnt(13)
    v_mfma_f32_32x32x16_bf16 v[80:95], a[160:163], a[44:47], v[80:95]
    global_load_dwordx4 a[228:231], v2, s[4:5] offset:-3072
    v_exp_f32 v147, -v71
    v_add_f32 v146, 1.0, v146
    v_add_f32 v147, 1.0, v147
    v_rcp_f32 v146, v146
    v_mfma_f32_32x32x16_bf16 v[112:127], a[160:163], a[108:111], v[112:127]
    v_rcp_f32 v147, v147
    v_mul_f32 v146, v70, v146
    v_mul_f32 v147, v71, v147
    v_mfma_f32_32x32x16_bf16 v[96:111], a[164:167], a[44:47], v[96:111]
    global_load_dwordx4 a[232:235], v2, s[4:5] offset:-2048
    v_cvt_pk_bf16_f32 v151, v146, v147
    ds_write_b128 v3, v[148:151] offset:5120
    v_exp_f32 v144, -v72
    v_mfma_f32_32x32x16_bf16 v[128:143], a[164:167], a[108:111], v[128:143]
    v_exp_f32 v145, -v73
    v_add_f32 v144, 1.0, v144
    v_add_f32 v145, 1.0, v145
    v_rcp_f32 v144, v144
    v_mfma_f32_32x32x16_bf16 v[80:95], a[168:171], a[48:51], v[80:95]
    global_load_dwordx4 a[236:239], v2, s[4:5] offset:-1024
    v_rcp_f32 v145, v145
    v_mul_f32 v144, v72, v144
    v_mul_f32 v145, v73, v145
    v_mfma_f32_32x32x16_bf16 v[112:127], a[168:171], a[112:115], v[112:127]
    v_cvt_pk_bf16_f32 v152, v144, v145
    v_exp_f32 v146, -v74
    v_exp_f32 v147, -v75
    v_mfma_f32_32x32x16_bf16 v[96:111], a[172:175], a[48:51], v[96:111]
    global_load_dwordx4 a[240:243], v2, s[4:5] offset:0
    v_add_f32 v146, 1.0, v146
    v_add_f32 v147, 1.0, v147
    v_rcp_f32 v146, v146
    v_mfma_f32_32x32x16_bf16 v[128:143], a[172:175], a[112:115], v[128:143]
    v_rcp_f32 v147, v147
    v_mul_f32 v146, v74, v146
    v_mul_f32 v147, v75, v147
    v_cvt_pk_bf16_f32 v153, v146, v147
    s_waitcnt vmcnt(13)
    v_mfma_f32_32x32x16_bf16 v[80:95], a[176:179], a[52:55], v[80:95]
    global_load_dwordx4 a[244:247], v2, s[4:5] offset:1024
    v_exp_f32 v144, -v76
    v_exp_f32 v145, -v77
    v_add_f32 v144, 1.0, v144
    v_mfma_f32_32x32x16_bf16 v[112:127], a[176:179], a[116:119], v[112:127]
    v_add_f32 v145, 1.0, v145
    v_rcp_f32 v144, v144
    v_rcp_f32 v145, v145
    v_mfma_f32_32x32x16_bf16 v[96:111], a[180:183], a[52:55], v[96:111]
    global_load_dwordx4 a[248:251], v2, s[4:5] offset:2048
    v_mul_f32 v144, v76, v144
    v_mul_f32 v145, v77, v145
    v_cvt_pk_bf16_f32 v154, v144, v145
    v_exp_f32 v146, -v78
    v_mfma_f32_32x32x16_bf16 v[128:143], a[180:183], a[116:119], v[128:143]
    v_exp_f32 v147, -v79
    v_add_f32 v146, 1.0, v146
    v_add_f32 v147, 1.0, v147
    v_mfma_f32_32x32x16_bf16 v[80:95], a[184:187], a[56:59], v[80:95]
    global_load_dwordx4 a[252:255], v2, s[4:5] offset:3072
    v_add_u32 v2, 8192, v2
    v_rcp_f32 v146, v146
    v_rcp_f32 v147, v147
    v_mul_f32 v146, v78, v146
    v_mfma_f32_32x32x16_bf16 v[112:127], a[184:187], a[120:123], v[112:127]
    v_mul_f32 v147, v79, v147
    v_cvt_pk_bf16_f32 v155, v146, v147
    ds_write_b128 v3, v[152:155] offset:7168
    v_mfma_f32_32x32x16_bf16 v[96:111], a[188:191], a[56:59], v[96:111]
    global_load_dwordx4 a[128:131], v2, s[4:5] offset:-4096
    s_waitcnt lgkmcnt(0)
    s_barrier
    v_mfma_f32_32x32x16_bf16 v[128:143], a[188:191], a[120:123], v[128:143]
    ds_read_b128 v[156:159], v1 offset:0
    global_load_dwordx4 a[132:135], v2, s[4:5] offset:-3072
    s_waitcnt vmcnt(14)
    v_mfma_f32_32x32x16_bf16 v[80:95], a[192:195], a[60:63], v[80:95]
    ds_read_b128 v[160:163], v1 offset:1024
    global_load_dwordx4 a[136:139], v2, s[4:5] offset:-2048
    v_mfma_f32_32x32x16_bf16 v[112:127], a[192:195], a[124:127], v[112:127]
    ds_read_b128 v[164:167], v1 offset:2048
    v_mfma_f32_32x32x16_bf16 v[96:111], a[196:199], a[60:63], v[96:111]
    ds_read_b128 v[168:171], v1 offset:3072
    global_load_dwordx4 a[140:143], v2, s[4:5] offset:-1024
    v_mfma_f32_32x32x16_bf16 v[128:143], a[196:199], a[124:127], v[128:143]
    s_waitcnt lgkmcnt(3)
    v_mfma_f32_32x32x16_bf16 v[16:31], a[200:203], v[156:159], v[196:211]
    global_load_dwordx4 a[144:147], v2, s[4:5] offset:0
    s_waitcnt lgkmcnt(2)
    v_mfma_f32_32x32x16_bf16 v[48:63], a[200:203], v[160:163], 0
    v_mfma_f32_32x32x16_bf16 v[32:47], a[204:207], v[156:159], v[212:227]
    ds_read_b128 v[172:175], v1 offset:4096
    global_load_dwordx4 a[148:151], v2, s[4:5] offset:1024
    v_exp_f32 v144, -v112
    v_exp_f32 v145, -v113
    v_add_f32 v144, 1.0, v144
    v_add_f32 v145, 1.0, v145
    v_rcp_f32 v144, v144
    v_rcp_f32 v145, v145
    v_mul_f32 v144, v112, v144
    v_mul_f32 v145, v113, v145
    v_cvt_pk_bf16_f32 v148, v144, v145
    v_exp_f32 v146, -v114
    v_mfma_f32_32x32x16_bf16 v[64:79], a[204:207], v[160:163], 0
    global_load_dwordx4 a[152:155], v2, s[4:5] offset:2048
    v_exp_f32 v147, -v115
    v_add_f32 v146, 1.0, v146
    v_add_f32 v147, 1.0, v147
    v_rcp_f32 v146, v146
    s_waitcnt lgkmcnt(2)
    s_waitcnt vmcnt(15)
    v_mfma_f32_32x32x16_bf16 v[16:31], a[208:211], v[164:167], v[16:31]
    ds_read_b128 v[176:179], v1 offset:5120
    v_rcp_f32 v147, v147
    v_mul_f32 v146, v114, v146
    v_mul_f32 v147, v115, v147
    s_waitcnt lgkmcnt(2)
    v_mfma_f32_32x32x16_bf16 v[48:63], a[208:211], v[168:171], v[48:63]
    global_load_dwordx4 a[156:159], v2, s[4:5] offset:3072
    v_add_u32 v2, 8192, v2
    v_cvt_pk_bf16_f32 v149, v146, v147
    v_exp_f32 v144, -v116
    v_exp_f32 v145, -v117
    v_mfma_f32_32x32x16_bf16 v[32:47], a[212:215], v[164:167], v[32:47]
    ds_read_b128 v[156:159], v1 offset:6144
    v_add_f32 v144, 1.0, v144
    v_add_f32 v145, 1.0, v145
    v_rcp_f32 v144, v144
    v_rcp_f32 v145, v145
    v_mfma_f32_32x32x16_bf16 v[64:79], a[212:215], v[168:171], v[64:79]
    global_load_dwordx4 a[160:163], v2, s[4:5] offset:-4096
    v_mul_f32 v144, v116, v144
    v_mul_f32 v145, v117, v145
    v_cvt_pk_bf16_f32 v150, v144, v145
    s_waitcnt lgkmcnt(2)
    v_mfma_f32_32x32x16_bf16 v[16:31], a[216:219], v[172:175], v[16:31]
    ds_read_b128 v[160:163], v1 offset:7168
    v_exp_f32 v146, -v118
    v_exp_f32 v147, -v119
    v_add_f32 v146, 1.0, v146
    s_waitcnt lgkmcnt(2)
    v_mfma_f32_32x32x16_bf16 v[48:63], a[216:219], v[176:179], v[48:63]
    global_load_dwordx4 a[164:167], v2, s[4:5] offset:-3072
    v_add_f32 v147, 1.0, v147
    v_rcp_f32 v146, v146
    v_rcp_f32 v147, v147
    v_mfma_f32_32x32x16_bf16 v[32:47], a[220:223], v[172:175], v[32:47]
    ds_read_b128 v[164:167], v1 offset:8192
    v_mul_f32 v146, v118, v146
    v_mul_f32 v147, v119, v147
    v_cvt_pk_bf16_f32 v151, v146, v147
    ds_write_b128 v3, v[148:151] offset:33792
    v_mfma_f32_32x32x16_bf16 v[64:79], a[220:223], v[176:179], v[64:79]
    global_load_dwordx4 a[168:171], v2, s[4:5] offset:-2048
    v_exp_f32 v144, -v120
    v_exp_f32 v145, -v121
    v_add_f32 v144, 1.0, v144
    s_waitcnt lgkmcnt(3)
    s_waitcnt vmcnt(15)
    v_mfma_f32_32x32x16_bf16 v[16:31], a[224:227], v[156:159], v[16:31]
    ds_read_b128 v[168:171], v1 offset:9216
    global_load_dwordx4 a[172:175], v2, s[4:5] offset:-1024
    v_add_f32 v145, 1.0, v145
    v_rcp_f32 v144, v144
    v_rcp_f32 v145, v145
    s_waitcnt lgkmcnt(3)
    v_mfma_f32_32x32x16_bf16 v[48:63], a[224:227], v[160:163], v[48:63]
    v_mul_f32 v144, v120, v144
    v_mul_f32 v145, v121, v145
    v_cvt_pk_bf16_f32 v152, v144, v145
    v_exp_f32 v146, -v122
    v_mfma_f32_32x32x16_bf16 v[32:47], a[228:231], v[156:159], v[32:47]
    ds_read_b128 v[172:175], v1 offset:10240
    global_load_dwordx4 a[176:179], v2, s[4:5] offset:0
    v_exp_f32 v147, -v123
    v_add_f32 v146, 1.0, v146
    v_add_f32 v147, 1.0, v147
    v_mfma_f32_32x32x16_bf16 v[64:79], a[228:231], v[160:163], v[64:79]
    v_rcp_f32 v146, v146
    v_rcp_f32 v147, v147
    v_mul_f32 v146, v122, v146
    s_waitcnt lgkmcnt(3)
    v_mfma_f32_32x32x16_bf16 v[16:31], a[232:235], v[164:167], v[16:31]
    ds_read_b128 v[176:179], v1 offset:11264
    global_load_dwordx4 a[180:183], v2, s[4:5] offset:1024
    v_mul_f32 v147, v123, v147
    v_cvt_pk_bf16_f32 v153, v146, v147
    v_exp_f32 v144, -v124
    s_waitcnt lgkmcnt(2)
    v_mfma_f32_32x32x16_bf16 v[48:63], a[232:235], v[168:171], v[48:63]
    v_exp_f32 v145, -v125
    v_add_f32 v144, 1.0, v144
    v_add_f32 v145, 1.0, v145
    v_rcp_f32 v144, v144
    v_mfma_f32_32x32x16_bf16 v[32:47], a[236:239], v[164:167], v[32:47]
    ds_read_b128 v[156:159], v1 offset:12288
    global_load_dwordx4 a[184:187], v2, s[4:5] offset:2048
    v_rcp_f32 v145, v145
    v_mul_f32 v144, v124, v144
    v_mul_f32 v145, v125, v145
    v_mfma_f32_32x32x16_bf16 v[64:79], a[236:239], v[168:171], v[64:79]
    v_cvt_pk_bf16_f32 v154, v144, v145
    v_exp_f32 v146, -v126
    v_exp_f32 v147, -v127
    s_waitcnt lgkmcnt(2)
    s_waitcnt vmcnt(15)
    v_mfma_f32_32x32x16_bf16 v[16:31], a[240:243], v[172:175], v[16:31]
    ds_read_b128 v[160:163], v1 offset:13312
    global_load_dwordx4 a[188:191], v2, s[4:5] offset:3072
    v_add_u32 v2, 8192, v2
    v_add_f32 v146, 1.0, v146
    v_add_f32 v147, 1.0, v147
    v_rcp_f32 v146, v146
    v_rcp_f32 v147, v147
    s_waitcnt lgkmcnt(2)
    v_mfma_f32_32x32x16_bf16 v[48:63], a[240:243], v[176:179], v[48:63]
    v_mul_f32 v146, v126, v146
    v_mul_f32 v147, v127, v147
    v_cvt_pk_bf16_f32 v155, v146, v147
    v_mfma_f32_32x32x16_bf16 v[32:47], a[244:247], v[172:175], v[32:47]
    ds_read_b128 v[164:167], v1 offset:14336
    global_load_dwordx4 a[192:195], v2, s[4:5] offset:-4096
    ds_write_b128 v3, v[152:155] offset:35840
    v_exp_f32 v144, -v128
    v_exp_f32 v145, -v129
    v_mfma_f32_32x32x16_bf16 v[64:79], a[244:247], v[176:179], v[64:79]
    v_add_f32 v144, 1.0, v144
    v_add_f32 v145, 1.0, v145
    v_rcp_f32 v144, v144
    s_waitcnt lgkmcnt(3)
    v_mfma_f32_32x32x16_bf16 v[16:31], a[248:251], v[156:159], v[16:31]
    ds_read_b128 v[168:171], v1 offset:15360
    global_load_dwordx4 a[196:199], v2, s[4:5] offset:-3072
    v_rcp_f32 v145, v145
    v_mul_f32 v144, v128, v144
    v_mul_f32 v145, v129, v145
    v_cvt_pk_bf16_f32 v148, v144, v145
    s_waitcnt lgkmcnt(3)
    v_mfma_f32_32x32x16_bf16 v[48:63], a[248:251], v[160:163], v[48:63]
    v_exp_f32 v146, -v130
    v_exp_f32 v147, -v131
    v_add_f32 v146, 1.0, v146
    v_mfma_f32_32x32x16_bf16 v[32:47], a[252:255], v[156:159], v[32:47]
    ds_read_b128 v[172:175], v1 offset:16384
    global_load_dwordx4 a[200:203], v2, s[4:5] offset:-2048
    v_add_f32 v147, 1.0, v147
    v_rcp_f32 v146, v146
    v_rcp_f32 v147, v147
    v_mfma_f32_32x32x16_bf16 v[64:79], a[252:255], v[160:163], v[64:79]
    v_mul_f32 v146, v130, v146
    v_mul_f32 v147, v131, v147
    v_cvt_pk_bf16_f32 v149, v146, v147
    v_exp_f32 v144, -v132
    s_waitcnt lgkmcnt(3)
    s_waitcnt vmcnt(15)
    v_mfma_f32_32x32x16_bf16 v[16:31], a[128:131], v[164:167], v[16:31]
    ds_read_b128 v[176:179], v1 offset:17408
    global_load_dwordx4 a[204:207], v2, s[4:5] offset:-1024
    v_exp_f32 v145, -v133
    v_add_f32 v144, 1.0, v144
    v_add_f32 v145, 1.0, v145
    s_waitcnt lgkmcnt(2)
    v_mfma_f32_32x32x16_bf16 v[48:63], a[128:131], v[168:171], v[48:63]
    v_rcp_f32 v144, v144
    v_rcp_f32 v145, v145
    v_mul_f32 v144, v132, v144
    v_mfma_f32_32x32x16_bf16 v[32:47], a[132:135], v[164:167], v[32:47]
    ds_read_b128 v[156:159], v1 offset:18432
    global_load_dwordx4 a[208:211], v2, s[4:5] offset:0
    v_mul_f32 v145, v133, v145
    v_cvt_pk_bf16_f32 v150, v144, v145
    v_exp_f32 v146, -v134
    v_mfma_f32_32x32x16_bf16 v[64:79], a[132:135], v[168:171], v[64:79]
    v_exp_f32 v147, -v135
    v_add_f32 v146, 1.0, v146
    v_add_f32 v147, 1.0, v147
    v_rcp_f32 v146, v146
    s_waitcnt lgkmcnt(2)
    v_mfma_f32_32x32x16_bf16 v[16:31], a[136:139], v[172:175], v[16:31]
    ds_read_b128 v[160:163], v1 offset:19456
    global_load_dwordx4 a[212:215], v2, s[4:5] offset:1024
    v_rcp_f32 v147, v147
    v_mul_f32 v146, v134, v146
    v_mul_f32 v147, v135, v147
    s_waitcnt lgkmcnt(2)
    v_mfma_f32_32x32x16_bf16 v[48:63], a[136:139], v[176:179], v[48:63]
    v_cvt_pk_bf16_f32 v151, v146, v147
    ds_write_b128 v3, v[148:151] offset:37888
    v_exp_f32 v144, -v136
    v_mfma_f32_32x32x16_bf16 v[32:47], a[140:143], v[172:175], v[32:47]
    ds_read_b128 v[164:167], v1 offset:20480
    global_load_dwordx4 a[216:219], v2, s[4:5] offset:2048
    v_exp_f32 v145, -v137
    v_add_f32 v144, 1.0, v144
    v_add_f32 v145, 1.0, v145
    v_rcp_f32 v144, v144
    v_mfma_f32_32x32x16_bf16 v[64:79], a[140:143], v[176:179], v[64:79]
    v_rcp_f32 v145, v145
    v_mul_f32 v144, v136, v144
    v_mul_f32 v145, v137, v145
    s_waitcnt lgkmcnt(3)
    s_waitcnt vmcnt(15)
    v_mfma_f32_32x32x16_bf16 v[16:31], a[144:147], v[156:159], v[16:31]
    ds_read_b128 v[168:171], v1 offset:21504
    global_load_dwordx4 a[220:223], v2, s[4:5] offset:3072
    v_add_u32 v2, 8192, v2
    v_cvt_pk_bf16_f32 v152, v144, v145
    v_exp_f32 v146, -v138
    v_exp_f32 v147, -v139
    s_waitcnt lgkmcnt(3)
    v_mfma_f32_32x32x16_bf16 v[48:63], a[144:147], v[160:163], v[48:63]
    global_load_dwordx4 a[224:227], v2, s[4:5] offset:-4096
    v_add_f32 v146, 1.0, v146
    v_add_f32 v147, 1.0, v147
    v_rcp_f32 v146, v146
    v_mfma_f32_32x32x16_bf16 v[32:47], a[148:151], v[156:159], v[32:47]
    ds_read_b128 v[172:175], v1 offset:22528
    v_rcp_f32 v147, v147
    v_mul_f32 v146, v138, v146
    v_mul_f32 v147, v139, v147
    v_cvt_pk_bf16_f32 v153, v146, v147
    v_mfma_f32_32x32x16_bf16 v[64:79], a[148:151], v[160:163], v[64:79]
    global_load_dwordx4 a[228:231], v2, s[4:5] offset:-3072
    v_exp_f32 v144, -v140
    v_exp_f32 v145, -v141
    v_add_f32 v144, 1.0, v144
    s_waitcnt lgkmcnt(2)
    v_mfma_f32_32x32x16_bf16 v[16:31], a[152:155], v[164:167], v[16:31]
    ds_read_b128 v[176:179], v1 offset:23552
    v_add_f32 v145, 1.0, v145
    v_rcp_f32 v144, v144
    v_rcp_f32 v145, v145
    s_waitcnt lgkmcnt(2)
    v_mfma_f32_32x32x16_bf16 v[48:63], a[152:155], v[168:171], v[48:63]
    global_load_dwordx4 a[232:235], v2, s[4:5] offset:-2048
    v_mul_f32 v144, v140, v144
    v_mul_f32 v145, v141, v145
    v_cvt_pk_bf16_f32 v154, v144, v145
    v_exp_f32 v146, -v142
    v_mfma_f32_32x32x16_bf16 v[32:47], a[156:159], v[164:167], v[32:47]
    ds_read_b128 v[156:159], v1 offset:24576
    v_exp_f32 v147, -v143
    v_add_f32 v146, 1.0, v146
    v_add_f32 v147, 1.0, v147
    v_mfma_f32_32x32x16_bf16 v[64:79], a[156:159], v[168:171], v[64:79]
    global_load_dwordx4 a[236:239], v2, s[4:5] offset:-1024
    v_rcp_f32 v146, v146
    v_rcp_f32 v147, v147
    v_mul_f32 v146, v142, v146
    s_waitcnt lgkmcnt(2)
    s_waitcnt vmcnt(16)
    v_mfma_f32_32x32x16_bf16 v[16:31], a[160:163], v[172:175], v[16:31]
    ds_read_b128 v[160:163], v1 offset:25600
    v_mul_f32 v147, v143, v147
    v_cvt_pk_bf16_f32 v155, v146, v147
    ds_write_b128 v3, v[152:155] offset:39936
    s_waitcnt lgkmcnt(3)
    v_mfma_f32_32x32x16_bf16 v[48:63], a[160:163], v[176:179], v[48:63]
    global_load_dwordx4 a[240:243], v2, s[4:5] offset:0
    v_exp_f32 v144, -v80
    v_exp_f32 v145, -v81
    v_add_f32 v144, 1.0, v144
    v_add_f32 v145, 1.0, v145
    v_mfma_f32_32x32x16_bf16 v[32:47], a[164:167], v[172:175], v[32:47]
    ds_read_b128 v[164:167], v1 offset:26624
    v_rcp_f32 v144, v144
    v_rcp_f32 v145, v145
    v_mul_f32 v144, v80, v144
    v_mfma_f32_32x32x16_bf16 v[64:79], a[164:167], v[176:179], v[64:79]
    global_load_dwordx4 a[244:247], v2, s[4:5] offset:1024
    v_mul_f32 v145, v81, v145
    v_cvt_pk_bf16_f32 v148, v144, v145
    v_exp_f32 v146, -v82
    s_waitcnt lgkmcnt(3)
    v_mfma_f32_32x32x16_bf16 v[16:31], a[168:171], v[156:159], v[16:31]
    ds_read_b128 v[168:171], v1 offset:27648
    v_exp_f32 v147, -v83
    v_add_f32 v146, 1.0, v146
    v_add_f32 v147, 1.0, v147
    v_rcp_f32 v146, v146
    s_waitcnt lgkmcnt(3)
    v_mfma_f32_32x32x16_bf16 v[48:63], a[168:171], v[160:163], v[48:63]
    global_load_dwordx4 a[248:251], v2, s[4:5] offset:2048
    v_rcp_f32 v147, v147
    v_mul_f32 v146, v82, v146
    v_mul_f32 v147, v83, v147
    v_mfma_f32_32x32x16_bf16 v[32:47], a[172:175], v[156:159], v[32:47]
    ds_read_b128 v[172:175], v1 offset:28672
    v_cvt_pk_bf16_f32 v149, v146, v147
    v_exp_f32 v144, -v84
    v_exp_f32 v145, -v85
    v_mfma_f32_32x32x16_bf16 v[64:79], a[172:175], v[160:163], v[64:79]
    global_load_dwordx4 a[252:255], v2, s[4:5] offset:3072
    v_add_u32 v2, 8192, v2
    v_add_f32 v144, 1.0, v144
    v_add_f32 v145, 1.0, v145
    v_rcp_f32 v144, v144
    v_rcp_f32 v145, v145
    s_waitcnt lgkmcnt(2)
    s_waitcnt vmcnt(16)
    v_mfma_f32_32x32x16_bf16 v[16:31], a[176:179], v[164:167], v[16:31]
    ds_read_b128 v[176:179], v1 offset:29696
    v_mul_f32 v144, v84, v144
    v_mul_f32 v145, v85, v145
    v_cvt_pk_bf16_f32 v150, v144, v145
    s_waitcnt lgkmcnt(2)
    v_mfma_f32_32x32x16_bf16 v[48:63], a[176:179], v[168:171], v[48:63]
    global_load_dwordx4 a[128:131], v2, s[4:5] offset:-4096
    v_exp_f32 v146, -v86
    v_exp_f32 v147, -v87
    v_add_f32 v146, 1.0, v146
    v_mfma_f32_32x32x16_bf16 v[32:47], a[180:183], v[164:167], v[32:47]
    ds_read_b128 v[156:159], v1 offset:30720
    v_add_f32 v147, 1.0, v147
    v_rcp_f32 v146, v146
    v_rcp_f32 v147, v147
    v_mfma_f32_32x32x16_bf16 v[64:79], a[180:183], v[168:171], v[64:79]
    global_load_dwordx4 a[132:135], v2, s[4:5] offset:-3072
    v_mul_f32 v146, v86, v146
    v_mul_f32 v147, v87, v147
    v_cvt_pk_bf16_f32 v151, v146, v147
    ds_write_b128 v3, v[148:151] offset:32768
    s_waitcnt lgkmcnt(3)
    v_mfma_f32_32x32x16_bf16 v[16:31], a[184:187], v[172:175], v[16:31]
    ds_read_b128 v[160:163], v1 offset:31744
    v_exp_f32 v144, -v88
    v_exp_f32 v145, -v89
    v_add_f32 v144, 1.0, v144
    s_waitcnt lgkmcnt(3)
    v_mfma_f32_32x32x16_bf16 v[48:63], a[184:187], v[176:179], v[48:63]
    global_load_dwordx4 a[136:139], v2, s[4:5] offset:-2048
    v_add_f32 v145, 1.0, v145
    v_rcp_f32 v144, v144
    v_rcp_f32 v145, v145
    v_mfma_f32_32x32x16_bf16 v[32:47], a[188:191], v[172:175], v[32:47]
    v_mul_f32 v144, v88, v144
    v_mul_f32 v145, v89, v145
    v_cvt_pk_bf16_f32 v152, v144, v145
    v_exp_f32 v146, -v90
    s_waitcnt lgkmcnt(0)
    s_barrier
    v_mfma_f32_32x32x16_bf16 v[64:79], a[188:191], v[176:179], v[64:79]
    global_load_dwordx4 a[140:143], v2, s[4:5] offset:-1024
    v_exp_f32 v147, -v91
    v_add_f32 v146, 1.0, v146
    v_add_f32 v147, 1.0, v147
    s_waitcnt vmcnt(16)
    v_mfma_f32_32x32x16_bf16 v[16:31], a[192:195], v[156:159], v[16:31]
    ds_read_b128 v[164:167], v1 offset:33792
    global_load_dwordx4 a[144:147], v2, s[4:5] offset:0
    v_rcp_f32 v146, v146
    v_rcp_f32 v147, v147
    v_mul_f32 v146, v90, v146
    v_mfma_f32_32x32x16_bf16 v[48:63], a[192:195], v[160:163], v[48:63]
    v_mul_f32 v147, v91, v147
    v_cvt_pk_bf16_f32 v153, v146, v147
    v_exp_f32 v144, -v92
    v_mfma_f32_32x32x16_bf16 v[32:47], a[196:199], v[156:159], v[32:47]
    ds_read_b128 v[168:171], v1 offset:35840
    global_load_dwordx4 a[148:151], v2, s[4:5] offset:1024
    v_exp_f32 v145, -v93
    v_add_f32 v144, 1.0, v144
    v_add_f32 v145, 1.0, v145
    v_rcp_f32 v144, v144
    v_mfma_f32_32x32x16_bf16 v[64:79], a[196:199], v[160:163], v[64:79]
    v_rcp_f32 v145, v145
    v_mul_f32 v144, v92, v144
    v_mul_f32 v145, v93, v145
    s_waitcnt lgkmcnt(1)
    v_mfma_f32_32x32x16_bf16 v[48:63], a[200:203], v[164:167], v[48:63]
    ds_read_b128 v[172:175], v1 offset:37888
    global_load_dwordx4 a[152:155], v2, s[4:5] offset:2048
    v_cvt_pk_bf16_f32 v154, v144, v145
    v_exp_f32 v146, -v94
    v_exp_f32 v147, -v95
    v_mfma_f32_32x32x16_bf16 v[64:79], a[204:207], v[164:167], v[64:79]
    v_add_f32 v146, 1.0, v146
    v_add_f32 v147, 1.0, v147
    v_rcp_f32 v146, v146
    v_rcp_f32 v147, v147
    s_waitcnt lgkmcnt(1)
    s_waitcnt vmcnt(15)
    v_mfma_f32_32x32x16_bf16 v[48:63], a[208:211], v[168:171], v[48:63]
    ds_read_b128 v[176:179], v1 offset:39936
    global_load_dwordx4 a[156:159], v2, s[4:5] offset:3072
    v_add_u32 v2, 8192, v2
    v_mul_f32 v146, v94, v146
    v_mul_f32 v147, v95, v147
    v_cvt_pk_bf16_f32 v155, v146, v147
    v_mfma_f32_32x32x16_bf16 v[64:79], a[212:215], v[168:171], v[64:79]
    ds_write_b128 v3, v[152:155] offset:34816
    v_exp_f32 v144, -v96
    v_exp_f32 v145, -v97
    s_waitcnt lgkmcnt(2)
    v_mfma_f32_32x32x16_bf16 v[48:63], a[216:219], v[172:175], v[48:63]
    ds_read_b128 v[156:159], v1 offset:41984
    global_load_dwordx4 a[160:163], v2, s[4:5] offset:-4096
    v_add_f32 v144, 1.0, v144
    v_add_f32 v145, 1.0, v145
    v_rcp_f32 v144, v144
    v_mfma_f32_32x32x16_bf16 v[64:79], a[220:223], v[172:175], v[64:79]
    global_load_dwordx4 a[164:167], v2, s[4:5] offset:-3072
    v_rcp_f32 v145, v145
    v_mul_f32 v144, v96, v144
    v_mul_f32 v145, v97, v145
    v_cvt_pk_bf16_f32 v148, v144, v145
    s_waitcnt lgkmcnt(2)
    s_waitcnt vmcnt(14)
    v_mfma_f32_32x32x16_bf16 v[48:63], a[224:227], v[176:179], v[48:63]
    ds_read_b128 v[160:163], v1 offset:44032
    v_exp_f32 v146, -v98
    v_exp_f32 v147, -v99
    v_add_f32 v146, 1.0, v146
    v_mfma_f32_32x32x16_bf16 v[64:79], a[228:231], v[176:179], v[64:79]
    global_load_dwordx4 a[168:171], v2, s[4:5] offset:-2048
    v_add_f32 v147, 1.0, v147
    v_rcp_f32 v146, v146
    v_rcp_f32 v147, v147
    s_waitcnt lgkmcnt(1)
    v_mfma_f32_32x32x16_bf16 v[48:63], a[232:235], v[156:159], v[48:63]
    ds_read_b128 v[164:167], v1 offset:46080
    v_mul_f32 v146, v98, v146
    v_mul_f32 v147, v99, v147
    v_cvt_pk_bf16_f32 v149, v146, v147
    v_exp_f32 v144, -v100
    v_mfma_f32_32x32x16_bf16 v[64:79], a[236:239], v[156:159], v[64:79]
    global_load_dwordx4 a[172:175], v2, s[4:5] offset:-1024
    v_exp_f32 v145, -v101
    v_add_f32 v144, 1.0, v144
    v_add_f32 v145, 1.0, v145
    s_waitcnt lgkmcnt(1)
    s_waitcnt vmcnt(12)
    v_mfma_f32_32x32x16_bf16 v[48:63], a[240:243], v[160:163], v[48:63]
    ds_read_b128 v[168:171], v1 offset:48128
    v_rcp_f32 v144, v144
    v_rcp_f32 v145, v145
    v_mul_f32 v144, v100, v144
    v_mfma_f32_32x32x16_bf16 v[64:79], a[244:247], v[160:163], v[64:79]
    global_load_dwordx4 a[176:179], v2, s[4:5] offset:0
    v_mul_f32 v145, v101, v145
    v_cvt_pk_bf16_f32 v150, v144, v145
    v_exp_f32 v146, -v102
    s_waitcnt lgkmcnt(1)
    v_mfma_f32_32x32x16_bf16 v[48:63], a[248:251], v[164:167], v[48:63]
    ds_read_b128 v[172:175], v1 offset:50176
    v_exp_f32 v147, -v103
    v_add_f32 v146, 1.0, v146
    v_add_f32 v147, 1.0, v147
    v_rcp_f32 v146, v146
    v_mfma_f32_32x32x16_bf16 v[64:79], a[252:255], v[164:167], v[64:79]
    global_load_dwordx4 a[180:183], v2, s[4:5] offset:1024
    v_rcp_f32 v147, v147
    v_mul_f32 v146, v102, v146
    v_mul_f32 v147, v103, v147
    s_waitcnt lgkmcnt(1)
    s_waitcnt vmcnt(10)
    v_mfma_f32_32x32x16_bf16 v[48:63], a[128:131], v[168:171], v[48:63]
    ds_read_b128 v[176:179], v1 offset:52224
    global_load_dwordx4 a[184:187], v2, s[4:5] offset:2048
    v_cvt_pk_bf16_f32 v151, v146, v147
    ds_write_b128 v3, v[148:151] offset:36864
    v_exp_f32 v144, -v104
    v_mfma_f32_32x32x16_bf16 v[64:79], a[132:135], v[168:171], v[64:79]
    global_load_dwordx4 a[188:191], v2, s[4:5] offset:3072
    v_add_u32 v2, 8192, v2
    v_exp_f32 v145, -v105
    v_add_f32 v144, 1.0, v144
    v_add_f32 v145, 1.0, v145
    v_rcp_f32 v144, v144
    s_waitcnt lgkmcnt(2)
    v_mfma_f32_32x32x16_bf16 v[48:63], a[136:139], v[172:175], v[48:63]
    ds_read_b128 v[156:159], v1 offset:54272
    global_load_dwordx4 a[192:195], v2, s[4:5] offset:-4096
    v_rcp_f32 v145, v145
    v_mul_f32 v144, v104, v144
    v_mul_f32 v145, v105, v145
    v_mfma_f32_32x32x16_bf16 v[64:79], a[140:143], v[172:175], v[64:79]
    global_load_dwordx4 a[196:199], v2, s[4:5] offset:-3072
    v_cvt_pk_bf16_f32 v152, v144, v145
    v_exp_f32 v146, -v106
    v_exp_f32 v147, -v107
    s_waitcnt lgkmcnt(2)
    s_waitcnt vmcnt(10)
    v_mfma_f32_32x32x16_bf16 v[48:63], a[144:147], v[176:179], v[48:63]
    ds_read_b128 v[160:163], v1 offset:56320
    v_add_f32 v146, 1.0, v146
    v_add_f32 v147, 1.0, v147
    v_rcp_f32 v146, v146
    v_mfma_f32_32x32x16_bf16 v[64:79], a[148:151], v[176:179], v[64:79]
    v_rcp_f32 v147, v147
    v_mul_f32 v146, v106, v146
    v_mul_f32 v147, v107, v147
    v_cvt_pk_bf16_f32 v153, v146, v147
    s_waitcnt lgkmcnt(1)
    v_mfma_f32_32x32x16_bf16 v[48:63], a[152:155], v[156:159], v[48:63]
    ds_read_b128 v[164:167], v1 offset:58368
    v_exp_f32 v144, -v108
    v_exp_f32 v145, -v109
    v_add_f32 v144, 1.0, v144
    v_mfma_f32_32x32x16_bf16 v[64:79], a[156:159], v[156:159], v[64:79]
    v_add_f32 v145, 1.0, v145
    v_rcp_f32 v144, v144
    v_rcp_f32 v145, v145
    s_waitcnt lgkmcnt(1)
    s_waitcnt vmcnt(6)
    v_mfma_f32_32x32x16_bf16 v[48:63], a[160:163], v[160:163], v[48:63]
    ds_read_b128 v[168:171], v1 offset:60416
    v_mul_f32 v144, v108, v144
    v_mul_f32 v145, v109, v145
    v_cvt_pk_bf16_f32 v154, v144, v145
    v_exp_f32 v146, -v110
    v_mfma_f32_32x32x16_bf16 v[64:79], a[164:167], v[160:163], v[64:79]
    v_exp_f32 v147, -v111
    v_add_f32 v146, 1.0, v146
    v_add_f32 v147, 1.0, v147
    s_waitcnt lgkmcnt(1)
    v_mfma_f32_32x32x16_bf16 v[48:63], a[168:171], v[164:167], v[48:63]
    ds_read_b128 v[172:175], v1 offset:62464
    v_rcp_f32 v146, v146
    v_rcp_f32 v147, v147
    v_mul_f32 v146, v110, v146
    v_mfma_f32_32x32x16_bf16 v[64:79], a[172:175], v[164:167], v[64:79]
    v_mul_f32 v147, v111, v147
    v_cvt_pk_bf16_f32 v155, v146, v147
    ds_write_b128 v3, v[152:155] offset:38912
    s_waitcnt lgkmcnt(2)
    s_waitcnt vmcnt(2)
    v_mfma_f32_32x32x16_bf16 v[48:63], a[176:179], v[168:171], v[48:63]
    ds_read_b128 v[176:179], v1 offset:64512
    s_waitcnt lgkmcnt(0)
    s_barrier
    v_mfma_f32_32x32x16_bf16 v[64:79], a[180:183], v[168:171], v[64:79]
    v_mfma_f32_32x32x16_bf16 v[48:63], a[184:187], v[172:175], v[48:63]
    ds_read_b128 v[156:159], v1 offset:32768
    v_mfma_f32_32x32x16_bf16 v[64:79], a[188:191], v[172:175], v[64:79]
    s_waitcnt vmcnt(0)
    v_mfma_f32_32x32x16_bf16 v[48:63], a[192:195], v[176:179], v[48:63]
    ds_read_b128 v[160:163], v1 offset:34816
    v_mfma_f32_32x32x16_bf16 v[64:79], a[196:199], v[176:179], v[64:79]
    s_waitcnt lgkmcnt(1)
    v_mfma_f32_32x32x16_bf16 v[16:31], a[200:203], v[156:159], v[16:31]
    ds_read_b128 v[164:167], v1 offset:36864
    v_mfma_f32_32x32x16_bf16 v[32:47], a[204:207], v[156:159], v[32:47]
    s_waitcnt lgkmcnt(1)
    v_mfma_f32_32x32x16_bf16 v[16:31], a[208:211], v[160:163], v[16:31]
    ds_read_b128 v[168:171], v1 offset:38912
    v_mfma_f32_32x32x16_bf16 v[32:47], a[212:215], v[160:163], v[32:47]
    v_cvt_pk_bf16_f32 v228, v48, v49
    v_cvt_pk_bf16_f32 v229, v50, v51
    v_cvt_pk_bf16_f32 v230, v52, v53
    v_cvt_pk_bf16_f32 v231, v54, v55
    s_cbranch_vccz post_kernel_xs7
    global_store_dwordx4 v15, v[228:231], s[6:7] offset:0
post_kernel_xj7:
    s_waitcnt lgkmcnt(1)
    v_mfma_f32_32x32x16_bf16 v[16:31], a[216:219], v[164:167], v[16:31]
    ds_read_b128 v[172:175], v1 offset:40960
    v_cvt_pk_bf16_f32 v232, v56, v57
    v_cvt_pk_bf16_f32 v233, v58, v59
    v_cvt_pk_bf16_f32 v234, v60, v61
    v_cvt_pk_bf16_f32 v235, v62, v63
    s_cbranch_vccz post_kernel_xs8
    global_store_dwordx4 v15, v[232:235], s[6:7] offset:1024
post_kernel_xj8:
    v_mfma_f32_32x32x16_bf16 v[32:47], a[220:223], v[164:167], v[32:47]
    v_cvt_pk_bf16_f32 v236, v64, v65
    v_cvt_pk_bf16_f32 v237, v66, v67
    v_cvt_pk_bf16_f32 v238, v68, v69
    v_cvt_pk_bf16_f32 v239, v70, v71
    s_cbranch_vccz post_kernel_xs9
    global_store_dwordx4 v15, v[236:239], s[6:7] offset:2048
post_kernel_xj9:
    s_waitcnt lgkmcnt(1)
    v_mfma_f32_32x32x16_bf16 v[16:31], a[224:227], v[168:171], v[16:31]
    ds_read_b128 v[176:179], v1 offset:43008
    v_cvt_pk_bf16_f32 v240, v72, v73
    v_cvt_pk_bf16_f32 v241, v74, v75
    v_cvt_pk_bf16_f32 v242, v76, v77
    v_cvt_pk_bf16_f32 v243, v78, v79
    s_cbranch_vccz post_kernel_xs10
    global_store_dwordx4 v15, v[240:243], s[6:7] offset:3072
post_kernel_xj10:
    v_mfma_f32_32x32x16_bf16 v[32:47], a[228:231], v[168:171], v[32:47]
    s_waitcnt lgkmcnt(1)
    v_mfma_f32_32x32x16_bf16 v[16:31], a[232:235], v[172:175], v[16:31]
    ds_read_b128 v[156:159], v1 offset:45056
    v_mfma_f32_32x32x16_bf16 v[32:47], a[236:239], v[172:175], v[32:47]
    s_waitcnt lgkmcnt(1)
    v_mfma_f32_32x32x16_bf16 v[16:31], a[240:243], v[176:179], v[16:31]
    ds_read_b128 v[160:163], v1 offset:47104
    v_mfma_f32_32x32x16_bf16 v[32:47], a[244:247], v[176:179], v[32:47]
    s_waitcnt lgkmcnt(1)
    v_mfma_f32_32x32x16_bf16 v[16:31], a[248:251], v[156:159], v[16:31]
    ds_read_b128 v[164:167], v1 offset:49152
    v_mfma_f32_32x32x16_bf16 v[32:47], a[252:255], v[156:159], v[32:47]
    s_waitcnt lgkmcnt(1)
    v_mfma_f32_32x32x16_bf16 v[16:31], a[128:131], v[160:163], v[16:31]
    ds_read_b128 v[168:171], v1 offset:51200
    v_mfma_f32_32x32x16_bf16 v[32:47], a[132:135], v[160:163], v[32:47]
    s_waitcnt lgkmcnt(1)
    v_mfma_f32_32x32x16_bf16 v[16:31], a[136:139], v[164:167], v[16:31]
    ds_read_b128 v[172:175], v1 offset:53248
    v_mfma_f32_32x32x16_bf16 v[32:47], a[140:143], v[164:167], v[32:47]
    s_waitcnt vmcnt(0)
    s_cbranch_vccz post_kernel_xs11
    global_store_dwordx2 v14, v[252:253], s[4:5] offset:384
post_kernel_xj11:
    s_waitcnt lgkmcnt(1)
    v_mfma_f32_32x32x16_bf16 v[16:31], a[144:147], v[168:171], v[16:31]
    ds_read_b128 v[176:179], v1 offset:55296
    v_mfma_f32_32x32x16_bf16 v[32:47], a[148:151], v[168:171], v[32:47]
    s_waitcnt lgkmcnt(1)
    v_mfma_f32_32x32x16_bf16 v[16:31], a[152:155], v[172:175], v[16:31]
    ds_read_b128 v[156:159], v1 offset:57344
    v_mfma_f32_32x32x16_bf16 v[32:47], a[156:159], v[172:175], v[32:47]
    s_waitcnt lgkmcnt(1)
    v_mfma_f32_32x32x16_bf16 v[16:31], a[160:163], v[176:179], v[16:31]
    ds_read_b128 v[160:163], v1 offset:59392
    v_mfma_f32_32x32x16_bf16 v[32:47], a[164:167], v[176:179], v[32:47]
    s_waitcnt lgkmcnt(1)
    v_mfma_f32_32x32x16_bf16 v[16:31], a[168:171], v[156:159], v[16:31]
    ds_read_b128 v[164:167], v1 offset:61440
    v_mfma_f32_32x32x16_bf16 v[32:47], a[172:175], v[156:159], v[32:47]
    s_waitcnt lgkmcnt(1)
    v_mfma_f32_32x32x16_bf16 v[16:31], a[176:179], v[160:163], v[16:31]
    ds_read_b128 v[168:171], v1 offset:63488
    v_mfma_f32_32x32x16_bf16 v[32:47], a[180:183], v[160:163], v[32:47]
    global_load_dwordx2 v[254:255], v13, s[4:5] offset:384 sc1
    s_waitcnt lgkmcnt(1)
    v_mfma_f32_32x32x16_bf16 v[16:31], a[184:187], v[164:167], v[16:31]
    v_mfma_f32_32x32x16_bf16 v[32:47], a[188:191], v[164:167], v[32:47]
    s_waitcnt lgkmcnt(0)
    v_mfma_f32_32x32x16_bf16 v[16:31], a[192:195], v[168:171], v[16:31]
    v_mfma_f32_32x32x16_bf16 v[32:47], a[196:199], v[168:171], v[32:47]
    s_nop 3
    s_waitcnt vmcnt(0)
    s_mov_b32 s34, 400000
post_kernel_p2:
    v_readfirstlane_b32 s42, v254
    v_readfirstlane_b32 s43, v255
    s_sub_u32 s34, s34, 1
    s_cselect_b64 s[42:43], s[100:101], s[42:43]
    s_cmp_lg_u64 s[42:43], s[100:101]
    s_cbranch_scc1 post_kernel_p2c
    global_load_dwordx4 v[228:231], v4, s[6:7] offset:0 sc1
    global_load_dwordx4 v[232:235], v4, s[6:7] offset:1024 sc1
    global_load_dwordx4 v[236:239], v4, s[6:7] offset:2048 sc1
    global_load_dwordx4 v[240:243], v4, s[6:7] offset:3072 sc1
    s_waitcnt vmcnt(3)
    v_dot2c_f32_bf16 v16, v228, v188
    v_dot2c_f32_bf16 v17, v228, v189
    v_dot2c_f32_bf16 v18, v229, v188
    v_dot2c_f32_bf16 v19, v229, v189
    v_dot2c_f32_bf16 v20, v230, v188
    v_dot2c_f32_bf16 v21, v230, v189
    v_dot2c_f32_bf16 v22, v231, v188
    v_dot2c_f32_bf16 v23, v231, v189
    s_waitcnt vmcnt(2)
    v_dot2c_f32_bf16 v24, v232, v188
    v_dot2c_f32_bf16 v25, v232, v189
    v_dot2c_f32_bf16 v26, v233, v188
    v_dot2c_f32_bf16 v27, v233, v189
    v_dot2c_f32_bf16 v28, v234, v188
    v_dot2c_f32_bf16 v29, v234, v189
    v_dot2c_f32_bf16 v30, v235, v188
    v_dot2c_f32_bf16 v31, v235, v189
    s_waitcnt vmcnt(1)
    v_dot2c_f32_bf16 v32, v236, v188
    v_dot2c_f32_bf16 v33, v236, v189
    v_dot2c_f32_bf16 v34, v237, v188
    v_dot2c_f32_bf16 v35, v237, v189
    v_dot2c_f32_bf16 v36, v238, v188
    v_dot2c_f32_bf16 v37, v238, v189
    v_dot2c_f32_bf16 v38, v239, v188
    v_dot2c_f32_bf16 v39, v239, v189
    s_waitcnt vmcnt(0)
    v_dot2c_f32_bf16 v40, v240, v188
    v_dot2c_f32_bf16 v41, v240, v189
    v_dot2c_f32_bf16 v42, v241, v188
    v_dot2c_f32_bf16 v43, v241, v189
    v_dot2c_f32_bf16 v44, v242, v188
    v_dot2c_f32_bf16 v45, v242, v189
    v_dot2c_f32_bf16 v46, v243, v188
    v_dot2c_f32_bf16 v47, v243, v189
    s_nop 2
    v_pk_add_f32 v[180:181], v[16:17], v[18:19]
    v_pk_mul_f32 v[182:183], v[16:17], v[16:17]
    v_pk_fma_f32 v[182:183], v[18:19], v[18:19], v[182:183]
    v_pk_add_f32 v[180:181], v[180:181], v[20:21]
    v_pk_fma_f32 v[182:183], v[20:21], v[20:21], v[182:183]
    v_pk_add_f32 v[180:181], v[180:181], v[22:23]
    v_pk_fma_f32 v[182:183], v[22:23], v[22:23], v[182:183]
    v_pk_add_f32 v[180:181], v[180:181], v[24:25]
    v_pk_fma_f32 v[182:183], v[24:25], v[24:25], v[182:183]
    v_pk_add_f32 v[180:181], v[180:181], v[26:27]
    v_pk_fma_f32 v[182:183], v[26:27], v[26:27], v[182:183]
    v_pk_add_f32 v[180:181], v[180:181], v[28:29]
    v_pk_fma_f32 v[182:183], v[28:29], v[28:29], v[182:183]
    v_pk_add_f32 v[180:181], v[180:181], v[30:31]
    v_pk_fma_f32 v[182:183], v[30:31], v[30:31], v[182:183]
    v_pk_add_f32 v[180:181], v[180:181], v[32:33]
    v_pk_fma_f32 v[182:183], v[32:33], v[32:33], v[182:183]
    v_pk_add_f32 v[180:181], v[180:181], v[34:35]
    v_pk_fma_f32 v[182:183], v[34:35], v[34:35], v[182:183]
    v_pk_add_f32 v[180:181], v[180:181], v[36:37]
    v_pk_fma_f32 v[182:183], v[36:37], v[36:37], v[182:183]
    v_pk_add_f32 v[180:181], v[180:181], v[38:39]
    v_pk_fma_f32 v[182:183], v[38:39], v[38:39], v[182:183]
    v_pk_add_f32 v[180:181], v[180:181], v[40:41]
    v_pk_fma_f32 v[182:183], v[40:41], v[40:41], v[182:183]
    v_pk_add_f32 v[180:181], v[180:181], v[42:43]
    v_pk_fma_f32 v[182:183], v[42:43], v[42:43], v[182:183]
    v_pk_add_f32 v[180:181], v[180:181], v[44:45]
    v_pk_fma_f32 v[182:183], v[44:45], v[44:45], v[182:183]
    v_pk_add_f32 v[180:181], v[180:181], v[46:47]
    v_pk_fma_f32 v[182:183], v[46:47], v[46:47], v[182:183]
    v_add_f32 v180, v180, v181
    v_add_f32 v181, v182, v183
    v_mov_b32 v182, v180
    v_mov_b32 v183, v181
    s_nop 1
    v_permlane32_swap_b32 v180, v182
    v_permlane32_swap_b32 v181, v183
    v_pk_add_f32 v[180:181], v[180:181], v[182:183]
    ds_write_b64 v5, v[180:181] offset:3072
    s_waitcnt lgkmcnt(0)
    s_barrier
    ds_read_b64 v[180:181], v6 offset:3072
    ds_read_b64 v[182:183], v6 offset:3328
    ds_read_b64 v[184:185], v6 offset:3584
    ds_read_b64 v[186:187], v6 offset:3840
    s_waitcnt lgkmcnt(0)
    v_pk_add_f32 v[180:181], v[180:181], v[182:183]
    v_pk_add_f32 v[184:185], v[184:185], v[186:187]
    v_pk_add_f32 v[180:181], v[180:181], v[184:185]
    v_mul_f32 v182, 0x3b800000, v180
    v_mul_f32 v181, 0x3b800000, v181
    v_fma_f32 v181, -v182, v182, v181
    v_max_f32 v181, 0, v181
    v_add_f32 v181, 0x38ae990f, v181
    v_rsq_f32 v180, v181
    s_nop 0
    v_mul_f32_e64 v182, -v182, v180
    v_pk_fma_f32 v[16:17], v[16:17], v[180:181], v[182:183] op_sel_hi:[1,0,0]
    v_pk_fma_f32 v[18:19], v[18:19], v[180:181], v[182:183] op_sel_hi:[1,0,0]
    v_pk_fma_f32 v[20:21], v[20:21], v[180:181], v[182:183] op_sel_hi:[1,0,0]
    v_pk_fma_f32 v[22:23], v[22:23], v[180:181], v[182:183] op_sel_hi:[1,0,0]
    v_pk_fma_f32 v[24:25], v[24:25], v[180:181], v[182:183] op_sel_hi:[1,0,0]
    v_pk_fma_f32 v[26:27], v[26:27], v[180:181], v[182:183] op_sel_hi:[1,0,0]
    v_pk_fma_f32 v[28:29], v[28:29], v[180:181], v[182:183] op_sel_hi:[1,0,0]
    v_pk_fma_f32 v[30:31], v[30:31], v[180:181], v[182:183] op_sel_hi:[1,0,0]
    v_pk_fma_f32 v[32:33], v[32:33], v[180:181], v[182:183] op_sel_hi:[1,0,0]
    v_pk_fma_f32 v[34:35], v[34:35], v[180:181], v[182:183] op_sel_hi:[1,0,0]
    v_pk_fma_f32 v[36:37], v[36:37], v[180:181], v[182:183] op_sel_hi:[1,0,0]
    v_pk_fma_f32 v[38:39], v[38:39], v[180:181], v[182:183] op_sel_hi:[1,0,0]
    v_pk_fma_f32 v[40:41], v[40:41], v[180:181], v[182:183] op_sel_hi:[1,0,0]
    v_pk_fma_f32 v[42:43], v[42:43], v[180:181], v[182:183] op_sel_hi:[1,0,0]
    v_pk_fma_f32 v[44:45], v[44:45], v[180:181], v[182:183] op_sel_hi:[1,0,0]
    v_pk_fma_f32 v[46:47], v[46:47], v[180:181], v[182:183] op_sel_hi:[1,0,0]
    v_cvt_pk_bf16_f32 v48, v16, v17
    v_cvt_pk_bf16_f32 v49, v18, v19
    v_cvt_pk_bf16_f32 v50, v20, v21
    v_cvt_pk_bf16_f32 v51, v22, v23
    v_cvt_pk_bf16_f32 v52, v24, v25
    v_cvt_pk_bf16_f32 v53, v26, v27
    v_cvt_pk_bf16_f32 v54, v28, v29
    v_cvt_pk_bf16_f32 v55, v30, v31
    v_cvt_pk_bf16_f32 v56, v32, v33
    v_cvt_pk_bf16_f32 v57, v34, v35
    v_cvt_pk_bf16_f32 v58, v36, v37
    v_cvt_pk_bf16_f32 v59, v38, v39
    v_cvt_pk_bf16_f32 v60, v40, v41
    v_cvt_pk_bf16_f32 v61, v42, v43
    v_cvt_pk_bf16_f32 v62, v44, v45
    v_cvt_pk_bf16_f32 v63, v46, v47
    v_permlane32_swap_b32 v48, v50
    v_permlane32_swap_b32 v49, v51
    ds_write_b128 v11, v[48:51] offset:0
    v_permlane32_swap_b32 v52, v54
    v_permlane32_swap_b32 v53, v55
    ds_write_b128 v11, v[52:55] offset:32
    v_permlane32_swap_b32 v56, v58
    v_permlane32_swap_b32 v57, v59
    ds_write_b128 v11, v[56:59] offset:64
    v_permlane32_swap_b32 v60, v62
    v_permlane32_swap_b32 v61, v63
    ds_write_b128 v11, v[60:63] offset:96
    s_waitcnt lgkmcnt(0)
    s_barrier
    ds_read_b128 v[64:67], v8 offset:0
    ds_read_b128 v[68:71], v8 offset:1056
    ds_read_b128 v[72:75], v8 offset:2112
    ds_read_b128 v[76:79], v8 offset:3168
    s_waitcnt lgkmcnt(3)
    buffer_store_dwordx4 v[64:67], v1, s[16:19], s24 offen offset:0
    s_waitcnt lgkmcnt(2)
    buffer_store_dwordx4 v[68:71], v1, s[16:19], s24 offen offset:1024
    s_waitcnt lgkmcnt(1)
    buffer_store_dwordx4 v[72:75], v1, s[16:19], s24 offen offset:2048
    s_waitcnt lgkmcnt(0)
    buffer_store_dwordx4 v[76:79], v1, s[16:19], s24 offen offset:3072
    s_endpgm
post_kernel_idle:
    s_waitcnt vmcnt(0)
    buffer_store_dwordx2 v[252:253], off, s[44:47], s39 sc1
    s_endpgm
post_kernel_xs1:
    global_store_dwordx4 v4, v[144:147], s[6:7] offset:0 sc1
    s_branch post_kernel_xj1
post_kernel_xs2:
    global_store_dwordx4 v4, v[148:151], s[6:7] offset:1024 sc1
    s_branch post_kernel_xj2
post_kernel_xs3:
    global_store_dwordx4 v4, v[152:155], s[6:7] offset:2048 sc1
    s_branch post_kernel_xj3
post_kernel_xs4:
    global_store_dwordx4 v4, v[156:159], s[6:7] offset:3072 sc1
    s_branch post_kernel_xj4
post_kernel_xs5:
    global_store_dwordx2 v14, v[252:253], s[4:5] offset:256 sc1
    s_branch post_kernel_xj5
post_kernel_p1c:
    global_load_dwordx2 v[254:255], v13, s[4:5] offset:256 sc1
    s_waitcnt vmcnt(0)
    s_branch post_kernel_p1
post_kernel_xs7:
    global_store_dwordx4 v15, v[228:231], s[6:7] offset:0 sc1
    s_branch post_kernel_xj7
post_kernel_xs8:
    global_store_dwordx4 v15, v[232:235], s[6:7] offset:1024 sc1
    s_branch post_kernel_xj8
post_kernel_xs9:
    global_store_dwordx4 v15, v[236:239], s[6:7] offset:2048 sc1
    s_branch post_kernel_xj9
post_kernel_xs10:
    global_store_dwordx4 v15, v[240:243], s[6:7] offset:3072 sc1
    s_branch post_kernel_xj10
post_kernel_xs11:
    global_store_dwordx2 v14, v[252:253], s[4:5] offset:384 sc1
    s_branch post_kernel_xj11
post_kernel_p2c:
    global_load_dwordx2 v[254:255], v13, s[4:5] offset:384 sc1
    s_waitcnt vmcnt(0)
    s_branch post_kernel_p2
standalone__conformer_family_zipformer__speech_kernel_end:
    s_endpgm
.section .rodata,"a"
.p2align 6
.amdhsa_kernel standalone__conformer_family_zipformer__speech_kernel
.amdhsa_next_free_vgpr 512
.amdhsa_next_free_sgpr 102
.amdhsa_accum_offset 256
.amdhsa_group_segment_fixed_size 0
.amdhsa_kernarg_size 104
.amdhsa_user_sgpr_count 2
.amdhsa_user_sgpr_kernarg_segment_ptr 1
.amdhsa_system_sgpr_workgroup_id_x 1
.amdhsa_float_denorm_mode_32 3
.end_amdhsa_kernel
```
